```python
import torch

def _softmax(x, axis=-1):
    return torch.softmax(x, dim=axis)
def _gelu(x):
    return torch.nn.functional.gelu(x, approximate="tanh")
def _silu(x):
    return torch.nn.functional.silu(x)
def _sigmoid(x):
    return torch.sigmoid(x)
def _layernorm(x, axis=-1, eps=1e-5):
    m = x.mean(dim=axis, keepdim=True)
    v = x.var(dim=axis, keepdim=True, unbiased=False)
    return (x - m) / torch.sqrt(v + eps)
def _scatter_add(tgt, idx, src, axis=0):
    return tgt.clone().index_add_(axis, idx, src)
def _segment_sum(src, seg, n):
    out = torch.zeros((n,) + src.shape[1:], dtype=src.dtype)
    return out.index_add_(0, seg, src)
def _pad(x, pw):
    flat = tuple(v for pair in reversed(pw) for v in pair)
    return torch.nn.functional.pad(x, flat)

kernel_name = 'parallel_sum__linear_kernel_hedgehog__glu_gated_reglu__prompt'

def setup_inputs():

    _w = (lambda a: (lambda t: t.to(torch.bfloat16) if t.is_floating_point() else t)(torch.as_tensor(a)))
    def _A_setup():
        B, S, D, H = 1, 2048, 576, 32
        Dh = D // H
        return {
            "x": _w((lambda *s: torch.randn(*s, dtype=torch.bfloat16) * 0.05)(B, S, D)),
            "wqkv": _w((lambda *s: torch.randn(*s, dtype=torch.bfloat16) * 0.2)(D, 3 * D)),
            "w_phi": _w((lambda *s: torch.randn(*s, dtype=torch.bfloat16) * 0.2)(H, Dh, Dh) * (Dh ** -0.5)),
            "wo": _w((lambda *s: torch.randn(*s, dtype=torch.bfloat16) * 0.05)(D, D)),
        }
    _A_in = _A_setup()

    def _B_setup():
        B, S, D, F = 1, 2048, 576, 4608
        return {
            "x": _w((lambda *s: torch.randn(*s, dtype=torch.bfloat16) * 0.05)(B, S, D)),
            "W_gate": _w((lambda *s: torch.randn(*s, dtype=torch.bfloat16) * 0.4)(D, F) * (2.0 / D) ** 0.5),
            "W_up": _w((lambda *s: torch.randn(*s, dtype=torch.bfloat16) * 0.4)(D, F) * (2.0 / D) ** 0.5),
            "W_down": _w((lambda *s: torch.randn(*s, dtype=torch.bfloat16) * 0.4)(F, D) * (1.0 / F) ** 0.5),
        }
    _B_in = _B_setup()

    return {
        "A_x": _A_in["x"],
        "A_wqkv": _A_in["wqkv"],
        "A_w_phi": _A_in["w_phi"],
        "A_wo": _A_in["wo"],
        "B_x": _B_in["x"],
        "B_W_gate": _B_in["W_gate"],
        "B_W_up": _B_in["W_up"],
        "B_W_down": _B_in["W_down"],
    }

def reference(A_x, A_wqkv, A_w_phi, A_wo, B_x, B_W_gate, B_W_up, B_W_down):
    def _A_ref(x, wqkv, w_phi, wo):
        B, S, D = x.shape
        H = 32; Dh = D // H
        qkv = (lambda x, *d: x.permute(*d))((x @ wqkv).reshape(B, S, 3, H, Dh), 2, 0, 3, 1, 4)
        q, k, v = qkv[0], qkv[1], qkv[2]
        pq = torch.einsum("bhsd,hdf->bhsf", q, w_phi)
        pk = torch.einsum("bhsd,hdf->bhsf", k, w_phi)
        phi_q = torch.concatenate([_softmax(pq, axis=-1), _softmax(-pq, axis=-1)], axis=-1)
        phi_k = torch.concatenate([_softmax(pk, axis=-1), _softmax(-pk, axis=-1)], axis=-1)
        kv = torch.einsum("bhsf,bhsd->bhfd", phi_k, v)
        z  = torch.einsum("bhsf->bhf", phi_k)
        num = torch.einsum("bhqf,bhfd->bhqd", phi_q, kv)
        den = torch.einsum("bhqf,bhf->bhq", phi_q, z)[..., None] + 1e-6
        o = num / den
        return (lambda x, *d: x.permute(*d))(o, 0, 2, 1, 3).reshape(B, S, D) @ wo

    def _B_ref(x, W_gate, W_up, W_down):
        gate = torch.einsum("bsd,df->bsf", x, W_gate)
        up = torch.einsum("bsd,df->bsf", x, W_up)
        gate = gate * (lambda x, dt: x.to(dt))(gate > 0, gate.dtype)
        h = gate * up
        return torch.einsum("bsf,fd->bsd", h, W_down)

    x = A_x
    xn = _layernorm(x, axis=-1)
    return x + _A_ref(xn, A_wqkv, A_w_phi, A_wo) + _B_ref(xn, B_W_gate, B_W_up, B_W_down)
```

```asm
; @launch grid=(256,1,1) block=(256,1,1) lds=163840
.amdgcn_target "amdgcn-amd-amdhsa--gfx950"
.text
.globl parallel_sum__linear_kernel_hedgehog__glu_gated_reglu__prompt_kernel
.p2align 12
.p2align 8
.type parallel_sum__linear_kernel_hedgehog__glu_gated_reglu__prompt_kernel,@function
parallel_sum__linear_kernel_hedgehog__glu_gated_reglu__prompt_kernel:
  s_cmp_ge_u32 s2, 256
  s_cbranch_scc1 K1_end
  s_load_dwordx2 s[4:5], s[0:1], 80
  s_load_dwordx16 s[64:79], s[0:1], 0
  s_load_dwordx2 s[30:31], s[0:1], 64
  v_lshrrev_b32 v13, 6, v0
  v_and_b32 v0, 63, v0
  v_readfirstlane_b32 s34, v13
  s_and_b32 s33, s2, 7
  s_lshl_b32 s33, s33, 1
  s_bfe_u32 s42, s2, 0x10003
  s_add_u32 s33, s33, s42
  s_lshr_b32 s32, s2, 4
  v_lshlrev_b32 v1, 4, v0
  s_mov_b32 s6, 268435456
  s_mov_b32 s7, 0x20000
  s_lshr_b32 s35, s34, 1
  s_and_b32 s36, s34, 1
  s_lshl_b32 s39, s34, 11
  s_mul_i32 s40, s34, 3072
  s_mul_i32 s41, s34, 6144
  s_mul_i32 s37, s32, 147456
  s_add_u32 s37, s37, s39
  s_mul_i32 s38, s33, 221184
  s_add_u32 s38, s38, s40
  s_add_u32 s38, s38, 2359296
  s_load_dwordx2 s[84:85], s[0:1], 72
  s_memrealtime s[94:95]
  v_and_b32 v32, 7, v0
  v_lshrrev_b32 v33, 3, v0
  v_mul_u32_u24 v34, 1152, v32
  v_lshl_add_u32 v35, v33, 4, v34
  s_mul_i32 s88, s34, 384
  s_cmp_eq_u32 s34, 3
  s_cselect_b32 s92, 0x40000000, 0
  s_or_b32 s88, s88, s92
  v_add_u32 v35, s88, v35
  s_lshl_b32 s91, s32, 4
  s_add_u32 s91, s91, s33
  s_mul_i32 s88, s91, 9216
  s_waitcnt lgkmcnt(0)
  s_mov_b32 s8, s64
  s_mov_b32 s9, s65
  s_mov_b32 s10, 2359296
  s_mov_b32 s11, 0x20000
  buffer_load_dwordx4 v[40:43], v35, s[8:11], s88 offen offset:0
  buffer_load_dwordx4 v[44:47], v35, s[8:11], s88 offen offset:128
  buffer_load_dwordx4 v[48:51], v35, s[8:11], s88 offen offset:256
  buffer_load_ushort v52, v34, s[8:11], s88 offen
  s_mov_b32 s86, 256
  s_mov_b32 s87, 0x20000
  v_lshl_add_u32 v36, s34, 6, v0
  v_min_u32 v36, 1, v36
  v_lshlrev_b32 v36, 30, v36
  s_or_b32 s89, s94, 1
  v_mov_b32 v37, s89
  s_min_u32 s89, s2, 1
  s_lshl_b32 s89, s89, 30
  buffer_store_dword v37, v36, s[84:87], s89 offen sc1
  s_mov_b32 s12, s66
  s_mov_b32 s13, s67
  s_mov_b32 s14, 1990656
  s_mov_b32 s15, 0x20000
  s_mul_i32 s89, s33, 9
  s_add_u32 s89, s89, s34
  v_lshrrev_b32 v38, 4, v0
  s_and_b32 s90, s89, 2
  s_lshl_b32 s90, s90, 1
  v_add_u32 v39, s90, v38
  v_lshlrev_b32 v39, 1, v39
  v_sub_u32 v39, v0, v39
  v_and_b32 v39, 15, v39
  v_min_u32 v39, 14, v39
  v_mul_u32_u24 v53, 52, v39
  v_lshrrev_b32 v53, 8, v53
  v_mul_u32_u24 v53, 1072, v53
  v_lshl_add_u32 v53, v39, 4, v53
  v_mul_u32_u24 v39, 3456, v38
  v_add_u32 v53, v53, v39
  s_mul_i32 s90, s89, 13824
  s_mul_i32 s88, s32, 72
  s_add_u32 s90, s90, s88
  s_min_u32 s45, s34, 1
  s_lshl_b32 s45, s45, 30
  buffer_load_dwordx4 v[56:59], v53, s[12:15], s90 offen nt
  s_add_u32 s90, s90, 55296
  buffer_load_dwordx4 v[60:63], v53, s[12:15], s90 offen nt
  s_add_u32 s90, s90, 55296
  s_or_b32 s90, s90, s45
  buffer_load_dwordx4 v[64:67], v53, s[12:15], s90 offen nt
  s_bitcmp1_b32 s33, 0
  s_cselect_b32 s16, s76, s74
  s_cselect_b32 s17, s77, s75
  s_mov_b32 s18, 5308416
  s_mov_b32 s19, 0x20000
  s_mul_i32 s90, s32, 36
  s_lshl_b32 s88, s34, 3
  s_add_u32 s90, s90, s88
  v_add_u32 v54, s90, v33
  v_mul_u32_u24 v55, 9216, v54
  v_lshl_add_u32 v55, v32, 4, v55
  s_lshr_b32 s88, s33, 1
  s_mul_i32 s90, s88, 1152
  buffer_load_dwordx4 v[68:71], v55, s[16:19], s90 offen offset:512 nt
  v_lshrrev_b32 v76, 5, v0
  v_lshlrev_b32 v76, 30, v76
  v_or_b32 v76, s45, v76
  v_or_b32 v55, v55, v76
  s_add_u32 s90, s90, 294912
  buffer_load_dwordx4 v[72:75], v55, s[16:19], s90 offen offset:512 nt
  s_mov_b32 s20, s68
  s_mov_b32 s21, s69
  s_mov_b32 s22, 20736
  s_mov_b32 s23, 0x20000
  s_lshl_b32 s88, s33, 1
  s_add_u32 s88, s88, s35
  s_mul_i32 s88, s88, 648
  s_lshl_b32 s90, s34, 10
  s_add_u32 m0, s90, 135168
  s_nop 0
  buffer_load_dwordx4 v1, s[20:23], s88 offen lds
  s_getpc_b64 s[60:61]
K1_pc:
  s_sub_u32 s60, s60, K1_pc-parallel_sum__linear_kernel_hedgehog__glu_gated_reglu__prompt_kernel
  s_subb_u32 s61, s61, 0
  s_lshr_b32 s88, s2, 3
  s_lshl_b32 s88, s88, 2
  s_add_u32 s88, s88, s34
  s_lshl_b32 s88, s88, 9
  s_min_u32 s88, s88, K1_last-parallel_sum__linear_kernel_hedgehog__glu_gated_reglu__prompt_kernel-512
  v_lshl_add_u32 v85, v0, 3, s88
  global_load_dword v86, v85, s[60:61]
  s_cmp_eq_u32 s35, 0
  s_cselect_b32 s24, s74, s76
  s_cselect_b32 s25, s75, s77
  s_mov_b32 s26, 5308416
  s_mov_b32 s27, 0x20000
  v_min_u32 v87, 17, v0
  v_mul_u32_u24 v87, 9216, v87
  s_lshl_b32 s93, s32, 1
  s_add_u32 s93, s93, s36
  s_mul_i32 s93, s93, 165888
  s_mul_i32 s90, s33, 576
  s_add_u32 s93, s93, s90
  s_mov_b32 s44, s93
  v_mov_b32 v80, 0
  v_mov_b32 v81, 0
  v_mov_b32 v82, 0
  v_mov_b32 v83, 0
  s_lshl_b32 s88, s91, 4
  s_add_u32 s88, s88, 6234112
  buffer_store_dwordx4 v[80:83], v36, s[4:7], s88 offen sc1
  s_lshl_b32 s88, s33, 6
  s_add_u32 s88, s88, s32
  s_lshl_b32 s88, s88, 2
  s_add_u32 s88, s88, 6225920
  buffer_store_dword v80, v36, s[4:7], s88 offen sc1
  s_and_b32 s90, s33, 1
  s_lshl_b32 s88, s32, 1
  s_add_u32 s88, s88, s90
  s_lshl_b32 s88, s88, 5
  s_lshr_b32 s90, s33, 1
  s_add_u32 s88, s88, s90
  s_lshl_b32 s88, s88, 2
  s_add_u32 s88, s88, 6230016
  buffer_store_dword v80, v36, s[4:7], s88 offen sc1
  v_lshlrev_b32 v84, 2, v0
  v_add_u32 v84, 131072, v84
  ds_write_b32 v84, v80
  s_lshr_b32 s88, s89, 1
  s_mul_i32 s88, s88, 3072
  s_and_b32 s90, s89, 1
  s_lshl_b32 s90, s90, 10
  s_add_u32 s88, s88, s90
  s_mul_i32 s90, s32, 221184
  s_add_u32 s88, s88, s90
  s_add_u32 s46, s88, 2359296
  s_add_u32 s47, s88, 2365440
  s_add_u32 s48, s88, 2371584
  s_or_b32 s48, s48, s45
  v_lshrrev_b32 v93, 5, v54
  v_mul_u32_u24 v93, 12288, v93
  v_bfe_u32 v94, v54, 4, 1
  v_mul_u32_u24 v94, 3072, v94
  v_add_u32 v93, v93, v94
  v_and_b32 v94, 15, v54
  v_lshl_add_u32 v93, v94, 6, v93
  v_bfe_u32 v94, v54, 3, 1
  v_lshlrev_b32 v94, 1, v94
  v_and_b32 v95, 3, v32
  v_xor_b32 v94, v94, v95
  v_lshl_add_u32 v93, v94, 4, v93
  v_lshrrev_b32 v94, 2, v32
  v_mul_u32_u24 v94, 221184, v94
  v_add_u32 v93, v93, v94
  v_add_u32 v94, 12288, v93
  v_or_b32 v94, v94, v76
  s_lshr_b32 s89, s33, 1
  s_mul_i32 s89, s89, 442368
  s_and_b32 s90, s33, 1
  s_mul_i32 s90, s90, 6144
  s_add_u32 s89, s89, s90
  s_add_u32 s89, s89, 2361344
  v_lshrrev_b32 v89, 5, v0
  v_lshlrev_b32 v90, 13, v89
  v_and_b32 v91, 3, v33
  v_lshl_add_u32 v90, v91, 8, v90
  v_lshl_add_u32 v90, v32, 4, v90
  s_mul_i32 s88, s34, 49152
  s_or_b32 s88, s88, s92
  v_add_u32 v90, s88, v90
  v_lshl_add_u32 v91, v32, 1, v89
  v_lshlrev_b32 v91, 4, v91
  v_add_u32 v91, 126976, v91
  v_lshl_add_u32 v92, s34, 2, v91
  s_mul_i32 s88, s32, 147456
  s_lshr_b32 s90, s33, 1
  s_lshl_b32 s90, s90, 10
  s_add_u32 s88, s88, s90
  s_and_b32 s90, s33, 1
  s_lshl_b32 s90, s90, 7
  s_add_u32 s88, s88, s90
  s_waitcnt vmcnt(14)
  v_lshlrev_b32 v128, 16, v40
  v_and_b32 v129, 0xffff0000, v40
  v_lshlrev_b32 v130, 16, v41
  v_and_b32 v131, 0xffff0000, v41
  v_lshlrev_b32 v132, 16, v42
  v_and_b32 v133, 0xffff0000, v42
  v_lshlrev_b32 v134, 16, v43
  v_and_b32 v135, 0xffff0000, v43
  s_waitcnt vmcnt(13)
  v_lshlrev_b32 v136, 16, v44
  v_and_b32 v137, 0xffff0000, v44
  v_lshlrev_b32 v138, 16, v45
  v_and_b32 v139, 0xffff0000, v45
  v_lshlrev_b32 v140, 16, v46
  v_and_b32 v141, 0xffff0000, v46
  v_lshlrev_b32 v142, 16, v47
  v_and_b32 v143, 0xffff0000, v47
  s_waitcnt vmcnt(12)
  v_lshlrev_b32 v144, 16, v48
  v_and_b32 v145, 0xffff0000, v48
  v_lshlrev_b32 v146, 16, v49
  v_and_b32 v147, 0xffff0000, v49
  v_lshlrev_b32 v148, 16, v50
  v_and_b32 v149, 0xffff0000, v50
  v_lshlrev_b32 v150, 16, v51
  v_and_b32 v151, 0xffff0000, v51
  s_waitcnt vmcnt(11)
  v_lshlrev_b32 v52, 16, v52
  buffer_load_dword v37, off, s[84:87], 0 sc1
  v_sub_f32 v152, v128, v52
  v_sub_f32 v153, v129, v52
  v_sub_f32 v154, v130, v52
  v_sub_f32 v155, v131, v52
  v_sub_f32 v156, v132, v52
  v_sub_f32 v157, v133, v52
  v_sub_f32 v158, v134, v52
  v_sub_f32 v159, v135, v52
  v_sub_f32 v160, v136, v52
  v_sub_f32 v161, v137, v52
  v_sub_f32 v162, v138, v52
  v_sub_f32 v163, v139, v52
  v_sub_f32 v164, v140, v52
  v_sub_f32 v165, v141, v52
  v_sub_f32 v166, v142, v52
  v_sub_f32 v167, v143, v52
  v_sub_f32 v168, v144, v52
  v_sub_f32 v169, v145, v52
  v_sub_f32 v170, v146, v52
  v_sub_f32 v171, v147, v52
  v_sub_f32 v172, v148, v52
  v_sub_f32 v173, v149, v52
  v_sub_f32 v174, v150, v52
  v_sub_f32 v175, v151, v52
  v_mul_f32 v40, v152, v152
  v_mul_f32 v41, v153, v153
  v_mul_f32 v42, v154, v154
  v_mul_f32 v43, v155, v155
  v_add_f32 v44, v152, v156
  v_add_f32 v45, v153, v157
  v_add_f32 v46, v154, v158
  v_add_f32 v47, v155, v159
  v_fmac_f32 v40, v156, v156
  v_fmac_f32 v41, v157, v157
  v_fmac_f32 v42, v158, v158
  v_fmac_f32 v43, v159, v159
  v_fmac_f32 v40, v160, v160
  v_fmac_f32 v41, v161, v161
  v_fmac_f32 v42, v162, v162
  v_fmac_f32 v43, v163, v163
  v_fmac_f32 v40, v164, v164
  v_fmac_f32 v41, v165, v165
  v_fmac_f32 v42, v166, v166
  v_fmac_f32 v43, v167, v167
  v_fmac_f32 v40, v168, v168
  v_fmac_f32 v41, v169, v169
  v_fmac_f32 v42, v170, v170
  v_fmac_f32 v43, v171, v171
  v_fmac_f32 v40, v172, v172
  v_fmac_f32 v41, v173, v173
  v_fmac_f32 v42, v174, v174
  v_fmac_f32 v43, v175, v175
  v_add_f32 v44, v44, v160
  v_add_f32 v45, v45, v161
  v_add_f32 v46, v46, v162
  v_add_f32 v47, v47, v163
  v_add_f32 v44, v44, v164
  v_add_f32 v45, v45, v165
  v_add_f32 v46, v46, v166
  v_add_f32 v47, v47, v167
  v_add_f32 v44, v44, v168
  v_add_f32 v45, v45, v169
  v_add_f32 v46, v46, v170
  v_add_f32 v47, v47, v171
  v_add_f32 v44, v44, v172
  v_add_f32 v45, v45, v173
  v_add_f32 v46, v46, v174
  v_add_f32 v47, v47, v175
  v_add_f32 v40, v40, v41
  v_add_f32 v42, v42, v43
  v_add_f32 v44, v44, v45
  v_add_f32 v46, v46, v47
  v_add_f32 v41, v40, v42
  v_add_f32 v40, v44, v46
  s_nop 1
  v_permlane32_swap_b32 v40, v41
  v_add_f32 v40, v40, v41
  v_mov_b32 v41, v40
  s_nop 1
  v_permlane16_swap_b32 v40, v41
  v_add_f32 v40, v40, v41
  s_nop 1
  v_add_f32_dpp v40, v40, v40 row_ror:8 row_mask:0xf bank_mask:0xf
  ds_write_b32 v92, v40
  s_waitcnt lgkmcnt(0)
  s_barrier
  ds_read_b128 v[40:43], v91
  s_waitcnt lgkmcnt(0)
  v_add_f32 v40, v40, v41
  v_add_f32 v40, v40, v42
  v_mul_f32 v40, 0x3ae38e39, v40
  v_mov_b32 v41, v40
  s_nop 1
  v_permlane32_swap_b32 v40, v41
  v_add_f32 v42, v52, v40
  v_fma_f32 v41, -v40, v40, v41
  v_cvt_pk_bf16_f32 v42, v42, v42
  v_and_b32 v42, 0xffff0000, v42
  v_max_f32 v41, 0, v41
  v_cvt_pk_bf16_f32 v41, v41, v41
  v_and_b32 v41, 0xffff0000, v41
  v_add_f32 v41, 0x3727c5ac, v41
  v_cvt_pk_bf16_f32 v41, v41, v41
  v_and_b32 v41, 0xffff0000, v41
  v_sqrt_f32 v41, v41
  v_sub_f32 v128, v128, v42
  v_sub_f32 v129, v129, v42
  v_sub_f32 v130, v130, v42
  v_sub_f32 v131, v131, v42
  v_sub_f32 v132, v132, v42
  v_sub_f32 v133, v133, v42
  v_sub_f32 v134, v134, v42
  v_sub_f32 v135, v135, v42
  v_sub_f32 v136, v136, v42
  v_sub_f32 v137, v137, v42
  v_sub_f32 v138, v138, v42
  v_sub_f32 v139, v139, v42
  v_sub_f32 v140, v140, v42
  v_sub_f32 v141, v141, v42
  v_sub_f32 v142, v142, v42
  v_sub_f32 v143, v143, v42
  v_sub_f32 v144, v144, v42
  v_sub_f32 v145, v145, v42
  v_sub_f32 v146, v146, v42
  v_sub_f32 v147, v147, v42
  v_sub_f32 v148, v148, v42
  v_sub_f32 v149, v149, v42
  v_sub_f32 v150, v150, v42
  v_sub_f32 v151, v151, v42
  v_cvt_pk_bf16_f32 v41, v41, v41
  v_and_b32 v41, 0xffff0000, v41
  v_rcp_f32 v43, v41
  v_cvt_pk_bf16_f32 v152, v128, v129
  v_cvt_pk_bf16_f32 v153, v130, v131
  v_cvt_pk_bf16_f32 v154, v132, v133
  v_cvt_pk_bf16_f32 v155, v134, v135
  v_cvt_pk_bf16_f32 v156, v136, v137
  v_cvt_pk_bf16_f32 v157, v138, v139
  v_cvt_pk_bf16_f32 v158, v140, v141
  v_cvt_pk_bf16_f32 v159, v142, v143
  v_cvt_pk_bf16_f32 v160, v144, v145
  v_cvt_pk_bf16_f32 v161, v146, v147
  v_cvt_pk_bf16_f32 v162, v148, v149
  v_cvt_pk_bf16_f32 v163, v150, v151
  v_fma_f32 v44, -v41, v43, 1.0
  v_fmac_f32 v43, v44, v43
  v_lshlrev_b32 v128, 16, v152
  v_and_b32 v129, 0xffff0000, v152
  v_lshlrev_b32 v130, 16, v153
  v_and_b32 v131, 0xffff0000, v153
  v_lshlrev_b32 v132, 16, v154
  v_and_b32 v133, 0xffff0000, v154
  v_lshlrev_b32 v134, 16, v155
  v_and_b32 v135, 0xffff0000, v155
  v_mul_f32 v128, v128, v43
  v_mul_f32 v129, v129, v43
  v_mul_f32 v130, v130, v43
  v_mul_f32 v131, v131, v43
  v_mul_f32 v132, v132, v43
  v_mul_f32 v133, v133, v43
  v_mul_f32 v134, v134, v43
  v_mul_f32 v135, v135, v43
  v_cvt_pk_bf16_f32 v164, v128, v129
  v_cvt_pk_bf16_f32 v165, v130, v131
  v_cvt_pk_bf16_f32 v166, v132, v133
  v_cvt_pk_bf16_f32 v167, v134, v135
  buffer_store_dwordx4 v[164:167], v90, s[4:7], s88 offen sc1
  v_lshlrev_b32 v136, 16, v156
  v_and_b32 v137, 0xffff0000, v156
  v_lshlrev_b32 v138, 16, v157
  v_and_b32 v139, 0xffff0000, v157
  v_lshlrev_b32 v140, 16, v158
  v_and_b32 v141, 0xffff0000, v158
  v_lshlrev_b32 v142, 16, v159
  v_and_b32 v143, 0xffff0000, v159
  v_mul_f32 v136, v136, v43
  v_mul_f32 v137, v137, v43
  v_mul_f32 v138, v138, v43
  v_mul_f32 v139, v139, v43
  v_mul_f32 v140, v140, v43
  v_mul_f32 v141, v141, v43
  v_mul_f32 v142, v142, v43
  v_mul_f32 v143, v143, v43
  v_cvt_pk_bf16_f32 v168, v136, v137
  v_cvt_pk_bf16_f32 v169, v138, v139
  v_cvt_pk_bf16_f32 v170, v140, v141
  v_cvt_pk_bf16_f32 v171, v142, v143
  s_add_u32 s88, s88, 16384
  buffer_store_dwordx4 v[168:171], v90, s[4:7], s88 offen sc1
  v_lshlrev_b32 v144, 16, v160
  v_and_b32 v145, 0xffff0000, v160
  v_lshlrev_b32 v146, 16, v161
  v_and_b32 v147, 0xffff0000, v161
  v_lshlrev_b32 v148, 16, v162
  v_and_b32 v149, 0xffff0000, v162
  v_lshlrev_b32 v150, 16, v163
  v_and_b32 v151, 0xffff0000, v163
  v_mul_f32 v144, v144, v43
  v_mul_f32 v145, v145, v43
  v_mul_f32 v146, v146, v43
  v_mul_f32 v147, v147, v43
  v_mul_f32 v148, v148, v43
  v_mul_f32 v149, v149, v43
  v_mul_f32 v150, v150, v43
  v_mul_f32 v151, v151, v43
  v_cvt_pk_bf16_f32 v172, v144, v145
  v_cvt_pk_bf16_f32 v173, v146, v147
  v_cvt_pk_bf16_f32 v174, v148, v149
  v_cvt_pk_bf16_f32 v175, v150, v151
  s_add_u32 s88, s88, 16384
  buffer_store_dwordx4 v[172:175], v90, s[4:7], s88 offen sc1
  s_waitcnt vmcnt(13)
  buffer_store_dwordx4 v[56:59], v1, s[4:7], s46 offen sc1
  s_waitcnt vmcnt(13)
  buffer_store_dwordx4 v[60:63], v1, s[4:7], s47 offen sc1
  s_waitcnt vmcnt(13)
  buffer_store_dwordx4 v[64:67], v1, s[4:7], s48 offen sc1
  s_waitcnt vmcnt(13)
  buffer_store_dwordx4 v[68:71], v93, s[4:7], s89 offen sc1
  s_waitcnt vmcnt(13)
  buffer_store_dwordx4 v[72:75], v94, s[4:7], s89 offen sc1
  s_waitcnt vmcnt(8)
  v_readfirstlane_b32 s93, v37
  s_mov_b32 s3, 200000
  s_nop 3
K1_tag:
  s_cmp_lg_u32 s93, 0
  s_cbranch_scc1 K1_tagok
  buffer_load_dword v37, off, s[84:87], 0 sc1
  s_waitcnt vmcnt(0)
  v_readfirstlane_b32 s93, v37
  s_nop 3
  s_sub_u32 s3, s3, 1
  s_cbranch_scc0 K1_tag
K1_tagok:
  s_waitcnt vmcnt(0) lgkmcnt(0)
  s_barrier
  s_lshl_b32 s88, s91, 6
  s_add_u32 s88, s88, 6242304
  buffer_store_dword v37, v36, s[4:7], s88 offen sc1
  buffer_load_dword v88, v87, s[24:27], s44 offen offset:64
  s_mov_b64 exec, 0
  s_cmp_eq_u32 s34, 0
  s_cbranch_scc1 STUB0
  s_cmp_eq_u32 s34, 1
  s_cbranch_scc1 STUB1
  s_cmp_eq_u32 s34, 2
  s_cbranch_scc1 STUB2
  s_branch STUB3
K1_back0:
  s_mov_b64 exec, -1
  s_branch K1_body
.p2align 12
K1_body:
STUB0:
  s_cbranch_execz K1_back0
  v_lshrrev_b32 v184, 4, v0
  v_bfe_u32 v185, v0, 2, 2
  v_and_b32 v186, 3, v0
  v_and_b32 v187, 1, v184
  v_lshl_add_u32 v188, v187, 2, v185
  v_lshlrev_b32 v188, 5, v188
  v_mul_u32_u24 v189, 3072, v184
  v_lshl_add_u32 v189, v185, 8, v189
  v_lshl_add_u32 v190, v186, 3, v188
  s_mul_i32 s42, s36, 40
  s_add_u32 s43, s42, 0
  v_add_u32 v191, s43, v190
  v_and_b32 v191, 255, v191
  v_add_u32 v4, v189, v191
  s_add_u32 s43, s42, 80
  v_add_u32 v191, s43, v190
  v_and_b32 v191, 255, v191
  v_add_u32 v6, v189, v191
  s_add_u32 s43, s42, 160
  v_add_u32 v191, s43, v190
  v_and_b32 v191, 255, v191
  v_add_u32 v7, v189, v191
  v_min_u32 v191, 2, v186
  v_mul_u32_u24 v191, 80, v191
  v_add3_u32 v191, v191, v188, 32
  v_and_b32 v191, 255, v191
  v_add_u32 v5, v189, v191
  s_lshl_b32 s42, s35, 12
  v_add_u32 v30, s42, v1
  v_xor_b32 v191, s36, v187
  v_lshlrev_b32 v191, 5, v191
  v_lshl_add_u32 v191, v186, 3, v191
  v_lshl_add_u32 v188, v187, 3, v185
  v_lshl_add_u32 v188, v188, 6, v191
  v_lshrrev_b32 v189, 1, v184
  v_mul_u32_u24 v189, 3072, v189
  v_add_u32 v14, v188, v189
  v_lshrrev_b32 v188, 3, v0
  s_lshl_b32 s42, s34, 3
  v_add_u32 v188, s42, v188
  v_mul_u32_u24 v188, 9216, v188
  s_lshl_b32 s42, s36, 2
  v_lshl_or_b32 v189, v187, 1, s42
  v_and_b32 v190, 7, v0
  v_xor_b32 v189, v189, v190
  v_lshl_add_u32 v3, v189, 4, v188
  v_lshrrev_b32 v188, 1, v185
  v_lshl_or_b32 v188, v187, 1, v188
  v_xor_b32 v188, s36, v188
  v_lshlrev_b32 v188, 5, v188
  v_lshl_add_u32 v188, v186, 3, v188
  v_lshl_add_u32 v188, v185, 7, v188
  v_mul_u32_u24 v189, 6144, v184
  v_add_u32 v12, v188, v189
  v_xor_b32 v13, 64, v12
  s_mov_b32 s12, s74
  s_mov_b32 s13, s75
  s_mov_b32 s14, 5308416
  s_mov_b32 s15, 0x20000
  s_mov_b32 s16, s76
  s_mov_b32 s17, s77
  s_mov_b32 s18, 5308416
  s_mov_b32 s19, 0x20000
  s_sub_u32 s20, s70, 4096
  s_subb_u32 s21, s71, 0
  s_mov_b32 s22, 667648
  s_mov_b32 s23, 0x20000
  s_cmp_eq_u32 s35, 0
  s_cselect_b32 s24, s74, s76
  s_cselect_b32 s25, s75, s77
  s_mov_b32 s26, 5308416
  s_mov_b32 s27, 0x20000
  s_mov_b32 s8, s78
  s_mov_b32 s9, s79
  s_mov_b32 s10, 5308416
  s_mov_b32 s11, 0x20000
  s_mov_b32 s28, s64
  s_mov_b32 s29, s65
  s_mul_i32 s42, s33, 576
  s_add_u32 s42, s42, 64
  s_and_b32 s42, s42, 0xffffff80
  s_add_u32 s64, s42, 0
  s_add_u32 s65, s42, 293888
  s_add_u32 s66, s42, 587776
  s_add_u32 s67, s42, 884736
  s_add_u32 s68, s42, 1178624
  s_add_u32 s69, s42, 1472512
  s_add_u32 s70, s42, 1769472
  s_add_u32 s71, s42, 2063360
  s_add_u32 s72, s42, 2357248
  s_add_u32 s73, s42, 2654208
  s_add_u32 s74, s42, 2948096
  s_add_u32 s75, s42, 3241984
  s_add_u32 s76, s42, 3538944
  s_add_u32 s77, s42, 3832832
  s_add_u32 s78, s42, 4126720
  s_add_u32 s79, s42, 4423680
  s_add_u32 s80, s42, 4717568
  s_add_u32 s81, s42, 5011456
  s_mul_i32 s83, s34, 5120
  s_mul_i32 s82, s33, 20480
  s_add_u32 s82, s82, s83
  s_add_u32 s82, s82, 5898240
  v_and_b32 v77, 15, v0
  v_lshrrev_b32 v78, 3, v77
  v_cmp_eq_u32 s[60:61], s36, v78
  v_cmp_eq_u32 s[62:63], s36, v38
  v_and_b32 v79, 3, v77
  v_cmp_gt_u32 vcc, 2, v79
  v_mov_b32 v80, 131072
  s_lshl_b32 s88, s35, 1
  v_lshl_add_u32 v81, v38, 2, s88
  v_mul_u32_u24 v81, 36, v81
  v_lshl_add_u32 v81, v79, 1, v81
  s_lshl_b32 s90, s34, 10
  s_add_u32 s90, s90, 135168
  v_add_u32 v81, s90, v81
  s_and_b64 s[62:63], s[62:63], s[60:61]
  s_cmp_eq_u32 s35, 0
  s_cselect_b32 s88, 576, 0
  s_add_u32 s88, s88, s90
  v_lshl_add_u32 v82, v79, 1, s88
  v_cndmask_b32 v81, v80, v81, s[60:61]
  v_cndmask_b32 v82, v80, v82, s[62:63]
  v_cndmask_b32 v83, v80, v81, vcc
  v_cndmask_b32 v84, v80, v82, vcc
  ds_read_u16 v96, v81 offset:0
  ds_read_u16 v97, v81 offset:36
  ds_read_u16 v98, v81 offset:72
  ds_read_u16 v99, v81 offset:108
  ds_read_u16 v100, v82 offset:0
  ds_read_u16 v101, v82 offset:36
  ds_read_u16 v102, v81 offset:8
  ds_read_u16 v103, v81 offset:44
  ds_read_u16 v104, v81 offset:80
  ds_read_u16 v105, v81 offset:116
  ds_read_u16 v106, v82 offset:8
  ds_read_u16 v107, v82 offset:44
  ds_read_u16 v108, v81 offset:16
  ds_read_u16 v109, v81 offset:52
  ds_read_u16 v110, v81 offset:88
  ds_read_u16 v111, v81 offset:124
  ds_read_u16 v112, v82 offset:16
  ds_read_u16 v113, v82 offset:52
  ds_read_u16 v114, v81 offset:24
  ds_read_u16 v115, v81 offset:60
  ds_read_u16 v116, v81 offset:96
  ds_read_u16 v117, v81 offset:132
  ds_read_u16 v118, v82 offset:24
  ds_read_u16 v119, v82 offset:60
  ds_read_u16 v120, v83 offset:32
  ds_read_u16 v121, v83 offset:68
  ds_read_u16 v122, v83 offset:104
  ds_read_u16 v123, v83 offset:140
  ds_read_u16 v124, v84 offset:32
  ds_read_u16 v125, v84 offset:68
  v_bfe_u32 v48, v77, 2, 1
  v_mul_u32_u24 v48, 0x8000, v48
  v_lshl_or_b32 v48, v48, 16, v48
  s_cmp_eq_u32 s35, 0
  s_cselect_b32 s88, -1, 0
  s_not_b32 s90, s88
  s_cmp_eq_u32 s36, 0
  s_cselect_b64 vcc, -1, 0
  s_mul_i32 s89, s35, 10240
  s_lshl_b32 s92, s36, 10
  s_add_u32 s89, s89, s92
  s_add_u32 s89, s89, 143360
  v_add_u32 v49, s89, v1
  s_waitcnt lgkmcnt(15)
  v_lshl_or_b32 v96, v97, 16, v96
  v_xor_b32 v96, v96, v48
  v_lshl_or_b32 v98, v99, 16, v98
  v_xor_b32 v98, v98, v48
  v_lshl_or_b32 v100, v101, 16, v100
  v_xor_b32 v100, v100, v48
  v_and_b32 v101, s90, v100
  v_and_b32 v100, s88, v100
  v_cndmask_b32 v128, v100, v96, vcc
  v_cndmask_b32 v129, v101, v98, vcc
  v_cndmask_b32 v130, v96, v100, vcc
  v_cndmask_b32 v131, v98, v101, vcc
  ds_write_b128 v49, v[128:131] offset:0
  v_lshl_or_b32 v102, v103, 16, v102
  v_xor_b32 v102, v102, v48
  v_lshl_or_b32 v104, v105, 16, v104
  v_xor_b32 v104, v104, v48
  v_lshl_or_b32 v106, v107, 16, v106
  v_xor_b32 v106, v106, v48
  v_and_b32 v107, s90, v106
  v_and_b32 v106, s88, v106
  v_cndmask_b32 v132, v106, v102, vcc
  v_cndmask_b32 v133, v107, v104, vcc
  v_cndmask_b32 v134, v102, v106, vcc
  v_cndmask_b32 v135, v104, v107, vcc
  ds_write_b128 v49, v[132:135] offset:2048
  v_lshl_or_b32 v108, v109, 16, v108
  v_xor_b32 v108, v108, v48
  s_waitcnt lgkmcnt(15)
  v_lshl_or_b32 v110, v111, 16, v110
  v_xor_b32 v110, v110, v48
  s_waitcnt lgkmcnt(14)
  v_lshl_or_b32 v112, v113, 16, v112
  v_xor_b32 v112, v112, v48
  v_and_b32 v113, s90, v112
  v_and_b32 v112, s88, v112
  v_cndmask_b32 v136, v112, v108, vcc
  v_cndmask_b32 v137, v113, v110, vcc
  v_cndmask_b32 v138, v108, v112, vcc
  v_cndmask_b32 v139, v110, v113, vcc
  ds_write_b128 v49, v[136:139] offset:4096
  s_waitcnt lgkmcnt(13)
  v_lshl_or_b32 v114, v115, 16, v114
  v_xor_b32 v114, v114, v48
  s_waitcnt lgkmcnt(11)
  v_lshl_or_b32 v116, v117, 16, v116
  v_xor_b32 v116, v116, v48
  s_waitcnt lgkmcnt(9)
  v_lshl_or_b32 v118, v119, 16, v118
  v_xor_b32 v118, v118, v48
  v_and_b32 v119, s90, v118
  v_and_b32 v118, s88, v118
  v_cndmask_b32 v140, v118, v114, vcc
  v_cndmask_b32 v141, v119, v116, vcc
  v_cndmask_b32 v142, v114, v118, vcc
  v_cndmask_b32 v143, v116, v119, vcc
  ds_write_b128 v49, v[140:143] offset:6144
  s_waitcnt lgkmcnt(8)
  v_lshl_or_b32 v120, v121, 16, v120
  v_xor_b32 v120, v120, v48
  s_waitcnt lgkmcnt(6)
  v_lshl_or_b32 v122, v123, 16, v122
  v_xor_b32 v122, v122, v48
  s_waitcnt lgkmcnt(4)
  v_lshl_or_b32 v124, v125, 16, v124
  v_xor_b32 v124, v124, v48
  v_and_b32 v125, s90, v124
  v_and_b32 v124, s88, v124
  v_cndmask_b32 v144, v124, v120, vcc
  v_cndmask_b32 v145, v125, v122, vcc
  v_cndmask_b32 v146, v120, v124, vcc
  v_cndmask_b32 v147, v122, v125, vcc
  ds_write_b128 v49, v[144:147] offset:8192
  v_and_b32 v77, 15, v0
  v_subrev_u32 v50, 16, v0
  v_and_b32 v50, 31, v50
  v_lshrrev_b32 v51, 1, v50
  v_and_b32 v50, 1, v50
  v_lshl_add_u32 v50, v51, 4, v50
  s_and_b32 s88, s33, 14
  v_add_u32 v50, s88, v50
  v_lshl_add_u32 v51, s32, 4, v77
  v_cmp_gt_u32 vcc, 16, v0
  s_nop 1
  v_cndmask_b32 v50, v50, v51, vcc
  v_lshl_add_u32 v51, s33, 4, v77
  v_cmp_lt_u32 vcc, 47, v0
  s_nop 1
  v_cndmask_b32 v50, v50, v51, vcc
  v_lshlrev_b32 v50, 6, v50
  s_nop 1
  s_mov_b64 exec, 0
  s_cmp_eq_u32 s34, 0
  s_cbranch_scc1 STUB4
  s_cmp_eq_u32 s34, 1
  s_cbranch_scc1 STUB5
  s_cmp_eq_u32 s34, 2
  s_cbranch_scc1 STUB6
  s_branch STUB7
K1_back1:
  s_mov_b64 exec, -1
  s_mov_b64 exec, 0
  s_cmp_eq_u32 s34, 0
  s_cbranch_scc1 STUB8
  s_cmp_eq_u32 s34, 1
  s_cbranch_scc1 STUB9
  s_cmp_eq_u32 s34, 2
  s_cbranch_scc1 STUB10
  s_branch STUB11
K1_back2:
  s_mov_b64 exec, -1
  s_mov_b64 exec, 0
  s_cmp_eq_u32 s34, 0
  s_cbranch_scc1 K1_back3
  s_cmp_eq_u32 s34, 1
  s_cbranch_scc1 K1_back3
  s_cmp_eq_u32 s34, 2
  s_cbranch_scc1 K1_back3
  s_branch K1_back3
K1_back3:
  s_mov_b64 exec, -1
  s_add_u32 m0, s41, 0
  s_nop 0
  buffer_load_dwordx4 v3, s[12:15], s64 offen offset:0 lds
  buffer_load_dwordx4 v3, s[12:15], s65 offen offset:1024 lds
  buffer_load_dwordx4 v3, s[12:15], s66 offen offset:2048 lds
  s_add_u32 m0, s41, 3072
  s_nop 0
  buffer_load_dwordx4 v3, s[16:19], s64 offen offset:0 lds
  buffer_load_dwordx4 v3, s[16:19], s65 offen offset:1024 lds
  buffer_load_dwordx4 v3, s[16:19], s66 offen offset:2048 lds
  s_mov_b32 s88, 6242304
  s_mov_b32 s3, 200000
K1_go:
  buffer_load_dword v51, v50, s[4:7], s88 offen sc1
  s_waitcnt vmcnt(0)
  v_cmp_eq_u32 vcc, v37, v51
  s_nop 3
  s_cmp_eq_u64 vcc, -1
  s_cbranch_scc1 K1_gook
  s_sleep 1
  s_sub_u32 s3, s3, 1
  s_cbranch_scc0 K1_go
K1_gook:
  s_add_u32 m0, s39, 65536
  s_nop 0
  buffer_load_dwordx4 v1, s[4:7], s37 offen offset:0 sc1 lds
  buffer_load_dwordx4 v1, s[4:7], s37 offen offset:1024 sc1 lds
  s_add_u32 m0, s40, 73728
  s_nop 0
  buffer_load_dwordx4 v1, s[4:7], s38 offen offset:0 sc1 lds
  buffer_load_dwordx4 v1, s[4:7], s38 offen offset:1024 sc1 lds
  buffer_load_dwordx4 v1, s[4:7], s38 offen offset:2048 sc1 lds
  s_add_u32 m0, s39, 86016
  s_add_u32 s37, s37, 8192
  buffer_load_dwordx4 v1, s[4:7], s37 offen offset:0 sc1 lds
  buffer_load_dwordx4 v1, s[4:7], s37 offen offset:1024 sc1 lds
  s_add_u32 m0, s40, 94208
  s_add_u32 s38, s38, 12288
  buffer_load_dwordx4 v1, s[4:7], s38 offen offset:0 sc1 lds
  buffer_load_dwordx4 v1, s[4:7], s38 offen offset:1024 sc1 lds
  buffer_load_dwordx4 v1, s[4:7], s38 offen offset:2048 sc1 lds
  s_add_u32 m0, s39, 106496
  s_add_u32 s37, s37, 8192
  buffer_load_dwordx4 v1, s[4:7], s37 offen offset:0 sc1 lds
  buffer_load_dwordx4 v1, s[4:7], s37 offen offset:1024 sc1 lds
  s_add_u32 m0, s40, 114688
  s_add_u32 s38, s38, 12288
  buffer_load_dwordx4 v1, s[4:7], s38 offen offset:0 sc1 lds
  buffer_load_dwordx4 v1, s[4:7], s38 offen offset:1024 sc1 lds
  buffer_load_dwordx4 v1, s[4:7], s38 offen offset:2048 sc1 lds
  v_add_u32 v4, 73728, v4
  v_add_u32 v5, 73728, v5
  v_add_u32 v30, 65536, v30
  v_add_u32 v6, 73728, v6
  v_add_u32 v7, 73728, v7
  v_add_u32 v14, 75776, v14
  s_waitcnt vmcnt(10) lgkmcnt(0)
  s_barrier
  ds_read_b64_tr_b16 v[160:161], v4 offset:0
  ds_read_b64_tr_b16 v[162:163], v4 offset:1024
  ds_read_b64_tr_b16 v[164:165], v5 offset:0
  ds_read_b64_tr_b16 v[166:167], v5 offset:1024
  ds_read_b128 a[0:3], v30 offset:0
  ds_read_b128 a[4:7], v30 offset:1024
  ds_read_b128 a[8:11], v30 offset:2048
  ds_read_b128 a[12:15], v30 offset:3072
  ds_read_b64_tr_b16 v[168:169], v6 offset:0
  ds_read_b64_tr_b16 v[170:171], v6 offset:1024
  ds_read_b64_tr_b16 v[172:173], v7 offset:0
  ds_read_b64_tr_b16 v[174:175], v7 offset:1024
  s_waitcnt lgkmcnt(7)
  v_mfma_f32_16x16x32_bf16 v[32:35], v[160:163], a[0:3], 0
  ds_read_b64_tr_b16 v[176:177], v14 offset:0
  s_add_u32 m0, s39, 24576
  v_mfma_f32_16x16x32_bf16 v[36:39], v[164:167], a[0:3], 0
  ds_read_b64_tr_b16 v[178:179], v14 offset:256
  s_add_u32 s37, s37, 8192
  s_waitcnt lgkmcnt(8)
  v_mfma_f32_16x16x32_bf16 v[48:51], v[160:163], a[4:7], 0
  ds_read_b64_tr_b16 v[180:181], v14 offset:6144
  s_mov_b32 s58, 0
  v_mfma_f32_16x16x32_bf16 v[52:55], v[164:167], a[4:7], 0
  ds_read_b64_tr_b16 v[182:183], v14 offset:6400
  s_mov_b32 s59, 0xffff0000
  s_waitcnt lgkmcnt(9)
  v_mfma_f32_16x16x32_bf16 v[64:67], v[160:163], a[8:11], 0
  buffer_load_dwordx4 v1, s[4:7], s37 offen offset:0 sc1 lds
  v_mfma_f32_16x16x32_bf16 v[68:71], v[164:167], a[8:11], 0
  buffer_load_dwordx4 v1, s[4:7], s37 offen offset:1024 sc1 lds
  s_waitcnt lgkmcnt(8)
  v_mfma_f32_16x16x32_bf16 v[80:83], v[160:163], a[12:15], 0
  s_add_u32 m0, s40, 32768
  s_add_u32 s38, s38, 12288
  s_mov_b32 s50, 0x3fb8aa3b
  v_mfma_f32_16x16x32_bf16 v[84:87], v[164:167], a[12:15], 0
  s_waitcnt vmcnt(7) lgkmcnt(0)
  s_barrier
  v_mfma_f32_16x16x32_bf16 v[40:43], v[168:171], a[0:3], 0
  ds_read_b64_tr_b16 v[160:161], v4 offset:20480
  v_mov_b32 v223, 0x3f803f80
  v_mfma_f32_16x16x32_bf16 v[44:47], v[172:175], a[0:3], 0
  ds_read_b64_tr_b16 v[162:163], v4 offset:21504
  s_lshl_b32 s42, s35, 12
  v_mfma_f32_16x16x32_bf16 v[56:59], v[168:171], a[4:7], 0
  buffer_load_dwordx4 v1, s[4:7], s38 offen offset:0 sc1 lds
  v_mfma_f32_16x16x32_bf16 v[60:63], v[172:175], a[4:7], 0
  ds_read_b64_tr_b16 v[164:165], v5 offset:20480
  s_add_u32 s42, s42, 73728
  v_mfma_f32_16x16x32_bf16 v[72:75], v[168:171], a[8:11], 0
  ds_read_b64_tr_b16 v[166:167], v5 offset:21504
  v_add_u32 v15, s42, v1
  v_mfma_f32_16x16x32_bf16 v[76:79], v[172:175], a[8:11], 0
  ds_read_b128 a[16:19], v30 offset:20480
  s_lshl_b32 s42, s36, 3
  v_mfma_f32_16x16x32_bf16 v[88:91], v[168:171], a[12:15], 0
  buffer_load_dwordx4 v1, s[4:7], s38 offen offset:1024 sc1 lds
  v_mfma_f32_16x16x32_bf16 v[92:95], v[172:175], a[12:15], 0
  ds_read_b128 a[20:23], v30 offset:21504
  v_add_u32 v16, s42, v15
  v_mfma_f32_16x16x32_bf16 v[128:131], v[176:179], a[0:3], 0
  ds_read_b128 a[24:27], v30 offset:22528
  v_and_b32 v184, 15, v0
  v_mfma_f32_16x16x32_bf16 v[144:147], v[180:183], a[0:3], 0
  ds_read_b128 a[28:31], v30 offset:23552
  v_lshrrev_b32 v185, 4, v0
  v_mfma_f32_16x16x32_bf16 v[132:135], v[176:179], a[4:7], 0
  buffer_load_dwordx4 v1, s[4:7], s38 offen offset:2048 sc1 lds
  v_mfma_f32_16x16x32_bf16 v[148:151], v[180:183], a[4:7], 0
  ds_read_b64_tr_b16 v[168:169], v6 offset:20480
  s_add_u32 m0, s39, 45056
  v_mfma_f32_16x16x32_bf16 v[136:139], v[176:179], a[8:11], 0
  ds_read_b64_tr_b16 v[170:171], v6 offset:21504
  s_add_u32 s37, s37, 8192
  v_mfma_f32_16x16x32_bf16 v[152:155], v[180:183], a[8:11], 0
  ds_read_b64_tr_b16 v[172:173], v7 offset:20480
  s_mul_i32 s42, s36, 20480
  v_mfma_f32_16x16x32_bf16 v[140:143], v[176:179], a[12:15], 0
  buffer_load_dwordx4 v1, s[4:7], s37 offen offset:0 sc1 lds
  v_mfma_f32_16x16x32_bf16 v[156:159], v[180:183], a[12:15], 0
  ds_read_b64_tr_b16 v[174:175], v7 offset:21504
  s_waitcnt lgkmcnt(4)
  v_mfma_f32_16x16x32_bf16 v[32:35], v[160:163], a[16:19], v[32:35]
  ds_read_b64_tr_b16 v[176:177], v14 offset:20480
  s_add_u32 s42, s42, 98304
  v_mfma_f32_16x16x32_bf16 v[36:39], v[164:167], a[16:19], v[36:39]
  ds_read_b64_tr_b16 v[178:179], v14 offset:20736
  s_mul_i32 s43, s35, 10240
  v_mfma_f32_16x16x32_bf16 v[48:51], v[160:163], a[20:23], v[48:51]
  ds_read_b64_tr_b16 v[180:181], v14 offset:26624
  s_add_u32 s43, s43, s42
  v_mfma_f32_16x16x32_bf16 v[52:55], v[164:167], a[20:23], v[52:55]
  ds_read_b64_tr_b16 v[182:183], v14 offset:26880
  v_mul_u32_u24 v186, 160, v184
  v_mfma_f32_16x16x32_bf16 v[64:67], v[160:163], a[24:27], v[64:67]
  buffer_load_dwordx4 v1, s[4:7], s37 offen offset:1024 sc1 lds
  v_mfma_f32_16x16x32_bf16 v[68:71], v[164:167], a[24:27], v[68:71]
  s_add_u32 m0, s40, 53248
  s_add_u32 s38, s38, 12288
  v_add_u32 v186, s43, v186
  v_mfma_f32_16x16x32_bf16 v[80:83], v[160:163], a[28:31], v[80:83]
  buffer_load_dwordx4 v1, s[4:7], s38 offen offset:0 sc1 lds
  v_mfma_f32_16x16x32_bf16 v[84:87], v[164:167], a[28:31], v[84:87]
  s_waitcnt vmcnt(8) lgkmcnt(0)
  s_barrier
  v_mfma_f32_16x16x32_bf16 v[40:43], v[168:171], a[16:19], v[40:43]
  ds_read_b64_tr_b16 v[160:161], v4 offset:40960
  v_lshl_add_u32 v17, v185, 3, v186
  v_mfma_f32_16x16x32_bf16 v[44:47], v[172:175], a[16:19], v[44:47]
  ds_read_b64_tr_b16 v[162:163], v4 offset:41984
  v_subrev_u32 v4, 40960, v4
  v_mfma_f32_16x16x32_bf16 v[56:59], v[168:171], a[20:23], v[56:59]
  buffer_load_dwordx4 v1, s[4:7], s38 offen offset:1024 sc1 lds
  v_mfma_f32_16x16x32_bf16 v[60:63], v[172:175], a[20:23], v[60:63]
  ds_read_b64_tr_b16 v[164:165], v5 offset:40960
  v_and_b32 v187, 1, v185
  v_mfma_f32_16x16x32_bf16 v[72:75], v[168:171], a[24:27], v[72:75]
  ds_read_b64_tr_b16 v[166:167], v5 offset:41984
  v_subrev_u32 v5, 40960, v5
  v_mfma_f32_16x16x32_bf16 v[76:79], v[172:175], a[24:27], v[76:79]
  ds_read_b128 a[32:35], v30 offset:40960
  v_mul_u32_u24 v187, 48, v187
  v_mfma_f32_16x16x32_bf16 v[88:91], v[168:171], a[28:31], v[88:91]
  buffer_load_dwordx4 v1, s[4:7], s38 offen offset:2048 sc1 lds
  v_mfma_f32_16x16x32_bf16 v[92:95], v[172:175], a[28:31], v[92:95]
  ds_read_b128 a[36:39], v30 offset:41984
  s_add_u32 m0, s39, 65536
  v_mfma_f32_16x16x32_bf16 v[128:131], v[176:179], a[16:19], v[128:131]
  ds_read_b128 a[40:43], v30 offset:43008
  s_add_u32 s37, s37, 8192
  v_mfma_f32_16x16x32_bf16 v[144:147], v[180:183], a[16:19], v[144:147]
  ds_read_b128 a[44:47], v30 offset:44032
  v_subrev_u32 v30, 40960, v30
  v_mfma_f32_16x16x32_bf16 v[132:135], v[176:179], a[20:23], v[132:135]
  buffer_load_dwordx4 v1, s[4:7], s37 offen offset:0 sc1 lds
  v_mfma_f32_16x16x32_bf16 v[148:151], v[180:183], a[20:23], v[148:151]
  ds_read_b64_tr_b16 v[168:169], v6 offset:40960
  v_add_u32 v187, v187, v186
  v_mfma_f32_16x16x32_bf16 v[136:139], v[176:179], a[24:27], v[136:139]
  ds_read_b64_tr_b16 v[170:171], v6 offset:41984
  v_subrev_u32 v6, 40960, v6
  v_mfma_f32_16x16x32_bf16 v[152:155], v[180:183], a[24:27], v[152:155]
  ds_read_b64_tr_b16 v[172:173], v7 offset:40960
  v_lshrrev_b32 v188, 1, v185
  v_mfma_f32_16x16x32_bf16 v[140:143], v[176:179], a[28:31], v[140:143]
  buffer_load_dwordx4 v1, s[4:7], s37 offen offset:1024 sc1 lds
  v_mfma_f32_16x16x32_bf16 v[156:159], v[180:183], a[28:31], v[156:159]
  ds_read_b64_tr_b16 v[174:175], v7 offset:41984
  v_subrev_u32 v7, 40960, v7
  s_waitcnt lgkmcnt(4)
  v_mfma_f32_16x16x32_bf16 v[32:35], v[160:163], a[32:35], v[32:35]
  ds_read_b64_tr_b16 v[176:177], v14 offset:40960
  s_add_u32 m0, s40, 73728
  v_mfma_f32_16x16x32_bf16 v[36:39], v[164:167], a[32:35], v[36:39]
  ds_read_b64_tr_b16 v[178:179], v14 offset:41216
  s_add_u32 s38, s38, 12288
  v_mfma_f32_16x16x32_bf16 v[48:51], v[160:163], a[36:39], v[48:51]
  ds_read_b64_tr_b16 v[180:181], v14 offset:47104
  v_mul_u32_u24 v188, 2560, v188
  v_mfma_f32_16x16x32_bf16 v[52:55], v[164:167], a[36:39], v[52:55]
  ds_read_b64_tr_b16 v[182:183], v14 offset:47360
  v_subrev_u32 v14, 40960, v14
  v_mfma_f32_16x16x32_bf16 v[64:67], v[160:163], a[40:43], v[64:67]
  buffer_load_dwordx4 v1, s[4:7], s38 offen offset:0 sc1 lds
  v_mfma_f32_16x16x32_bf16 v[68:71], v[164:167], a[40:43], v[68:71]
  buffer_load_dwordx4 v1, s[4:7], s38 offen offset:1024 sc1 lds
  v_mfma_f32_16x16x32_bf16 v[80:83], v[160:163], a[44:47], v[80:83]
  s_cmp_eq_u32 s35, 0
  s_cselect_b64 vcc, -1, 0
  v_add_u32 v18, v187, v188
  v_mfma_f32_16x16x32_bf16 v[84:87], v[164:167], a[44:47], v[84:87]
  s_waitcnt vmcnt(9) lgkmcnt(0)
  s_barrier
  v_mfma_f32_16x16x32_bf16 v[40:43], v[168:171], a[32:35], v[40:43]
  ds_read_b64_tr_b16 v[160:161], v4 offset:0
  v_bfe_u32 v186, v0, 2, 4
  v_mfma_f32_16x16x32_bf16 v[44:47], v[172:175], a[32:35], v[44:47]
  ds_read_b64_tr_b16 v[162:163], v4 offset:1024
  v_mul_u32_u24 v186, 160, v186
  v_mfma_f32_16x16x32_bf16 v[56:59], v[168:171], a[36:39], v[56:59]
  buffer_load_dwordx4 v1, s[4:7], s38 offen offset:2048 sc1 lds
  v_mfma_f32_16x16x32_bf16 v[60:63], v[172:175], a[36:39], v[60:63]
  ds_read_b64_tr_b16 v[164:165], v5 offset:0
  s_add_u32 m0, s39, 86016
  v_mfma_f32_16x16x32_bf16 v[72:75], v[168:171], a[40:43], v[72:75]
  ds_read_b64_tr_b16 v[166:167], v5 offset:1024
  s_add_u32 s37, s37, 8192
  v_mfma_f32_16x16x32_bf16 v[76:79], v[172:175], a[40:43], v[76:79]
  ds_read_b128 a[48:51], v30 offset:0
  v_add_u32 v186, s42, v186
  v_mfma_f32_16x16x32_bf16 v[88:91], v[168:171], a[44:47], v[88:91]
  buffer_load_dwordx4 v1, s[4:7], s37 offen offset:0 sc1 lds
  v_mfma_f32_16x16x32_bf16 v[92:95], v[172:175], a[44:47], v[92:95]
  ds_read_b128 a[52:55], v30 offset:1024
  v_and_b32 v187, 3, v0
  v_mfma_f32_16x16x32_bf16 v[128:131], v[176:179], a[32:35], v[128:131]
  ds_read_b128 a[56:59], v30 offset:2048
  v_lshl_add_u32 v19, v187, 3, v186
  v_mfma_f32_16x16x32_bf16 v[144:147], v[180:183], a[32:35], v[144:147]
  ds_read_b128 a[60:63], v30 offset:3072
  v_and_b32 v188, 1, v0
  v_mfma_f32_16x16x32_bf16 v[132:135], v[176:179], a[36:39], v[132:135]
  buffer_load_dwordx4 v1, s[4:7], s37 offen offset:1024 sc1 lds
  v_mfma_f32_16x16x32_bf16 v[148:151], v[180:183], a[36:39], v[148:151]
  ds_read_b64_tr_b16 v[168:169], v6 offset:0
  s_add_u32 m0, s40, 94208
  v_mfma_f32_16x16x32_bf16 v[136:139], v[176:179], a[40:43], v[136:139]
  ds_read_b64_tr_b16 v[170:171], v6 offset:1024
  s_add_u32 s38, s38, 12288
  v_mfma_f32_16x16x32_bf16 v[152:155], v[180:183], a[40:43], v[152:155]
  ds_read_b64_tr_b16 v[172:173], v7 offset:0
  v_mul_u32_u24 v190, 48, v188
  v_mfma_f32_16x16x32_bf16 v[140:143], v[176:179], a[44:47], v[140:143]
  buffer_load_dwordx4 v1, s[4:7], s38 offen offset:0 sc1 lds
  v_mfma_f32_16x16x32_bf16 v[156:159], v[180:183], a[44:47], v[156:159]
  ds_read_b64_tr_b16 v[174:175], v7 offset:1024
  s_waitcnt lgkmcnt(4)
  v_mfma_f32_16x16x32_bf16 v[32:35], v[160:163], a[48:51], v[32:35]
  ds_read_b64_tr_b16 v[176:177], v14 offset:0
  v_add_u32 v20, v190, v186
  v_mfma_f32_16x16x32_bf16 v[36:39], v[164:167], a[48:51], v[36:39]
  ds_read_b64_tr_b16 v[178:179], v14 offset:256
  v_lshlrev_b32 v188, 3, v188
  v_mfma_f32_16x16x32_bf16 v[48:51], v[160:163], a[52:55], v[48:51]
  ds_read_b64_tr_b16 v[180:181], v14 offset:6144
  v_add_u32 v188, 48, v188
  v_mfma_f32_16x16x32_bf16 v[52:55], v[164:167], a[52:55], v[52:55]
  ds_read_b64_tr_b16 v[182:183], v14 offset:6400
  v_lshlrev_b32 v187, 3, v187
  v_mfma_f32_16x16x32_bf16 v[64:67], v[160:163], a[56:59], v[64:67]
  buffer_load_dwordx4 v1, s[4:7], s38 offen offset:1024 sc1 lds
  v_mfma_f32_16x16x32_bf16 v[68:71], v[164:167], a[56:59], v[68:71]
  buffer_load_dwordx4 v1, s[4:7], s38 offen offset:2048 sc1 lds
  v_mfma_f32_16x16x32_bf16 v[80:83], v[160:163], a[60:63], v[80:83]
  s_add_u32 m0, s39, 106496
  s_add_u32 s37, s37, 8192
  v_cndmask_b32 v188, v188, v187, vcc
  v_mfma_f32_16x16x32_bf16 v[84:87], v[164:167], a[60:63], v[84:87]
  s_waitcnt vmcnt(10) lgkmcnt(0)
  s_barrier
  v_mfma_f32_16x16x32_bf16 v[40:43], v[168:171], a[48:51], v[40:43]
  ds_read_b64_tr_b16 v[160:161], v4 offset:20480
  v_add_u32 v21, v188, v186
  v_mfma_f32_16x16x32_bf16 v[44:47], v[172:175], a[48:51], v[44:47]
  ds_read_b64_tr_b16 v[162:163], v4 offset:21504
  s_mul_i32 s42, s36, 10240
  v_mfma_f32_16x16x32_bf16 v[56:59], v[168:171], a[52:55], v[56:59]
  buffer_load_dwordx4 v1, s[4:7], s37 offen offset:0 sc1 lds
  v_mfma_f32_16x16x32_bf16 v[60:63], v[172:175], a[52:55], v[60:63]
  ds_read_b64_tr_b16 v[164:165], v5 offset:20480
  s_add_u32 s42, s42, 143360
  v_mfma_f32_16x16x32_bf16 v[72:75], v[168:171], a[56:59], v[72:75]
  ds_read_b64_tr_b16 v[166:167], v5 offset:21504
  v_add_u32 v27, s42, v1
  v_mfma_f32_16x16x32_bf16 v[76:79], v[172:175], a[56:59], v[76:79]
  ds_read_b128 a[64:67], v30 offset:20480
  v_xor_b32 v2, 128, v27
  v_mfma_f32_16x16x32_bf16 v[88:91], v[168:171], a[60:63], v[88:91]
  buffer_load_dwordx4 v1, s[4:7], s37 offen offset:1024 sc1 lds
  v_mfma_f32_16x16x32_bf16 v[92:95], v[172:175], a[60:63], v[92:95]
  ds_read_b128 a[68:71], v30 offset:21504
  s_add_u32 m0, s40, 114688
  v_mfma_f32_16x16x32_bf16 v[128:131], v[176:179], a[48:51], v[128:131]
  ds_read_b128 a[72:75], v30 offset:22528
  s_add_u32 s38, s38, 12288
  v_mfma_f32_16x16x32_bf16 v[144:147], v[180:183], a[48:51], v[144:147]
  ds_read_b128 a[76:79], v30 offset:23552
  s_lshl_b32 s42, s36, 1
  v_mfma_f32_16x16x32_bf16 v[132:135], v[176:179], a[52:55], v[132:135]
  buffer_load_dwordx4 v1, s[4:7], s38 offen offset:0 sc1 lds
  v_mfma_f32_16x16x32_bf16 v[148:151], v[180:183], a[52:55], v[148:151]
  ds_read_b64_tr_b16 v[168:169], v6 offset:20480
  v_add_u32 v186, s42, v184
  v_mfma_f32_16x16x32_bf16 v[136:139], v[176:179], a[56:59], v[136:139]
  ds_read_b64_tr_b16 v[170:171], v6 offset:21504
  v_subrev_u32 v187, s42, v184
  v_mfma_f32_16x16x32_bf16 v[152:155], v[180:183], a[56:59], v[152:155]
  ds_read_b64_tr_b16 v[172:173], v7 offset:20480
STUB1:
  s_cbranch_execz K1_back0
  v_cmp_gt_u32 vcc, 2, v187
  v_mfma_f32_16x16x32_bf16 v[140:143], v[176:179], a[60:63], v[140:143]
  buffer_load_dwordx4 v1, s[4:7], s38 offen offset:1024 sc1 lds
  v_mfma_f32_16x16x32_bf16 v[156:159], v[180:183], a[60:63], v[156:159]
  ds_read_b64_tr_b16 v[174:175], v7 offset:21504
  s_waitcnt lgkmcnt(4)
  v_mfma_f32_16x16x32_bf16 v[32:35], v[160:163], a[64:67], v[32:35]
  ds_read_b64_tr_b16 v[176:177], v14 offset:20480
  s_xor_b32 s43, s36, 1
  v_mfma_f32_16x16x32_bf16 v[36:39], v[164:167], a[64:67], v[36:39]
  ds_read_b64_tr_b16 v[178:179], v14 offset:20736
  s_lshl_b32 s43, s43, 4
  v_mfma_f32_16x16x32_bf16 v[48:51], v[160:163], a[68:71], v[48:51]
  ds_read_b64_tr_b16 v[180:181], v14 offset:26624
  v_add_u32 v187, s43, v187
  v_mfma_f32_16x16x32_bf16 v[52:55], v[164:167], a[68:71], v[52:55]
  ds_read_b64_tr_b16 v[182:183], v14 offset:26880
  v_mov_b32 v188, 0x400000
  v_mfma_f32_16x16x32_bf16 v[64:67], v[160:163], a[72:75], v[64:67]
  buffer_load_dwordx4 v1, s[4:7], s38 offen offset:2048 sc1 lds
  v_mfma_f32_16x16x32_bf16 v[68:71], v[164:167], a[72:75], v[68:71]
  s_add_u32 m0, s39, 24576
  s_add_u32 s37, s37, 8192
  v_cndmask_b32 v187, v188, v187, vcc
  v_mfma_f32_16x16x32_bf16 v[80:83], v[160:163], a[76:79], v[80:83]
  buffer_load_dwordx4 v1, s[4:7], s37 offen offset:0 sc1 lds
  v_mfma_f32_16x16x32_bf16 v[84:87], v[164:167], a[76:79], v[84:87]
  s_waitcnt vmcnt(11) lgkmcnt(0)
  s_barrier
  v_mfma_f32_16x16x32_bf16 v[40:43], v[168:171], a[64:67], v[40:43]
  ds_read_b64_tr_b16 v[160:161], v4 offset:40960
  v_cmp_eq_u32 vcc, 4, v184
  v_mfma_f32_16x16x32_bf16 v[44:47], v[172:175], a[64:67], v[44:47]
  ds_read_b64_tr_b16 v[162:163], v4 offset:41984
  v_cndmask_b32 v187, v187, 18, vcc
  v_mfma_f32_16x16x32_bf16 v[56:59], v[168:171], a[68:71], v[56:59]
  buffer_load_dwordx4 v1, s[4:7], s37 offen offset:1024 sc1 lds
  v_mfma_f32_16x16x32_bf16 v[60:63], v[172:175], a[68:71], v[60:63]
  ds_read_b64_tr_b16 v[164:165], v5 offset:40960
  s_add_u32 m0, s40, 32768
  v_mfma_f32_16x16x32_bf16 v[72:75], v[168:171], a[72:75], v[72:75]
  ds_read_b64_tr_b16 v[166:167], v5 offset:41984
  s_add_u32 s38, s38, 12288
  v_mfma_f32_16x16x32_bf16 v[76:79], v[172:175], a[72:75], v[76:79]
  ds_read_b128 a[80:83], v30 offset:40960
  v_and_b32 v188, 1, v185
  v_mfma_f32_16x16x32_bf16 v[88:91], v[168:171], a[76:79], v[88:91]
  buffer_load_dwordx4 v1, s[4:7], s38 offen offset:0 sc1 lds
  v_mfma_f32_16x16x32_bf16 v[92:95], v[172:175], a[76:79], v[92:95]
  ds_read_b128 a[84:87], v30 offset:41984
  v_mul_u32_u24 v188, 48, v188
  v_mfma_f32_16x16x32_bf16 v[128:131], v[176:179], a[64:67], v[128:131]
  ds_read_b128 a[88:91], v30 offset:43008
  s_lshl_b32 s51, s33, 1
  v_mfma_f32_16x16x32_bf16 v[144:147], v[180:183], a[64:67], v[144:147]
  ds_read_b128 a[92:95], v30 offset:44032
  s_add_u32 s51, s51, s36
  v_mfma_f32_16x16x32_bf16 v[132:135], v[176:179], a[68:71], v[132:135]
  buffer_load_dwordx4 v1, s[4:7], s38 offen offset:1024 sc1 lds
  v_mfma_f32_16x16x32_bf16 v[148:151], v[180:183], a[68:71], v[148:151]
  ds_read_b64_tr_b16 v[168:169], v6 offset:40960
  s_lshl_b32 s51, s51, 15
  v_mfma_f32_16x16x32_bf16 v[136:139], v[176:179], a[72:75], v[136:139]
  ds_read_b64_tr_b16 v[170:171], v6 offset:41984
  s_add_u32 s51, s51, 6258688
  v_mfma_f32_16x16x32_bf16 v[152:155], v[180:183], a[72:75], v[152:155]
  ds_read_b64_tr_b16 v[172:173], v7 offset:40960
  s_lshl_b32 s52, s32, 11
  v_mfma_f32_16x16x32_bf16 v[140:143], v[176:179], a[76:79], v[140:143]
  buffer_load_dwordx4 v1, s[4:7], s38 offen offset:2048 sc1 lds
  v_mfma_f32_16x16x32_bf16 v[156:159], v[180:183], a[76:79], v[156:159]
  ds_read_b64_tr_b16 v[174:175], v7 offset:41984
  s_add_u32 m0, s39, 45056
  s_waitcnt lgkmcnt(4)
  v_mfma_f32_16x16x32_bf16 v[32:35], v[160:163], a[80:83], v[32:35]
  ds_read_b64_tr_b16 v[176:177], v14 offset:40960
  s_add_u32 s37, s37, 8192
  v_mfma_f32_16x16x32_bf16 v[36:39], v[164:167], a[80:83], v[36:39]
  ds_read_b64_tr_b16 v[178:179], v14 offset:41216
  s_add_u32 s52, s52, s51
  v_mfma_f32_16x16x32_bf16 v[48:51], v[160:163], a[84:87], v[48:51]
  ds_read_b64_tr_b16 v[180:181], v14 offset:47104
  s_lshl_b32 s53, s33, 8
  v_mfma_f32_16x16x32_bf16 v[52:55], v[164:167], a[84:87], v[52:55]
  ds_read_b64_tr_b16 v[182:183], v14 offset:47360
  s_add_u32 s53, s53, 6225920
  v_mfma_f32_16x16x32_bf16 v[64:67], v[160:163], a[88:91], v[64:67]
  buffer_load_dwordx4 v1, s[4:7], s37 offen offset:0 sc1 lds
  v_mfma_f32_16x16x32_bf16 v[68:71], v[164:167], a[88:91], v[68:71]
  buffer_load_dwordx4 v1, s[4:7], s37 offen offset:1024 sc1 lds
  v_mfma_f32_16x16x32_bf16 v[80:83], v[160:163], a[92:95], v[80:83]
  s_add_u32 m0, s40, 53248
  s_add_u32 s38, s38, 12288
  s_lshl_b32 s54, s32, 2
  v_mfma_f32_16x16x32_bf16 v[84:87], v[164:167], a[92:95], v[84:87]
  s_waitcnt vmcnt(12) lgkmcnt(0)
  s_barrier
  v_mfma_f32_16x16x32_bf16 v[40:43], v[168:171], a[80:83], v[40:43]
  ds_read_b64_tr_b16 v[160:161], v4 offset:61440
  s_add_u32 s54, s54, s53
  v_mfma_f32_16x16x32_bf16 v[44:47], v[172:175], a[80:83], v[44:47]
  ds_read_b64_tr_b16 v[162:163], v4 offset:62464
  v_add_u32 v4, 81920, v4
  v_mfma_f32_16x16x32_bf16 v[56:59], v[168:171], a[84:87], v[56:59]
  buffer_load_dwordx4 v1, s[4:7], s38 offen offset:0 sc1 lds
  v_mfma_f32_16x16x32_bf16 v[60:63], v[172:175], a[84:87], v[60:63]
  ds_read_b64_tr_b16 v[164:165], v5 offset:61440
  s_lshl_b32 s42, s35, 10
  v_mfma_f32_16x16x32_bf16 v[72:75], v[168:171], a[88:91], v[72:75]
  ds_read_b64_tr_b16 v[166:167], v5 offset:62464
  v_add_u32 v5, 81920, v5
  v_mfma_f32_16x16x32_bf16 v[76:79], v[172:175], a[88:91], v[76:79]
  ds_read_b128 a[96:99], v30 offset:61440
  v_mov_b32 v189, 1824
  v_mfma_f32_16x16x32_bf16 v[88:91], v[168:171], a[92:95], v[88:91]
  buffer_load_dwordx4 v1, s[4:7], s38 offen offset:1024 sc1 lds
  v_mfma_f32_16x16x32_bf16 v[92:95], v[172:175], a[92:95], v[92:95]
  ds_read_b128 a[100:103], v30 offset:62464
  v_mfma_f32_16x16x32_bf16 v[128:131], v[176:179], a[80:83], v[128:131]
  ds_read_b128 a[104:107], v30 offset:63488
  v_mfma_f32_16x16x32_bf16 v[144:147], v[180:183], a[80:83], v[144:147]
  ds_read_b128 a[108:111], v30 offset:64512
  v_add_u32 v30, 81920, v30
  v_mfma_f32_16x16x32_bf16 v[132:135], v[176:179], a[84:87], v[132:135]
  buffer_load_dwordx4 v1, s[4:7], s38 offen offset:2048 sc1 lds
  v_mfma_f32_16x16x32_bf16 v[148:151], v[180:183], a[84:87], v[148:151]
  ds_read_b64_tr_b16 v[168:169], v6 offset:61440
  s_add_u32 m0, s39, 65536
  v_mfma_f32_16x16x32_bf16 v[136:139], v[176:179], a[88:91], v[136:139]
  ds_read_b64_tr_b16 v[170:171], v6 offset:62464
  v_add_u32 v6, 81920, v6
  v_mfma_f32_16x16x32_bf16 v[152:155], v[180:183], a[88:91], v[152:155]
  ds_read_b64_tr_b16 v[172:173], v7 offset:61440
  s_add_u32 s37, s37, 8192
  v_mfma_f32_16x16x32_bf16 v[140:143], v[176:179], a[92:95], v[140:143]
  buffer_load_dwordx4 v1, s[4:7], s37 offen offset:0 sc1 lds
  v_mfma_f32_16x16x32_bf16 v[156:159], v[180:183], a[92:95], v[156:159]
  ds_read_b64_tr_b16 v[174:175], v7 offset:62464
  v_add_u32 v7, 81920, v7
  s_waitcnt lgkmcnt(4)
  v_mfma_f32_16x16x32_bf16 v[32:35], v[160:163], a[96:99], v[32:35]
  ds_read_b64_tr_b16 v[176:177], v14 offset:61440
  v_mfma_f32_16x16x32_bf16 v[36:39], v[164:167], a[96:99], v[36:39]
  ds_read_b64_tr_b16 v[178:179], v14 offset:61696
  v_add_u32 v14, 67584, v14
  v_mfma_f32_16x16x32_bf16 v[48:51], v[160:163], a[100:103], v[48:51]
  ds_read_b64_tr_b16 v[180:181], v14 offset:0
  v_mfma_f32_16x16x32_bf16 v[52:55], v[164:167], a[100:103], v[52:55]
  ds_read_b64_tr_b16 v[182:183], v14 offset:256
  v_mfma_f32_16x16x32_bf16 v[64:67], v[160:163], a[104:107], v[64:67]
  buffer_load_dwordx4 v1, s[4:7], s37 offen offset:1024 sc1 lds
  v_mfma_f32_16x16x32_bf16 v[68:71], v[164:167], a[104:107], v[68:71]
  s_add_u32 m0, s40, 73728
  s_add_u32 s38, s38, 12288
  v_mfma_f32_16x16x32_bf16 v[80:83], v[160:163], a[108:111], v[80:83]
  buffer_load_dwordx4 v1, s[4:7], s38 offen offset:0 sc1 lds
  v_mfma_f32_16x16x32_bf16 v[84:87], v[164:167], a[108:111], v[84:87]
  s_waitcnt vmcnt(13) lgkmcnt(0)
  s_barrier
  v_mfma_f32_16x16x32_bf16 v[40:43], v[168:171], a[96:99], v[40:43]
  ds_read_b64_tr_b16 v[160:161], v4 offset:0
  v_mfma_f32_16x16x32_bf16 v[44:47], v[172:175], a[96:99], v[44:47]
  ds_read_b64_tr_b16 v[162:163], v4 offset:1024
  v_subrev_u32 v4, 81920, v4
  v_mfma_f32_16x16x32_bf16 v[56:59], v[168:171], a[100:103], v[56:59]
  buffer_load_dwordx4 v1, s[4:7], s38 offen offset:1024 sc1 lds
  v_mfma_f32_16x16x32_bf16 v[60:63], v[172:175], a[100:103], v[60:63]
  ds_read_b64_tr_b16 v[164:165], v5 offset:0
  v_mfma_f32_16x16x32_bf16 v[72:75], v[168:171], a[104:107], v[72:75]
  ds_read_b64_tr_b16 v[166:167], v5 offset:1024
  v_subrev_u32 v5, 81920, v5
  v_mfma_f32_16x16x32_bf16 v[76:79], v[172:175], a[104:107], v[76:79]
  ds_read_b128 a[112:115], v30 offset:0
  v_mfma_f32_16x16x32_bf16 v[88:91], v[168:171], a[108:111], v[88:91]
  buffer_load_dwordx4 v1, s[4:7], s38 offen offset:2048 sc1 lds
  v_mfma_f32_16x16x32_bf16 v[92:95], v[172:175], a[108:111], v[92:95]
  ds_read_b128 a[116:119], v30 offset:1024
  s_add_u32 m0, s39, 86016
  v_mfma_f32_16x16x32_bf16 v[128:131], v[176:179], a[96:99], v[128:131]
  ds_read_b128 a[120:123], v30 offset:2048
  s_add_u32 s37, s37, 8192
  v_mfma_f32_16x16x32_bf16 v[144:147], v[180:183], a[96:99], v[144:147]
  ds_read_b128 a[124:127], v30 offset:3072
  v_subrev_u32 v30, 81920, v30
  v_mfma_f32_16x16x32_bf16 v[132:135], v[176:179], a[100:103], v[132:135]
  buffer_load_dwordx4 v1, s[4:7], s37 offen offset:0 sc1 lds
  v_mfma_f32_16x16x32_bf16 v[148:151], v[180:183], a[100:103], v[148:151]
  ds_read_b64_tr_b16 v[168:169], v6 offset:0
  v_mfma_f32_16x16x32_bf16 v[136:139], v[176:179], a[104:107], v[136:139]
  ds_read_b64_tr_b16 v[170:171], v6 offset:1024
  v_subrev_u32 v6, 81920, v6
  v_mfma_f32_16x16x32_bf16 v[152:155], v[180:183], a[104:107], v[152:155]
  ds_read_b64_tr_b16 v[172:173], v7 offset:0
  v_mfma_f32_16x16x32_bf16 v[140:143], v[176:179], a[108:111], v[140:143]
  buffer_load_dwordx4 v1, s[4:7], s37 offen offset:1024 sc1 lds
  v_mfma_f32_16x16x32_bf16 v[156:159], v[180:183], a[108:111], v[156:159]
  ds_read_b64_tr_b16 v[174:175], v7 offset:1024
  v_subrev_u32 v7, 81920, v7
  s_waitcnt lgkmcnt(4)
  v_mfma_f32_16x16x32_bf16 v[32:35], v[160:163], a[112:115], v[32:35]
  ds_read_b64_tr_b16 v[176:177], v14 offset:14336
  s_add_u32 m0, s40, 94208
  v_mfma_f32_16x16x32_bf16 v[36:39], v[164:167], a[112:115], v[36:39]
  ds_read_b64_tr_b16 v[178:179], v14 offset:14592
  s_add_u32 s38, s38, 12288
  v_mfma_f32_16x16x32_bf16 v[48:51], v[160:163], a[116:119], v[48:51]
  ds_read_b64_tr_b16 v[180:181], v14 offset:20480
  v_mfma_f32_16x16x32_bf16 v[52:55], v[164:167], a[116:119], v[52:55]
  ds_read_b64_tr_b16 v[182:183], v14 offset:20736
  v_subrev_u32 v14, 67584, v14
  v_mfma_f32_16x16x32_bf16 v[64:67], v[160:163], a[120:123], v[64:67]
  buffer_load_dwordx4 v1, s[4:7], s38 offen offset:0 sc1 lds
  v_mfma_f32_16x16x32_bf16 v[68:71], v[164:167], a[120:123], v[68:71]
  buffer_load_dwordx4 v1, s[4:7], s38 offen offset:1024 sc1 lds
  v_mfma_f32_16x16x32_bf16 v[80:83], v[160:163], a[124:127], v[80:83]
  s_cmp_eq_u32 s35, 0
  s_cselect_b64 vcc, -1, 0
  v_cndmask_b32 v186, v187, v186, vcc
  v_mfma_f32_16x16x32_bf16 v[84:87], v[164:167], a[124:127], v[84:87]
  s_waitcnt vmcnt(14) lgkmcnt(0)
  s_barrier
  v_mfma_f32_16x16x32_bf16 v[40:43], v[168:171], a[112:115], v[40:43]
  ds_read_b64_tr_b16 v[160:161], v4 offset:0
  v_mul_u32_u24 v186, 96, v186
  v_mfma_f32_16x16x32_bf16 v[44:47], v[172:175], a[112:115], v[44:47]
  ds_read_b64_tr_b16 v[162:163], v4 offset:1024
  v_lshl_add_u32 v22, v185, 3, v186
  v_mfma_f32_16x16x32_bf16 v[56:59], v[168:171], a[116:119], v[56:59]
  buffer_load_dwordx4 v1, s[4:7], s38 offen offset:2048 sc1 lds
  v_mfma_f32_16x16x32_bf16 v[60:63], v[172:175], a[116:119], v[60:63]
  ds_read_b64_tr_b16 v[164:165], v5 offset:0
  s_add_u32 m0, s39, 106496
  v_mfma_f32_16x16x32_bf16 v[72:75], v[168:171], a[120:123], v[72:75]
  ds_read_b64_tr_b16 v[166:167], v5 offset:1024
  s_add_u32 s37, s37, 8192
  v_mfma_f32_16x16x32_bf16 v[76:79], v[172:175], a[120:123], v[76:79]
  ds_read_b128 a[128:131], v30 offset:0
  v_add_u32 v188, v188, v186
  v_mfma_f32_16x16x32_bf16 v[88:91], v[168:171], a[124:127], v[88:91]
  buffer_load_dwordx4 v1, s[4:7], s37 offen offset:0 sc1 lds
  v_mfma_f32_16x16x32_bf16 v[92:95], v[172:175], a[124:127], v[92:95]
  ds_read_b128 a[132:135], v30 offset:1024
  v_lshrrev_b32 v187, 1, v185
  v_mfma_f32_16x16x32_bf16 v[128:131], v[176:179], a[112:115], v[128:131]
  ds_read_b128 a[136:139], v30 offset:2048
  v_lshlrev_b32 v187, 3, v187
  v_mfma_f32_16x16x32_bf16 v[144:147], v[180:183], a[112:115], v[144:147]
  ds_read_b128 a[140:143], v30 offset:3072
  v_sub_u32 v23, v188, v187
  v_mfma_f32_16x16x32_bf16 v[132:135], v[176:179], a[116:119], v[132:135]
  buffer_load_dwordx4 v1, s[4:7], s37 offen offset:1024 sc1 lds
  v_mfma_f32_16x16x32_bf16 v[148:151], v[180:183], a[116:119], v[148:151]
  ds_read_b64_tr_b16 v[168:169], v6 offset:0
  s_add_u32 m0, s40, 114688
  v_mfma_f32_16x16x32_bf16 v[136:139], v[176:179], a[120:123], v[136:139]
  ds_read_b64_tr_b16 v[170:171], v6 offset:1024
  s_add_u32 s38, s38, 12288
  v_mfma_f32_16x16x32_bf16 v[152:155], v[180:183], a[120:123], v[152:155]
  ds_read_b64_tr_b16 v[172:173], v7 offset:0
  v_add_u32 v23, 40, v23
  v_mfma_f32_16x16x32_bf16 v[140:143], v[176:179], a[124:127], v[140:143]
  buffer_load_dwordx4 v1, s[4:7], s38 offen offset:0 sc1 lds
  v_mfma_f32_16x16x32_bf16 v[156:159], v[180:183], a[124:127], v[156:159]
  ds_read_b64_tr_b16 v[174:175], v7 offset:1024
  s_waitcnt lgkmcnt(4)
  v_mfma_f32_16x16x32_bf16 v[32:35], v[160:163], a[128:131], v[32:35]
  ds_read_b64_tr_b16 v[176:177], v14 offset:0
  v_lshlrev_b32 v186, 4, v184
  v_mfma_f32_16x16x32_bf16 v[36:39], v[164:167], a[128:131], v[36:39]
  ds_read_b64_tr_b16 v[178:179], v14 offset:256
  v_lshl_add_u32 v186, v185, 11, v186
  v_mfma_f32_16x16x32_bf16 v[48:51], v[160:163], a[132:135], v[48:51]
  ds_read_b64_tr_b16 v[180:181], v14 offset:6144
  v_add_u32 v24, s42, v186
  v_mfma_f32_16x16x32_bf16 v[52:55], v[164:167], a[132:135], v[52:55]
  ds_read_b64_tr_b16 v[182:183], v14 offset:6400
  s_lshl_b32 s42, s36, 11
  v_mfma_f32_16x16x32_bf16 v[64:67], v[160:163], a[136:139], v[64:67]
  buffer_load_dwordx4 v1, s[4:7], s38 offen offset:1024 sc1 lds
  v_mfma_f32_16x16x32_bf16 v[68:71], v[164:167], a[136:139], v[68:71]
  buffer_load_dwordx4 v1, s[4:7], s38 offen offset:2048 sc1 lds
  v_mfma_f32_16x16x32_bf16 v[80:83], v[160:163], a[140:143], v[80:83]
  s_add_u32 s42, s42, 98304
  v_and_b32 v186, 1, v185
  v_mul_u32_u24 v186, 48, v186
  v_mfma_f32_16x16x32_bf16 v[84:87], v[164:167], a[140:143], v[84:87]
  s_waitcnt vmcnt(15) lgkmcnt(0)
  s_barrier
  v_mfma_f32_16x16x32_bf16 v[40:43], v[168:171], a[128:131], v[40:43]
  ds_read_b64_tr_b16 v[160:161], v4 offset:20480
  s_add_u32 m0, s39, 24576
  v_mfma_f32_16x16x32_bf16 v[44:47], v[172:175], a[128:131], v[44:47]
  ds_read_b64_tr_b16 v[162:163], v4 offset:21504
  s_add_u32 s37, s37, 8192
  v_mfma_f32_16x16x32_bf16 v[56:59], v[168:171], a[132:135], v[56:59]
  buffer_load_dwordx4 v1, s[4:7], s37 offen offset:0 sc1 lds
  v_mfma_f32_16x16x32_bf16 v[60:63], v[172:175], a[132:135], v[60:63]
  ds_read_b64_tr_b16 v[164:165], v5 offset:20480
  v_mul_u32_u24 v187, 96, v184
  v_mfma_f32_16x16x32_bf16 v[72:75], v[168:171], a[136:139], v[72:75]
  ds_read_b64_tr_b16 v[166:167], v5 offset:21504
  v_add_u32 v187, v187, v186
  v_mfma_f32_16x16x32_bf16 v[76:79], v[172:175], a[136:139], v[76:79]
  ds_read_b128 a[144:147], v30 offset:20480
  v_add_u32 v188, 1536, v187
  v_mfma_f32_16x16x32_bf16 v[88:91], v[168:171], a[140:143], v[88:91]
  buffer_load_dwordx4 v1, s[4:7], s37 offen offset:1024 sc1 lds
  v_mfma_f32_16x16x32_bf16 v[92:95], v[172:175], a[140:143], v[92:95]
  ds_read_b128 a[148:151], v30 offset:21504
  s_add_u32 m0, s40, 32768
  v_mfma_f32_16x16x32_bf16 v[128:131], v[176:179], a[128:131], v[128:131]
  ds_read_b128 a[152:155], v30 offset:22528
  s_add_u32 s38, s38, 12288
  v_mfma_f32_16x16x32_bf16 v[144:147], v[180:183], a[128:131], v[144:147]
  ds_read_b128 a[156:159], v30 offset:23552
  v_cmp_gt_u32 vcc, 2, v184
  v_mfma_f32_16x16x32_bf16 v[132:135], v[176:179], a[132:135], v[132:135]
  buffer_load_dwordx4 v1, s[4:7], s38 offen offset:0 sc1 lds
  v_mfma_f32_16x16x32_bf16 v[148:151], v[180:183], a[132:135], v[148:151]
  ds_read_b64_tr_b16 v[168:169], v6 offset:20480
  v_cndmask_b32 v188, v189, v188, vcc
  v_mfma_f32_16x16x32_bf16 v[136:139], v[176:179], a[136:139], v[136:139]
  ds_read_b64_tr_b16 v[170:171], v6 offset:21504
  v_add_u32 v186, 1728, v186
  v_mfma_f32_16x16x32_bf16 v[152:155], v[180:183], a[136:139], v[152:155]
  ds_read_b64_tr_b16 v[172:173], v7 offset:20480
  v_and_b32 v184, 3, v184
  v_mfma_f32_16x16x32_bf16 v[140:143], v[176:179], a[140:143], v[140:143]
  buffer_load_dwordx4 v1, s[4:7], s38 offen offset:1024 sc1 lds
  v_mfma_f32_16x16x32_bf16 v[156:159], v[180:183], a[140:143], v[156:159]
  ds_read_b64_tr_b16 v[174:175], v7 offset:21504
  s_waitcnt lgkmcnt(4)
  v_mfma_f32_16x16x32_bf16 v[32:35], v[160:163], a[144:147], v[32:35]
  ds_read_b64_tr_b16 v[176:177], v14 offset:20480
  v_cmp_eq_u32 vcc, 3, v184
  v_mfma_f32_16x16x32_bf16 v[36:39], v[164:167], a[144:147], v[36:39]
  ds_read_b64_tr_b16 v[178:179], v14 offset:20736
  v_cndmask_b32 v188, v188, v186, vcc
  v_mfma_f32_16x16x32_bf16 v[48:51], v[160:163], a[148:151], v[48:51]
  ds_read_b64_tr_b16 v[180:181], v14 offset:26624
  v_add_u32 v25, s42, v187
  v_mfma_f32_16x16x32_bf16 v[52:55], v[164:167], a[148:151], v[52:55]
  ds_read_b64_tr_b16 v[182:183], v14 offset:26880
  v_add_u32 v26, s42, v188
  v_mfma_f32_16x16x32_bf16 v[64:67], v[160:163], a[152:155], v[64:67]
  buffer_load_dwordx4 v1, s[4:7], s38 offen offset:2048 sc1 lds
  v_mfma_f32_16x16x32_bf16 v[68:71], v[164:167], a[152:155], v[68:71]
  s_mul_i32 s98, s33, 331776
  s_mul_i32 s99, s33, 41472
  s_and_b32 s43, s33, 1
  v_mfma_f32_16x16x32_bf16 v[80:83], v[160:163], a[156:159], v[80:83]
  s_mul_i32 s42, s43, 36864
  s_add_u32 s42, s42, s98
  s_xor_b32 s43, s43, 1
  v_mfma_f32_16x16x32_bf16 v[84:87], v[164:167], a[156:159], v[84:87]
  s_waitcnt vmcnt(15) lgkmcnt(0)
  s_barrier
  v_mfma_f32_16x16x32_bf16 v[40:43], v[168:171], a[144:147], v[40:43]
  ds_read_b64_tr_b16 v[160:161], v4 offset:40960
  s_add_u32 m0, s39, 45056
  v_mfma_f32_16x16x32_bf16 v[44:47], v[172:175], a[144:147], v[44:47]
  ds_read_b64_tr_b16 v[162:163], v4 offset:41984
  s_add_u32 s37, s37, 8192
  v_mfma_f32_16x16x32_bf16 v[56:59], v[168:171], a[148:151], v[56:59]
  buffer_load_dwordx4 v1, s[4:7], s37 offen offset:0 sc1 lds
  v_mfma_f32_16x16x32_bf16 v[60:63], v[172:175], a[148:151], v[60:63]
  ds_read_b64_tr_b16 v[164:165], v5 offset:40960
  s_mul_i32 s43, s43, 294912
  v_mfma_f32_16x16x32_bf16 v[72:75], v[168:171], a[152:155], v[72:75]
  ds_read_b64_tr_b16 v[166:167], v5 offset:41984
  s_add_u32 s84, s42, 0
  v_mfma_f32_16x16x32_bf16 v[76:79], v[172:175], a[152:155], v[76:79]
  ds_read_b128 a[160:163], v30 offset:40960
  s_add_u32 s85, s98, s43
  v_mfma_f32_16x16x32_bf16 v[88:91], v[168:171], a[156:159], v[88:91]
  buffer_load_dwordx4 v1, s[4:7], s37 offen offset:1024 sc1 lds
  v_mfma_f32_16x16x32_bf16 v[92:95], v[172:175], a[156:159], v[92:95]
  ds_read_b128 a[164:167], v30 offset:41984
  s_add_u32 m0, s40, 53248
  v_mfma_f32_16x16x32_bf16 v[128:131], v[176:179], a[144:147], v[128:131]
  ds_read_b128 a[168:171], v30 offset:43008
  s_add_u32 s38, s38, 12288
  v_mfma_f32_16x16x32_bf16 v[144:147], v[180:183], a[144:147], v[144:147]
  ds_read_b128 a[172:175], v30 offset:44032
  s_sub_u32 s85, s85, 1024
  v_mfma_f32_16x16x32_bf16 v[132:135], v[176:179], a[148:151], v[132:135]
  buffer_load_dwordx4 v1, s[4:7], s38 offen offset:0 sc1 lds
  v_mfma_f32_16x16x32_bf16 v[148:151], v[180:183], a[148:151], v[148:151]
  ds_read_b64_tr_b16 v[168:169], v6 offset:40960
  s_add_u32 s86, s42, 34816
  v_mfma_f32_16x16x32_bf16 v[136:139], v[176:179], a[152:155], v[136:139]
  ds_read_b64_tr_b16 v[170:171], v6 offset:41984
  s_add_u32 s87, s42, 73728
  v_mfma_f32_16x16x32_bf16 v[152:155], v[180:183], a[152:155], v[152:155]
  ds_read_b64_tr_b16 v[172:173], v7 offset:40960
  s_add_u32 s88, s42, 109568
  v_mfma_f32_16x16x32_bf16 v[140:143], v[176:179], a[156:159], v[140:143]
  buffer_load_dwordx4 v1, s[4:7], s38 offen offset:1024 sc1 lds
  v_mfma_f32_16x16x32_bf16 v[156:159], v[180:183], a[156:159], v[156:159]
  ds_read_b64_tr_b16 v[174:175], v7 offset:41984
  s_waitcnt lgkmcnt(4)
  v_mfma_f32_16x16x32_bf16 v[32:35], v[160:163], a[160:163], v[32:35]
  ds_read_b64_tr_b16 v[176:177], v14 offset:40960
  s_add_u32 s89, s42, 145408
  v_mfma_f32_16x16x32_bf16 v[36:39], v[164:167], a[160:163], v[36:39]
  ds_read_b64_tr_b16 v[178:179], v14 offset:41216
  s_add_u32 s99, s99, 4096
  v_mfma_f32_16x16x32_bf16 v[48:51], v[160:163], a[164:167], v[48:51]
  ds_read_b64_tr_b16 v[180:181], v14 offset:47104
  s_mul_i32 s90, s35, 2304
  v_mfma_f32_16x16x32_bf16 v[52:55], v[164:167], a[164:167], v[52:55]
  ds_read_b64_tr_b16 v[182:183], v14 offset:47360
  s_add_u32 s90, s90, s99
  v_mfma_f32_16x16x32_bf16 v[64:67], v[160:163], a[168:171], v[64:67]
  buffer_load_dwordx4 v1, s[4:7], s38 offen offset:2048 sc1 lds
  v_mfma_f32_16x16x32_bf16 v[68:71], v[164:167], a[168:171], v[68:71]
  s_add_u32 s92, s42, 182272
  s_add_u32 s93, s42, 221184
  s_add_u32 s94, s42, 257024
  v_mfma_f32_16x16x32_bf16 v[80:83], v[160:163], a[172:175], v[80:83]
  s_and_b32 s43, s33, 1
  s_lshr_b32 s44, s33, 1
  s_lshl_b32 s42, s32, 1
  v_mfma_f32_16x16x32_bf16 v[84:87], v[164:167], a[172:175], v[84:87]
  s_waitcnt vmcnt(15) lgkmcnt(0)
  s_barrier
  v_mfma_f32_16x16x32_bf16 v[40:43], v[168:171], a[160:163], v[40:43]
  ds_read_b64_tr_b16 v[160:161], v4 offset:61440
  s_add_u32 m0, s39, 65536
  v_mfma_f32_16x16x32_bf16 v[44:47], v[172:175], a[160:163], v[44:47]
  ds_read_b64_tr_b16 v[162:163], v4 offset:62464
  v_add_u32 v4, 81920, v4
  v_mfma_f32_16x16x32_bf16 v[56:59], v[168:171], a[164:167], v[56:59]
  s_add_u32 s37, s37, 8192
  s_add_u32 s42, s42, s43
  s_mul_i32 s47, s42, 655360
  v_mfma_f32_16x16x32_bf16 v[60:63], v[172:175], a[164:167], v[60:63]
  ds_read_b64_tr_b16 v[164:165], v5 offset:61440
  s_add_u32 s47, s47, 8355840
  v_mfma_f32_16x16x32_bf16 v[72:75], v[168:171], a[168:171], v[72:75]
  ds_read_b64_tr_b16 v[166:167], v5 offset:62464
  v_add_u32 v5, 81920, v5
  v_mfma_f32_16x16x32_bf16 v[76:79], v[172:175], a[168:171], v[76:79]
  ds_read_b128 a[176:179], v30 offset:61440
  s_lshl_b32 s45, s44, 11
  v_mfma_f32_16x16x32_bf16 v[88:91], v[168:171], a[172:175], v[88:91]
  buffer_load_dwordx4 v1, s[4:7], s37 offen offset:0 sc1 lds
  v_mfma_f32_16x16x32_bf16 v[92:95], v[172:175], a[172:175], v[92:95]
  ds_read_b128 a[180:183], v30 offset:62464
  s_add_u32 s46, s47, s45
  v_mfma_f32_16x16x32_bf16 v[128:131], v[176:179], a[160:163], v[128:131]
  ds_read_b128 a[184:187], v30 offset:63488
  s_lshl_b32 s45, s35, 16
  v_mfma_f32_16x16x32_bf16 v[144:147], v[180:183], a[160:163], v[144:147]
  ds_read_b128 a[188:191], v30 offset:64512
  v_add_u32 v30, 81920, v30
  v_mfma_f32_16x16x32_bf16 v[132:135], v[176:179], a[164:167], v[132:135]
  buffer_load_dwordx4 v1, s[4:7], s37 offen offset:1024 sc1 lds
  v_mfma_f32_16x16x32_bf16 v[148:151], v[180:183], a[164:167], v[148:151]
  ds_read_b64_tr_b16 v[168:169], v6 offset:61440
  s_add_u32 m0, s40, 73728
  v_mfma_f32_16x16x32_bf16 v[136:139], v[176:179], a[168:171], v[136:139]
  ds_read_b64_tr_b16 v[170:171], v6 offset:62464
  v_add_u32 v6, 81920, v6
  v_mfma_f32_16x16x32_bf16 v[152:155], v[180:183], a[168:171], v[152:155]
  ds_read_b64_tr_b16 v[172:173], v7 offset:61440
  s_add_u32 s38, s38, 12288
  v_mfma_f32_16x16x32_bf16 v[140:143], v[176:179], a[172:175], v[140:143]
  buffer_load_dwordx4 v1, s[4:7], s38 offen offset:0 sc1 lds
  v_mfma_f32_16x16x32_bf16 v[156:159], v[180:183], a[172:175], v[156:159]
  ds_read_b64_tr_b16 v[174:175], v7 offset:62464
  v_add_u32 v7, 81920, v7
  s_waitcnt lgkmcnt(4)
  v_mfma_f32_16x16x32_bf16 v[32:35], v[160:163], a[176:179], v[32:35]
  ds_read_b64_tr_b16 v[176:177], v14 offset:61440
  s_add_u32 s46, s46, s45
  v_mfma_f32_16x16x32_bf16 v[36:39], v[164:167], a[176:179], v[36:39]
  ds_read_b64_tr_b16 v[178:179], v14 offset:61696
  v_add_u32 v14, 67584, v14
  v_mfma_f32_16x16x32_bf16 v[48:51], v[160:163], a[180:183], v[48:51]
  ds_read_b64_tr_b16 v[180:181], v14 offset:0
  s_lshl_b32 s45, s44, 14
  v_mfma_f32_16x16x32_bf16 v[52:55], v[164:167], a[180:183], v[52:55]
  ds_read_b64_tr_b16 v[182:183], v14 offset:256
  s_add_u32 s47, s47, s45
  v_mfma_f32_16x16x32_bf16 v[64:67], v[160:163], a[184:187], v[64:67]
  buffer_load_dwordx4 v1, s[4:7], s38 offen offset:1024 sc1 lds
  v_mfma_f32_16x16x32_bf16 v[68:71], v[164:167], a[184:187], v[68:71]
  buffer_load_dwordx4 v1, s[4:7], s38 offen offset:2048 sc1 lds
  v_mfma_f32_16x16x32_bf16 v[80:83], v[160:163], a[188:191], v[80:83]
  s_lshl_b32 s48, s32, 3
  s_add_u32 s48, s48, s44
  s_mul_i32 s48, s48, 18432
  v_mfma_f32_16x16x32_bf16 v[84:87], v[164:167], a[188:191], v[84:87]
  s_waitcnt vmcnt(15) lgkmcnt(0)
  s_barrier
  v_mfma_f32_16x16x32_bf16 v[40:43], v[168:171], a[176:179], v[40:43]
  ds_read_b64_tr_b16 v[160:161], v4 offset:0
  s_add_u32 m0, s39, 86016
  v_mfma_f32_16x16x32_bf16 v[44:47], v[172:175], a[176:179], v[44:47]
  ds_read_b64_tr_b16 v[162:163], v4 offset:1024
  v_subrev_u32 v4, 81920, v4
  v_mfma_f32_16x16x32_bf16 v[56:59], v[168:171], a[180:183], v[56:59]
  s_add_u32 s37, s37, 8192
  s_lshl_b32 s55, s42, 7
  s_add_u32 s55, s55, 6230016
  v_mfma_f32_16x16x32_bf16 v[60:63], v[172:175], a[180:183], v[60:63]
  ds_read_b64_tr_b16 v[164:165], v5 offset:0
  s_lshl_b32 s56, s44, 2
  v_mfma_f32_16x16x32_bf16 v[72:75], v[168:171], a[184:187], v[72:75]
  ds_read_b64_tr_b16 v[166:167], v5 offset:1024
  v_subrev_u32 v5, 81920, v5
  v_mfma_f32_16x16x32_bf16 v[76:79], v[172:175], a[184:187], v[76:79]
  ds_read_b128 a[192:195], v30 offset:0
  s_add_u32 s56, s56, s55
  v_mfma_f32_16x16x32_bf16 v[88:91], v[168:171], a[188:191], v[88:91]
  buffer_load_dwordx4 v1, s[4:7], s37 offen offset:0 sc1 lds
  v_mfma_f32_16x16x32_bf16 v[92:95], v[172:175], a[188:191], v[92:95]
  ds_read_b128 a[196:199], v30 offset:1024
  s_lshl_b32 s42, s32, 4
  v_mfma_f32_16x16x32_bf16 v[128:131], v[176:179], a[176:179], v[128:131]
  ds_read_b128 a[200:203], v30 offset:2048
  s_add_u32 s42, s42, s33
  v_mfma_f32_16x16x32_bf16 v[144:147], v[180:183], a[176:179], v[144:147]
  ds_read_b128 a[204:207], v30 offset:3072
  v_subrev_u32 v30, 81920, v30
  v_mfma_f32_16x16x32_bf16 v[132:135], v[176:179], a[180:183], v[132:135]
  buffer_load_dwordx4 v1, s[4:7], s37 offen offset:1024 sc1 lds
  v_mfma_f32_16x16x32_bf16 v[148:151], v[180:183], a[180:183], v[148:151]
  ds_read_b64_tr_b16 v[168:169], v6 offset:0
  s_add_u32 m0, s40, 94208
  v_mfma_f32_16x16x32_bf16 v[136:139], v[176:179], a[184:187], v[136:139]
  ds_read_b64_tr_b16 v[170:171], v6 offset:1024
  v_subrev_u32 v6, 81920, v6
  v_mfma_f32_16x16x32_bf16 v[152:155], v[180:183], a[184:187], v[152:155]
  ds_read_b64_tr_b16 v[172:173], v7 offset:0
  s_add_u32 s38, s38, 12288
  v_mfma_f32_16x16x32_bf16 v[140:143], v[176:179], a[188:191], v[140:143]
  buffer_load_dwordx4 v1, s[4:7], s38 offen offset:0 sc1 lds
  v_mfma_f32_16x16x32_bf16 v[156:159], v[180:183], a[188:191], v[156:159]
  ds_read_b64_tr_b16 v[174:175], v7 offset:1024
  v_subrev_u32 v7, 81920, v7
  s_waitcnt lgkmcnt(4)
  v_mfma_f32_16x16x32_bf16 v[32:35], v[160:163], a[192:195], v[32:35]
  ds_read_b64_tr_b16 v[176:177], v14 offset:14336
  s_mul_i32 s100, s42, 90112
  v_mfma_f32_16x16x32_bf16 v[36:39], v[164:167], a[192:195], v[36:39]
  ds_read_b64_tr_b16 v[178:179], v14 offset:14592
  s_add_u32 s100, s100, s39
  v_mfma_f32_16x16x32_bf16 v[48:51], v[160:163], a[196:199], v[48:51]
  ds_read_b64_tr_b16 v[180:181], v14 offset:20480
  s_add_u32 s100, s100, 29327360
  v_mfma_f32_16x16x32_bf16 v[52:55], v[164:167], a[196:199], v[52:55]
  ds_read_b64_tr_b16 v[182:183], v14 offset:20736
  v_subrev_u32 v14, 67584, v14
STUB2:
  s_cbranch_execz K1_back0
  v_mfma_f32_16x16x32_bf16 v[64:67], v[160:163], a[200:203], v[64:67]
  buffer_load_dwordx4 v1, s[4:7], s38 offen offset:1024 sc1 lds
  v_mfma_f32_16x16x32_bf16 v[68:71], v[164:167], a[200:203], v[68:71]
  buffer_load_dwordx4 v1, s[4:7], s38 offen offset:2048 sc1 lds
  v_mfma_f32_16x16x32_bf16 v[80:83], v[160:163], a[204:207], v[80:83]
  s_lshl_b32 s101, s42, 4
  s_add_u32 s101, s101, 6234112
  v_mfma_f32_16x16x32_bf16 v[84:87], v[164:167], a[204:207], v[84:87]
  s_waitcnt vmcnt(15) lgkmcnt(0)
  s_barrier
  v_mfma_f32_16x16x32_bf16 v[40:43], v[168:171], a[192:195], v[40:43]
  ds_read_b64_tr_b16 v[160:161], v4 offset:0
  s_add_u32 m0, s39, 106496
  v_mfma_f32_16x16x32_bf16 v[44:47], v[172:175], a[192:195], v[44:47]
  ds_read_b64_tr_b16 v[162:163], v4 offset:1024
  s_add_u32 s37, s37, 8192
  v_mfma_f32_16x16x32_bf16 v[56:59], v[168:171], a[196:199], v[56:59]
  buffer_load_dwordx4 v1, s[4:7], s37 offen offset:0 sc1 lds
  v_mfma_f32_16x16x32_bf16 v[60:63], v[172:175], a[196:199], v[60:63]
  ds_read_b64_tr_b16 v[164:165], v5 offset:0
  v_mfma_f32_16x16x32_bf16 v[72:75], v[168:171], a[200:203], v[72:75]
  ds_read_b64_tr_b16 v[166:167], v5 offset:1024
  v_mfma_f32_16x16x32_bf16 v[76:79], v[172:175], a[200:203], v[76:79]
  ds_read_b128 a[208:211], v30 offset:0
  v_mfma_f32_16x16x32_bf16 v[88:91], v[168:171], a[204:207], v[88:91]
  buffer_load_dwordx4 v1, s[4:7], s37 offen offset:1024 sc1 lds
  v_mfma_f32_16x16x32_bf16 v[92:95], v[172:175], a[204:207], v[92:95]
  ds_read_b128 a[212:215], v30 offset:1024
  s_add_u32 m0, s40, 114688
  v_mfma_f32_16x16x32_bf16 v[128:131], v[176:179], a[192:195], v[128:131]
  ds_read_b128 a[216:219], v30 offset:2048
  s_add_u32 s38, s38, 12288
  v_mfma_f32_16x16x32_bf16 v[144:147], v[180:183], a[192:195], v[144:147]
  ds_read_b128 a[220:223], v30 offset:3072
  v_mfma_f32_16x16x32_bf16 v[132:135], v[176:179], a[196:199], v[132:135]
  buffer_load_dwordx4 v1, s[4:7], s38 offen offset:0 sc1 lds
  v_mfma_f32_16x16x32_bf16 v[148:151], v[180:183], a[196:199], v[148:151]
  ds_read_b64_tr_b16 v[168:169], v6 offset:0
  v_mfma_f32_16x16x32_bf16 v[136:139], v[176:179], a[200:203], v[136:139]
  ds_read_b64_tr_b16 v[170:171], v6 offset:1024
  v_mfma_f32_16x16x32_bf16 v[152:155], v[180:183], a[200:203], v[152:155]
  ds_read_b64_tr_b16 v[172:173], v7 offset:0
  v_mfma_f32_16x16x32_bf16 v[140:143], v[176:179], a[204:207], v[140:143]
  buffer_load_dwordx4 v1, s[4:7], s38 offen offset:1024 sc1 lds
  v_mfma_f32_16x16x32_bf16 v[156:159], v[180:183], a[204:207], v[156:159]
  ds_read_b64_tr_b16 v[174:175], v7 offset:1024
  s_waitcnt lgkmcnt(4)
  v_mfma_f32_16x16x32_bf16 v[32:35], v[160:163], a[208:211], v[32:35]
  ds_read_b64_tr_b16 v[176:177], v14 offset:0
  v_mfma_f32_16x16x32_bf16 v[36:39], v[164:167], a[208:211], v[36:39]
  ds_read_b64_tr_b16 v[178:179], v14 offset:256
  v_mfma_f32_16x16x32_bf16 v[48:51], v[160:163], a[212:215], v[48:51]
  ds_read_b64_tr_b16 v[180:181], v14 offset:6144
  v_mfma_f32_16x16x32_bf16 v[52:55], v[164:167], a[212:215], v[52:55]
  ds_read_b64_tr_b16 v[182:183], v14 offset:6400
  v_mfma_f32_16x16x32_bf16 v[64:67], v[160:163], a[216:219], v[64:67]
  buffer_load_dwordx4 v1, s[4:7], s38 offen offset:2048 sc1 lds
  v_mfma_f32_16x16x32_bf16 v[68:71], v[164:167], a[216:219], v[68:71]
  v_mfma_f32_16x16x32_bf16 v[80:83], v[160:163], a[220:223], v[80:83]
  v_mfma_f32_16x16x32_bf16 v[84:87], v[164:167], a[220:223], v[84:87]
  s_waitcnt vmcnt(15) lgkmcnt(0)
  s_barrier
  v_mfma_f32_16x16x32_bf16 v[40:43], v[168:171], a[208:211], v[40:43]
  ds_read_b64_tr_b16 v[160:161], v4 offset:20480
  v_mfma_f32_16x16x32_bf16 v[44:47], v[172:175], a[208:211], v[44:47]
  ds_read_b64_tr_b16 v[162:163], v4 offset:21504
  v_mfma_f32_16x16x32_bf16 v[56:59], v[168:171], a[212:215], v[56:59]
  v_mfma_f32_16x16x32_bf16 v[60:63], v[172:175], a[212:215], v[60:63]
  ds_read_b64_tr_b16 v[164:165], v5 offset:20480
  v_mfma_f32_16x16x32_bf16 v[72:75], v[168:171], a[216:219], v[72:75]
  ds_read_b64_tr_b16 v[166:167], v5 offset:21504
  v_mfma_f32_16x16x32_bf16 v[76:79], v[172:175], a[216:219], v[76:79]
  ds_read_b128 a[224:227], v30 offset:20480
  v_mfma_f32_16x16x32_bf16 v[88:91], v[168:171], a[220:223], v[88:91]
  v_mfma_f32_16x16x32_bf16 v[92:95], v[172:175], a[220:223], v[92:95]
  ds_read_b128 a[228:231], v30 offset:21504
  v_mfma_f32_16x16x32_bf16 v[128:131], v[176:179], a[208:211], v[128:131]
  ds_read_b128 a[232:235], v30 offset:22528
  v_mfma_f32_16x16x32_bf16 v[144:147], v[180:183], a[208:211], v[144:147]
  ds_read_b128 a[236:239], v30 offset:23552
  v_mfma_f32_16x16x32_bf16 v[132:135], v[176:179], a[212:215], v[132:135]
  v_mfma_f32_16x16x32_bf16 v[148:151], v[180:183], a[212:215], v[148:151]
  ds_read_b64_tr_b16 v[168:169], v6 offset:20480
  v_mfma_f32_16x16x32_bf16 v[136:139], v[176:179], a[216:219], v[136:139]
  ds_read_b64_tr_b16 v[170:171], v6 offset:21504
  v_mfma_f32_16x16x32_bf16 v[152:155], v[180:183], a[216:219], v[152:155]
  ds_read_b64_tr_b16 v[172:173], v7 offset:20480
  v_mfma_f32_16x16x32_bf16 v[140:143], v[176:179], a[220:223], v[140:143]
  v_mfma_f32_16x16x32_bf16 v[156:159], v[180:183], a[220:223], v[156:159]
  ds_read_b64_tr_b16 v[174:175], v7 offset:21504
  s_waitcnt lgkmcnt(4)
  v_mfma_f32_16x16x32_bf16 v[32:35], v[160:163], a[224:227], v[32:35]
  ds_read_b64_tr_b16 v[176:177], v14 offset:20480
  v_mfma_f32_16x16x32_bf16 v[36:39], v[164:167], a[224:227], v[36:39]
  ds_read_b64_tr_b16 v[178:179], v14 offset:20736
  v_mfma_f32_16x16x32_bf16 v[48:51], v[160:163], a[228:231], v[48:51]
  ds_read_b64_tr_b16 v[180:181], v14 offset:26624
  v_mfma_f32_16x16x32_bf16 v[52:55], v[164:167], a[228:231], v[52:55]
  ds_read_b64_tr_b16 v[182:183], v14 offset:26880
  v_mfma_f32_16x16x32_bf16 v[64:67], v[160:163], a[232:235], v[64:67]
  v_mfma_f32_16x16x32_bf16 v[68:71], v[164:167], a[232:235], v[68:71]
  v_mfma_f32_16x16x32_bf16 v[80:83], v[160:163], a[236:239], v[80:83]
  v_mfma_f32_16x16x32_bf16 v[84:87], v[164:167], a[236:239], v[84:87]
  s_waitcnt vmcnt(10) lgkmcnt(0)
  s_barrier
  v_mfma_f32_16x16x32_bf16 v[40:43], v[168:171], a[224:227], v[40:43]
  ds_read_b64_tr_b16 v[160:161], v4 offset:40960
  s_add_u32 m0, s41, 24576
  v_mfma_f32_16x16x32_bf16 v[44:47], v[172:175], a[224:227], v[44:47]
  ds_read_b64_tr_b16 v[162:163], v4 offset:41984
  v_mfma_f32_16x16x32_bf16 v[56:59], v[168:171], a[228:231], v[56:59]
  buffer_load_dwordx4 v3, s[12:15], s67 offen offset:0 lds
  v_mfma_f32_16x16x32_bf16 v[60:63], v[172:175], a[228:231], v[60:63]
  ds_read_b64_tr_b16 v[164:165], v5 offset:40960
  v_mfma_f32_16x16x32_bf16 v[72:75], v[168:171], a[232:235], v[72:75]
  ds_read_b64_tr_b16 v[166:167], v5 offset:41984
  v_mfma_f32_16x16x32_bf16 v[76:79], v[172:175], a[232:235], v[76:79]
  ds_read_b128 a[240:243], v30 offset:40960
  v_mfma_f32_16x16x32_bf16 v[88:91], v[168:171], a[236:239], v[88:91]
  buffer_load_dwordx4 v3, s[12:15], s68 offen offset:1024 lds
  v_mfma_f32_16x16x32_bf16 v[92:95], v[172:175], a[236:239], v[92:95]
  ds_read_b128 a[244:247], v30 offset:41984
  v_mfma_f32_16x16x32_bf16 v[128:131], v[176:179], a[224:227], v[128:131]
  ds_read_b128 a[248:251], v30 offset:43008
  v_mfma_f32_16x16x32_bf16 v[144:147], v[180:183], a[224:227], v[144:147]
  ds_read_b128 a[252:255], v30 offset:44032
  v_mfma_f32_16x16x32_bf16 v[132:135], v[176:179], a[228:231], v[132:135]
  buffer_load_dwordx4 v3, s[12:15], s69 offen offset:2048 lds
  v_mfma_f32_16x16x32_bf16 v[148:151], v[180:183], a[228:231], v[148:151]
  ds_read_b64_tr_b16 v[168:169], v6 offset:40960
  s_add_u32 m0, s41, 27648
  v_mfma_f32_16x16x32_bf16 v[136:139], v[176:179], a[232:235], v[136:139]
  ds_read_b64_tr_b16 v[170:171], v6 offset:41984
  v_mfma_f32_16x16x32_bf16 v[152:155], v[180:183], a[232:235], v[152:155]
  ds_read_b64_tr_b16 v[172:173], v7 offset:40960
  v_mfma_f32_16x16x32_bf16 v[140:143], v[176:179], a[236:239], v[140:143]
  buffer_load_dwordx4 v3, s[16:19], s67 offen offset:0 lds
  v_mfma_f32_16x16x32_bf16 v[156:159], v[180:183], a[236:239], v[156:159]
  ds_read_b64_tr_b16 v[174:175], v7 offset:41984
  s_waitcnt lgkmcnt(4)
  v_mfma_f32_16x16x32_bf16 v[32:35], v[160:163], a[240:243], v[32:35]
  ds_read_b64_tr_b16 v[176:177], v14 offset:40960
  v_mfma_f32_16x16x32_bf16 v[36:39], v[164:167], a[240:243], v[36:39]
  ds_read_b64_tr_b16 v[178:179], v14 offset:41216
  v_mfma_f32_16x16x32_bf16 v[48:51], v[160:163], a[244:247], v[48:51]
  ds_read_b64_tr_b16 v[180:181], v14 offset:47104
  v_mfma_f32_16x16x32_bf16 v[52:55], v[164:167], a[244:247], v[52:55]
  ds_read_b64_tr_b16 v[182:183], v14 offset:47360
  v_mfma_f32_16x16x32_bf16 v[64:67], v[160:163], a[248:251], v[64:67]
  buffer_load_dwordx4 v3, s[16:19], s68 offen offset:1024 lds
  v_mfma_f32_16x16x32_bf16 v[68:71], v[164:167], a[248:251], v[68:71]
  buffer_load_dwordx4 v3, s[16:19], s69 offen offset:2048 lds
  v_mfma_f32_16x16x32_bf16 v[80:83], v[160:163], a[252:255], v[80:83]
  v_mfma_f32_16x16x32_bf16 v[84:87], v[164:167], a[252:255], v[84:87]
  s_waitcnt vmcnt(11) lgkmcnt(0)
  s_barrier
  v_mfma_f32_16x16x32_bf16 v[40:43], v[168:171], a[240:243], v[40:43]
  ds_read_b64_tr_b16 v[160:161], v4 offset:61440
  s_add_u32 m0, s41, 49152
  v_mfma_f32_16x16x32_bf16 v[44:47], v[172:175], a[240:243], v[44:47]
  ds_read_b64_tr_b16 v[162:163], v4 offset:62464
  v_add_u32 v4, 81920, v4
  v_mfma_f32_16x16x32_bf16 v[56:59], v[168:171], a[244:247], v[56:59]
  buffer_load_dwordx4 v3, s[12:15], s70 offen offset:0 lds
  v_mfma_f32_16x16x32_bf16 v[60:63], v[172:175], a[244:247], v[60:63]
  ds_read_b64_tr_b16 v[164:165], v5 offset:61440
  v_mfma_f32_16x16x32_bf16 v[72:75], v[168:171], a[248:251], v[72:75]
  ds_read_b64_tr_b16 v[166:167], v5 offset:62464
  v_add_u32 v5, 81920, v5
  v_mfma_f32_16x16x32_bf16 v[76:79], v[172:175], a[248:251], v[76:79]
  ds_read_b128 v[224:227], v30 offset:61440
  v_mfma_f32_16x16x32_bf16 v[88:91], v[168:171], a[252:255], v[88:91]
  buffer_load_dwordx4 v3, s[12:15], s71 offen offset:1024 lds
  v_mfma_f32_16x16x32_bf16 v[92:95], v[172:175], a[252:255], v[92:95]
  ds_read_b128 v[228:231], v30 offset:62464
  v_mfma_f32_16x16x32_bf16 v[128:131], v[176:179], a[240:243], v[128:131]
  ds_read_b128 v[232:235], v30 offset:63488
  v_mfma_f32_16x16x32_bf16 v[144:147], v[180:183], a[240:243], v[144:147]
  ds_read_b128 v[236:239], v30 offset:64512
  v_add_u32 v30, 81920, v30
  v_mfma_f32_16x16x32_bf16 v[132:135], v[176:179], a[244:247], v[132:135]
  buffer_load_dwordx4 v3, s[12:15], s72 offen offset:2048 lds
  v_mfma_f32_16x16x32_bf16 v[148:151], v[180:183], a[244:247], v[148:151]
  ds_read_b64_tr_b16 v[168:169], v6 offset:61440
  s_add_u32 m0, s41, 52224
  v_mfma_f32_16x16x32_bf16 v[136:139], v[176:179], a[248:251], v[136:139]
  ds_read_b64_tr_b16 v[170:171], v6 offset:62464
  v_add_u32 v6, 81920, v6
  v_mfma_f32_16x16x32_bf16 v[152:155], v[180:183], a[248:251], v[152:155]
  ds_read_b64_tr_b16 v[172:173], v7 offset:61440
  v_mfma_f32_16x16x32_bf16 v[140:143], v[176:179], a[252:255], v[140:143]
  buffer_load_dwordx4 v3, s[16:19], s70 offen offset:0 lds
  v_mfma_f32_16x16x32_bf16 v[156:159], v[180:183], a[252:255], v[156:159]
  ds_read_b64_tr_b16 v[174:175], v7 offset:62464
  v_add_u32 v7, 81920, v7
  s_waitcnt lgkmcnt(4)
  v_mfma_f32_16x16x32_bf16 v[32:35], v[160:163], v[224:227], v[32:35]
  ds_read_b64_tr_b16 v[176:177], v14 offset:61440
  v_mfma_f32_16x16x32_bf16 v[36:39], v[164:167], v[224:227], v[36:39]
  ds_read_b64_tr_b16 v[178:179], v14 offset:61696
  v_add_u32 v14, 67584, v14
  v_mfma_f32_16x16x32_bf16 v[48:51], v[160:163], v[228:231], v[48:51]
  ds_read_b64_tr_b16 v[180:181], v14 offset:0
  v_mfma_f32_16x16x32_bf16 v[52:55], v[164:167], v[228:231], v[52:55]
  ds_read_b64_tr_b16 v[182:183], v14 offset:256
  v_mfma_f32_16x16x32_bf16 v[64:67], v[160:163], v[232:235], v[64:67]
  buffer_load_dwordx4 v3, s[16:19], s71 offen offset:1024 lds
  v_mfma_f32_16x16x32_bf16 v[68:71], v[164:167], v[232:235], v[68:71]
  buffer_load_dwordx4 v3, s[16:19], s72 offen offset:2048 lds
  v_mfma_f32_16x16x32_bf16 v[80:83], v[160:163], v[236:239], v[80:83]
  v_mfma_f32_16x16x32_bf16 v[84:87], v[164:167], v[236:239], v[84:87]
  s_waitcnt vmcnt(12) lgkmcnt(0)
  s_barrier
  v_mfma_f32_16x16x32_bf16 v[40:43], v[168:171], v[224:227], v[40:43]
  ds_read_b64_tr_b16 v[160:161], v4 offset:0
  v_mfma_f32_16x16x32_bf16 v[44:47], v[172:175], v[224:227], v[44:47]
  ds_read_b64_tr_b16 v[162:163], v4 offset:1024
  v_mfma_f32_16x16x32_bf16 v[56:59], v[168:171], v[228:231], v[56:59]
  v_mfma_f32_16x16x32_bf16 v[60:63], v[172:175], v[228:231], v[60:63]
  ds_read_b64_tr_b16 v[164:165], v5 offset:0
  v_mfma_f32_16x16x32_bf16 v[72:75], v[168:171], v[232:235], v[72:75]
  ds_read_b64_tr_b16 v[166:167], v5 offset:1024
  v_mfma_f32_16x16x32_bf16 v[76:79], v[172:175], v[232:235], v[76:79]
  ds_read_b128 v[240:243], v30 offset:0
  v_mfma_f32_16x16x32_bf16 v[88:91], v[168:171], v[236:239], v[88:91]
  v_mfma_f32_16x16x32_bf16 v[92:95], v[172:175], v[236:239], v[92:95]
  ds_read_b128 v[244:247], v30 offset:1024
  v_min_u32 v29, 23, v0
  v_mfma_f32_16x16x32_bf16 v[128:131], v[176:179], v[224:227], v[128:131]
  ds_read_b128 v[248:251], v30 offset:2048
  v_lshrrev_b32 v28, 2, v29
  v_mfma_f32_16x16x32_bf16 v[144:147], v[180:183], v[224:227], v[144:147]
  ds_read_b128 v[252:255], v30 offset:3072
  v_mul_u32_u24 v28, 9216, v28
  v_mfma_f32_16x16x32_bf16 v[132:135], v[176:179], v[228:231], v[132:135]
  s_lshl_b32 s95, s32, 1
  v_and_b32 v29, 3, v29
  v_max_u32 v29, 1, v29
  v_mfma_f32_16x16x32_bf16 v[148:151], v[180:183], v[228:231], v[148:151]
  ds_read_b64_tr_b16 v[168:169], v6 offset:0
  v_lshl_add_u32 v28, v29, 7, v28
  v_mfma_f32_16x16x32_bf16 v[136:139], v[176:179], v[232:235], v[136:139]
  ds_read_b64_tr_b16 v[170:171], v6 offset:1024
  s_add_u32 s95, s95, s36
  v_mfma_f32_16x16x32_bf16 v[152:155], v[180:183], v[232:235], v[152:155]
  ds_read_b64_tr_b16 v[172:173], v7 offset:0
  s_mul_i32 s95, s95, 55296
  v_mfma_f32_16x16x32_bf16 v[140:143], v[176:179], v[236:239], v[140:143]
  s_add_u32 s95, s95, s64
  v_mfma_f32_16x16x32_bf16 v[156:159], v[180:183], v[236:239], v[156:159]
  ds_read_b64_tr_b16 v[174:175], v7 offset:1024
  s_waitcnt lgkmcnt(4)
  v_mfma_f32_16x16x32_bf16 v[32:35], v[160:163], v[240:243], v[32:35]
  ds_read_b64_tr_b16 v[176:177], v14 offset:14336
  v_mfma_f32_16x16x32_bf16 v[36:39], v[164:167], v[240:243], v[36:39]
  ds_read_b64_tr_b16 v[178:179], v14 offset:14592
  v_mfma_f32_16x16x32_bf16 v[48:51], v[160:163], v[244:247], v[48:51]
  ds_read_b64_tr_b16 v[180:181], v14 offset:20480
  v_mfma_f32_16x16x32_bf16 v[52:55], v[164:167], v[244:247], v[52:55]
  ds_read_b64_tr_b16 v[182:183], v14 offset:20736
  v_mfma_f32_16x16x32_bf16 v[64:67], v[160:163], v[248:251], v[64:67]
  buffer_load_dword v29, v28, s[24:27], s95 offen
  v_mfma_f32_16x16x32_bf16 v[68:71], v[164:167], v[248:251], v[68:71]
  s_add_u32 s95, s95, 1769472
  v_mfma_f32_16x16x32_bf16 v[80:83], v[160:163], v[252:255], v[80:83]
  v_mfma_f32_16x16x32_bf16 v[84:87], v[164:167], v[252:255], v[84:87]
  s_waitcnt lgkmcnt(0)
  s_barrier
  v_mfma_f32_16x16x32_bf16 v[40:43], v[168:171], v[240:243], v[40:43]
  ds_read_b64_tr_b16 v[160:161], v12 offset:0
  v_mfma_f32_16x16x32_bf16 v[44:47], v[172:175], v[240:243], v[44:47]
  ds_read_b64_tr_b16 v[162:163], v12 offset:512
  v_mfma_f32_16x16x32_bf16 v[56:59], v[168:171], v[244:247], v[56:59]
  v_mfma_f32_16x16x32_bf16 v[60:63], v[172:175], v[244:247], v[60:63]
  v_mfma_f32_16x16x32_bf16 v[72:75], v[168:171], v[248:251], v[72:75]
  ds_read_b64_tr_b16 v[164:165], v12 offset:3072
  v_mfma_f32_16x16x32_bf16 v[76:79], v[172:175], v[248:251], v[76:79]
  ds_read_b64_tr_b16 v[166:167], v12 offset:3584
  v_mfma_f32_16x16x32_bf16 v[88:91], v[168:171], v[252:255], v[88:91]
  v_mfma_f32_16x16x32_bf16 v[92:95], v[172:175], v[252:255], v[92:95]
  ds_read_b128 v[184:187], v2 offset:1024
  v_cvt_pk_bf16_f32 v32, v32, v33
  v_mfma_f32_16x16x32_bf16 v[128:131], v[176:179], v[240:243], v[128:131]
  ds_read_b64_tr_b16 v[168:169], v12 offset:1024
  v_cvt_pk_bf16_f32 v33, v34, v35
  v_mfma_f32_16x16x32_bf16 v[144:147], v[180:183], v[240:243], v[144:147]
  ds_read_b64_tr_b16 v[170:171], v12 offset:1536
  v_cvt_pk_bf16_f32 v34, v36, v37
  v_mfma_f32_16x16x32_bf16 v[132:135], v[176:179], v[244:247], v[132:135]
  ds_read_b128 v[188:191], v27 offset:1024
  v_cvt_pk_bf16_f32 v35, v38, v39
  v_mfma_f32_16x16x32_bf16 v[148:151], v[180:183], v[244:247], v[148:151]
  ds_read_b128 v[192:195], v2 offset:3072
  v_max_f32 v128, 0, v128
  v_mfma_f32_16x16x32_bf16 v[136:139], v[176:179], v[248:251], v[136:139]
  ds_read_b64_tr_b16 v[172:173], v12 offset:4096
  v_max_f32 v129, 0, v129
  v_mfma_f32_16x16x32_bf16 v[152:155], v[180:183], v[248:251], v[152:155]
  ds_read_b64_tr_b16 v[174:175], v12 offset:4608
  v_max_f32 v130, 0, v130
  v_mfma_f32_16x16x32_bf16 v[140:143], v[176:179], v[252:255], v[140:143]
  ds_read_b128 v[196:199], v27 offset:3072
  v_max_f32 v131, 0, v131
  v_mfma_f32_16x16x32_bf16 v[156:159], v[180:183], v[252:255], v[156:159]
  s_waitcnt lgkmcnt(8)
  v_mul_f32 v128, v128, v144
  v_mul_f32 v129, v129, v145
  v_mfma_f32_16x16x32_bf16 v[96:99], v[160:163], a[0:3], 0
  ds_read_b64_tr_b16 v[176:177], v12 offset:2048
  v_mul_f32 v130, v130, v146
  v_mfma_f32_16x16x32_bf16 v[112:115], v[164:167], a[0:3], 0
  ds_read_b64_tr_b16 v[178:179], v12 offset:2560
  v_mul_f32 v131, v131, v147
  v_mfma_f32_16x16x32_bf16 v[100:103], v[160:163], a[4:7], 0
  ds_read_b64_tr_b16 v[180:181], v12 offset:5120
  v_cvt_pk_bf16_f32 v4, v128, v129
  v_mfma_f32_16x16x32_bf16 v[116:119], v[164:167], a[4:7], 0
  ds_read_b64_tr_b16 v[182:183], v12 offset:5632
  v_cvt_pk_bf16_f32 v5, v130, v131
  v_mfma_f32_16x16x32_bf16 v[104:107], v[160:163], a[8:11], 0
  ds_write_b64 v16, v[4:5] offset:0
  v_mfma_f32_16x16x32_bf16 v[120:123], v[164:167], a[8:11], 0
  v_max_f32 v132, 0, v132
  v_max_f32 v133, 0, v133
  v_mfma_f32_16x16x32_bf16 v[108:111], v[160:163], a[12:15], 0
  s_waitcnt lgkmcnt(1)
  v_max_f32 v134, 0, v134
  v_max_f32 v135, 0, v135
  v_mfma_f32_16x16x32_bf16 v[124:127], v[164:167], a[12:15], 0
  s_barrier
  v_mfma_f32_16x16x32_bf16 v[96:99], v[168:171], a[16:19], v[96:99]
  ds_read_b64_tr_b16 v[160:161], v13 offset:0
  v_mul_f32 v132, v132, v148
  v_mfma_f32_16x16x32_bf16 v[112:115], v[172:175], a[16:19], v[112:115]
  ds_read_b64_tr_b16 v[162:163], v13 offset:512
  v_mul_f32 v133, v133, v149
  v_mfma_f32_16x16x32_bf16 v[100:103], v[168:171], a[20:23], v[100:103]
  v_mul_f32 v134, v134, v150
  v_mul_f32 v135, v135, v151
  v_mfma_f32_16x16x32_bf16 v[116:119], v[172:175], a[20:23], v[116:119]
  v_cvt_pk_bf16_f32 v6, v132, v133
  v_cvt_pk_bf16_f32 v7, v134, v135
  v_mfma_f32_16x16x32_bf16 v[104:107], v[168:171], a[24:27], v[104:107]
  ds_read_b64_tr_b16 v[164:165], v13 offset:3072
  v_max_f32 v136, 0, v136
  v_mfma_f32_16x16x32_bf16 v[120:123], v[172:175], a[24:27], v[120:123]
  ds_read_b64_tr_b16 v[166:167], v13 offset:3584
  v_max_f32 v137, 0, v137
  v_mfma_f32_16x16x32_bf16 v[108:111], v[168:171], a[28:31], v[108:111]
  ds_write_b64 v16, v[6:7] offset:1024
  v_mfma_f32_16x16x32_bf16 v[124:127], v[172:175], a[28:31], v[124:127]
  v_max_f32 v138, 0, v138
  v_max_f32 v140, 0, v140
  v_mfma_f32_16x16x32_bf16 v[96:99], v[176:179], a[32:35], v[96:99]
  ds_read_b64_tr_b16 v[168:169], v13 offset:1024
  v_max_f32 v139, 0, v139
  v_mfma_f32_16x16x32_bf16 v[112:115], v[180:183], a[32:35], v[112:115]
  ds_read_b64_tr_b16 v[170:171], v13 offset:1536
  v_max_f32 v141, 0, v141
  v_mfma_f32_16x16x32_bf16 v[100:103], v[176:179], a[36:39], v[100:103]
  v_mul_f32 v136, v136, v152
  v_max_f32 v142, 0, v142
  v_mfma_f32_16x16x32_bf16 v[116:119], v[180:183], a[36:39], v[116:119]
  s_waitcnt lgkmcnt(3)
  v_max_f32 v143, 0, v143
  v_mul_f32 v137, v137, v153
  v_mfma_f32_16x16x32_bf16 v[104:107], v[176:179], a[40:43], v[104:107]
  ds_read_b64_tr_b16 v[172:173], v13 offset:4096
  v_mul_f32 v140, v140, v156
  v_mfma_f32_16x16x32_bf16 v[120:123], v[180:183], a[40:43], v[120:123]
  ds_read_b64_tr_b16 v[174:175], v13 offset:4608
  v_mul_f32 v138, v138, v154
  v_mfma_f32_16x16x32_bf16 v[108:111], v[176:179], a[44:47], v[108:111]
  v_mul_f32 v141, v141, v157
  v_mul_f32 v139, v139, v155
  v_mfma_f32_16x16x32_bf16 v[124:127], v[180:183], a[44:47], v[124:127]
  v_mul_f32 v142, v142, v158
  v_cvt_pk_bf16_f32 v8, v136, v137
  v_mfma_f32_16x16x32_bf16 v[128:131], v[160:163], a[0:3], 0
  ds_read_b64_tr_b16 v[176:177], v13 offset:2048
  v_cvt_pk_bf16_f32 v9, v138, v139
  v_mfma_f32_16x16x32_bf16 v[144:147], v[164:167], a[0:3], 0
  ds_read_b64_tr_b16 v[178:179], v13 offset:2560
  v_mul_f32 v143, v143, v159
  v_mfma_f32_16x16x32_bf16 v[132:135], v[160:163], a[4:7], 0
  ds_read_b64_tr_b16 v[180:181], v13 offset:5120
  v_cvt_pk_bf16_f32 v10, v140, v141
  v_mfma_f32_16x16x32_bf16 v[148:151], v[164:167], a[4:7], 0
  ds_read_b64_tr_b16 v[182:183], v13 offset:5632
  v_cvt_pk_bf16_f32 v11, v142, v143
  v_mfma_f32_16x16x32_bf16 v[136:139], v[160:163], a[8:11], 0
  ds_write_b64 v16, v[8:9] offset:2048
  v_mfma_f32_16x16x32_bf16 v[152:155], v[164:167], a[8:11], 0
  v_cvt_pk_bf16_f32 v36, v40, v41
  v_cvt_pk_bf16_f32 v37, v42, v43
  v_mfma_f32_16x16x32_bf16 v[140:143], v[160:163], a[12:15], 0
  s_waitcnt vmcnt(7) lgkmcnt(1)
  v_cvt_pk_bf16_f32 v38, v44, v45
  v_cvt_pk_bf16_f32 v39, v46, v47
  v_mfma_f32_16x16x32_bf16 v[156:159], v[164:167], a[12:15], 0
  s_barrier
  v_mfma_f32_16x16x32_bf16 v[128:131], v[168:171], a[16:19], v[128:131]
  ds_read_b64_tr_b16 v[160:161], v12 offset:24576
  s_add_u32 m0, s41, 0
  v_mfma_f32_16x16x32_bf16 v[144:147], v[172:175], a[16:19], v[144:147]
  ds_read_b64_tr_b16 v[162:163], v12 offset:25088
  v_cndmask_b32 v34, v34, v223, s[58:59]
  v_mfma_f32_16x16x32_bf16 v[132:135], v[168:171], a[20:23], v[132:135]
  ds_write_b64 v16, v[10:11] offset:3072
  v_mfma_f32_16x16x32_bf16 v[148:151], v[172:175], a[20:23], v[148:151]
  buffer_load_dwordx4 v3, s[12:15], s73 offen offset:0 lds
  v_mfma_f32_16x16x32_bf16 v[136:139], v[168:171], a[24:27], v[136:139]
  ds_read_b64_tr_b16 v[164:165], v12 offset:27648
  v_cndmask_b32 v35, v35, v223, s[58:59]
  v_mfma_f32_16x16x32_bf16 v[152:155], v[172:175], a[24:27], v[152:155]
  ds_read_b64_tr_b16 v[166:167], v12 offset:28160
  v_cvt_pk_bf16_f32 v48, v48, v49
  v_mfma_f32_16x16x32_bf16 v[140:143], v[168:171], a[28:31], v[140:143]
  buffer_load_dwordx4 v3, s[12:15], s74 offen offset:1024 lds
  v_mfma_f32_16x16x32_bf16 v[156:159], v[172:175], a[28:31], v[156:159]
  v_cvt_pk_bf16_f32 v49, v50, v51
  v_cvt_pk_bf16_f32 v50, v52, v53
  v_mfma_f32_16x16x32_bf16 v[128:131], v[176:179], a[32:35], v[128:131]
  ds_read_b64_tr_b16 v[168:169], v12 offset:25600
  v_cvt_pk_bf16_f32 v51, v54, v55
  v_mfma_f32_16x16x32_bf16 v[144:147], v[180:183], a[32:35], v[144:147]
  ds_read_b64_tr_b16 v[170:171], v12 offset:26112
  v_cvt_pk_bf16_f32 v52, v56, v57
  v_mfma_f32_16x16x32_bf16 v[132:135], v[176:179], a[36:39], v[132:135]
  buffer_load_dwordx4 v3, s[12:15], s75 offen offset:2048 lds
  v_mfma_f32_16x16x32_bf16 v[148:151], v[180:183], a[36:39], v[148:151]
  s_add_u32 m0, s41, 3072
  v_cvt_pk_bf16_f32 v53, v58, v59
  v_cvt_pk_bf16_f32 v54, v60, v61
  v_mfma_f32_16x16x32_bf16 v[40:43], v[184:187], v[34:37], 0
  v_cvt_pk_bf16_f32 v55, v62, v63
  v_cndmask_b32 v50, v50, v223, s[58:59]
  v_mfma_f32_16x16x32_bf16 v[136:139], v[176:179], a[40:43], v[136:139]
  ds_read_b64_tr_b16 v[172:173], v12 offset:28672
  v_cndmask_b32 v51, v51, v223, s[58:59]
  v_mfma_f32_16x16x32_bf16 v[152:155], v[180:183], a[40:43], v[152:155]
  ds_read_b64_tr_b16 v[174:175], v12 offset:29184
  v_cvt_pk_bf16_f32 v64, v64, v65
  v_mfma_f32_16x16x32_bf16 v[40:43], v[188:191], v[50:53], v[40:43]
  v_cvt_pk_bf16_f32 v65, v66, v67
  v_cvt_pk_bf16_f32 v66, v68, v69
  v_mfma_f32_16x16x32_bf16 v[44:47], v[192:195], v[34:37], 0
  v_cvt_pk_bf16_f32 v67, v70, v71
  v_cvt_pk_bf16_f32 v68, v72, v73
  v_mfma_f32_16x16x32_bf16 v[44:47], v[196:199], v[50:53], v[44:47]
  v_cvt_pk_bf16_f32 v69, v74, v75
  v_cvt_pk_bf16_f32 v70, v76, v77
  v_mfma_f32_16x16x32_bf16 v[140:143], v[176:179], a[44:47], v[140:143]
  buffer_load_dwordx4 v3, s[16:19], s73 offen offset:0 lds
  v_mfma_f32_16x16x32_bf16 v[156:159], v[180:183], a[44:47], v[156:159]
  s_waitcnt lgkmcnt(4)
  v_cvt_pk_bf16_f32 v71, v78, v79
  v_cndmask_b32 v66, v66, v223, s[58:59]
  v_mfma_f32_16x16x32_bf16 v[96:99], v[160:163], a[48:51], v[96:99]
  ds_read_b64_tr_b16 v[176:177], v12 offset:26624
  v_cndmask_b32 v67, v67, v223, s[58:59]
  v_mfma_f32_16x16x32_bf16 v[112:115], v[164:167], a[48:51], v[112:115]
  ds_read_b64_tr_b16 v[178:179], v12 offset:27136
  v_cvt_pk_bf16_f32 v80, v80, v81
  v_mfma_f32_16x16x32_bf16 v[72:75], v[184:187], v[66:69], 0
  ds_read_b128 v[184:187], v2 offset:5120
  v_cvt_pk_bf16_f32 v81, v82, v83
  v_mfma_f32_16x16x32_bf16 v[76:79], v[192:195], v[66:69], 0
  ds_read_b128 v[192:195], v2 offset:7168
  v_cvt_pk_bf16_f32 v82, v84, v85
  v_mfma_f32_16x16x32_bf16 v[100:103], v[160:163], a[52:55], v[100:103]
  buffer_load_dwordx4 v3, s[16:19], s74 offen offset:1024 lds
  v_mfma_f32_16x16x32_bf16 v[116:119], v[164:167], a[52:55], v[116:119]
  s_waitcnt lgkmcnt(4)
  v_cvt_pk_bf16_f32 v83, v86, v87
  v_cvt_pk_bf16_f32 v84, v88, v89
  v_mfma_f32_16x16x32_bf16 v[104:107], v[160:163], a[56:59], v[104:107]
  ds_read_b64_tr_b16 v[180:181], v12 offset:29696
  v_cvt_pk_bf16_f32 v85, v90, v91
  v_mfma_f32_16x16x32_bf16 v[120:123], v[164:167], a[56:59], v[120:123]
  ds_read_b64_tr_b16 v[182:183], v12 offset:30208
  v_cvt_pk_bf16_f32 v86, v92, v93
  v_mfma_f32_16x16x32_bf16 v[108:111], v[160:163], a[60:63], v[108:111]
  buffer_load_dwordx4 v3, s[16:19], s75 offen offset:2048 lds
  s_waitcnt lgkmcnt(3)
  v_mfma_f32_16x16x32_bf16 v[56:59], v[184:187], v[34:37], 0
  buffer_load_dword v29, v28, s[24:27], s95 offen
  v_mfma_f32_16x16x32_bf16 v[88:91], v[184:187], v[66:69], 0
  s_add_u32 s95, s95, 1769472
  v_cvt_pk_bf16_f32 v87, v94, v95
  v_cndmask_b32 v82, v82, v223, s[58:59]
  s_waitcnt lgkmcnt(2)
  v_mfma_f32_16x16x32_bf16 v[60:63], v[192:195], v[34:37], 0
  ds_read_b128 v[184:187], v2 offset:9216
  v_cndmask_b32 v83, v83, v223, s[58:59]
  v_mfma_f32_16x16x32_bf16 v[92:95], v[192:195], v[66:69], 0
  ds_write_b64 v17, v[38:39] offset:96
  v_mfma_f32_16x16x32_bf16 v[72:75], v[188:191], v[82:85], v[72:75]
  ds_read_b128 v[188:191], v27 offset:5120
  v_mfma_f32_16x16x32_bf16 v[76:79], v[196:199], v[82:85], v[76:79]
  ds_read_b128 v[196:199], v27 offset:7168
  v_mfma_f32_16x16x32_bf16 v[124:127], v[164:167], a[60:63], v[124:127]
  v_mfma_f32_16x16x32_bf16 v[96:99], v[168:171], a[64:67], v[96:99]
  ds_read_b64_tr_b16 v[160:161], v13 offset:24576
  v_mfma_f32_16x16x32_bf16 v[112:115], v[172:175], a[64:67], v[112:115]
  ds_read_b64_tr_b16 v[162:163], v13 offset:25088
  s_waitcnt lgkmcnt(5)
  v_mfma_f32_16x16x32_bf16 v[200:203], v[184:187], v[34:37], 0
  ds_write_b64 v17, v[34:35] offset:128
  v_mfma_f32_16x16x32_bf16 v[204:207], v[184:187], v[66:69], 0
  s_waitcnt lgkmcnt(4)
  v_mfma_f32_16x16x32_bf16 v[56:59], v[188:191], v[50:53], v[56:59]
  v_mfma_f32_16x16x32_bf16 v[88:91], v[188:191], v[82:85], v[88:91]
  ds_read_b128 v[188:191], v27 offset:9216
  s_waitcnt lgkmcnt(4)
  v_mfma_f32_16x16x32_bf16 v[60:63], v[196:199], v[50:53], v[60:63]
  ds_write_b64 v17, v[54:55] offset:2656
  v_mfma_f32_16x16x32_bf16 v[92:95], v[196:199], v[82:85], v[92:95]
  v_mfma_f32_16x16x32_bf16 v[100:103], v[168:171], a[68:71], v[100:103]
  v_mfma_f32_16x16x32_bf16 v[116:119], v[172:175], a[68:71], v[116:119]
  v_mfma_f32_16x16x32_bf16 v[104:107], v[168:171], a[72:75], v[104:107]
  ds_read_b64_tr_b16 v[164:165], v13 offset:27648
  v_mfma_f32_16x16x32_bf16 v[120:123], v[172:175], a[72:75], v[120:123]
  ds_read_b64_tr_b16 v[166:167], v13 offset:28160
  s_waitcnt lgkmcnt(3)
  v_mfma_f32_16x16x32_bf16 v[200:203], v[188:191], v[50:53], v[200:203]
  ds_write_b64 v17, v[50:51] offset:2688
  v_mfma_f32_16x16x32_bf16 v[204:207], v[188:191], v[82:85], v[204:207]
  v_mfma_f32_16x16x32_bf16 v[108:111], v[168:171], a[76:79], v[108:111]
  v_mfma_f32_16x16x32_bf16 v[124:127], v[172:175], a[76:79], v[124:127]
  v_mfma_f32_16x16x32_bf16 v[96:99], v[176:179], a[80:83], v[96:99]
  ds_read_b64_tr_b16 v[168:169], v13 offset:25600
  v_mfma_f32_16x16x32_bf16 v[112:115], v[180:183], a[80:83], v[112:115]
  ds_read_b64_tr_b16 v[170:171], v13 offset:26112
  v_max3_f32 v202, v40, v41, v42
  v_mfma_f32_16x16x32_bf16 v[100:103], v[176:179], a[84:87], v[100:103]
  ds_write_b64 v17, v[70:71] offset:5216
  v_mfma_f32_16x16x32_bf16 v[116:119], v[180:183], a[84:87], v[116:119]
  s_waitcnt lgkmcnt(4)
  v_max3_f32 v203, v43, v44, v45
  v_max3_f32 v202, v202, v46, v47
  v_mfma_f32_16x16x32_bf16 v[104:107], v[176:179], a[88:91], v[104:107]
  ds_read_b64_tr_b16 v[172:173], v13 offset:28672
  v_max3_f32 v203, v203, v56, v57
  v_mfma_f32_16x16x32_bf16 v[120:123], v[180:183], a[88:91], v[120:123]
  ds_read_b64_tr_b16 v[174:175], v13 offset:29184
  v_max3_f32 v202, v202, v58, v59
  v_mfma_f32_16x16x32_bf16 v[108:111], v[176:179], a[92:95], v[108:111]
STUB3:
  s_cbranch_execz K1_back0
  ds_write_b64 v17, v[66:67] offset:5248
  v_mfma_f32_16x16x32_bf16 v[124:127], v[180:183], a[92:95], v[124:127]
  v_max3_f32 v203, v203, v60, v61
  v_max3_f32 v202, v202, v62, v63
  v_mfma_f32_16x16x32_bf16 v[128:131], v[160:163], a[48:51], v[128:131]
  ds_read_b64_tr_b16 v[176:177], v13 offset:26624
  v_max3_f32 v203, v203, v200, v201
  v_mfma_f32_16x16x32_bf16 v[144:147], v[164:167], a[48:51], v[144:147]
  ds_read_b64_tr_b16 v[178:179], v13 offset:27136
  v_max_f32 v202, v202, v203
  v_mfma_f32_16x16x32_bf16 v[132:135], v[160:163], a[52:55], v[132:135]
  ds_read_b64_tr_b16 v[180:181], v13 offset:29696
  v_mul_f32 v202, 0xbfb8aa3b, v202
  v_mfma_f32_16x16x32_bf16 v[148:151], v[164:167], a[52:55], v[148:151]
  ds_read_b64_tr_b16 v[182:183], v13 offset:30208
  v_fma_f32 v40, v40, s50, v202
  v_mfma_f32_16x16x32_bf16 v[136:139], v[160:163], a[56:59], v[136:139]
  ds_write_b64 v17, v[86:87] offset:7776
  v_mfma_f32_16x16x32_bf16 v[152:155], v[164:167], a[56:59], v[152:155]
  v_exp_f32 v40, v40
  v_mfma_f32_16x16x32_bf16 v[140:143], v[160:163], a[60:63], v[140:143]
  s_waitcnt vmcnt(8) lgkmcnt(1)
  v_fma_f32 v41, v41, s50, v202
  v_fma_f32 v42, v42, s50, v202
  v_mfma_f32_16x16x32_bf16 v[156:159], v[164:167], a[60:63], v[156:159]
  s_barrier
  v_mfma_f32_16x16x32_bf16 v[128:131], v[168:171], a[64:67], v[128:131]
  ds_read_b64_tr_b16 v[160:161], v12 offset:49152
  s_add_u32 m0, s41, 24576
  v_mfma_f32_16x16x32_bf16 v[144:147], v[172:175], a[64:67], v[144:147]
  ds_read_b64_tr_b16 v[162:163], v12 offset:49664
  s_add_u32 s49, s39, 73728
  v_mfma_f32_16x16x32_bf16 v[132:135], v[168:171], a[68:71], v[132:135]
  buffer_load_dwordx4 v3, s[12:15], s76 offen offset:0 lds
  v_mfma_f32_16x16x32_bf16 v[148:151], v[172:175], a[68:71], v[148:151]
  ds_write_b64 v17, v[82:83] offset:7808
  v_mfma_f32_16x16x32_bf16 v[136:139], v[168:171], a[72:75], v[136:139]
  ds_read_b64_tr_b16 v[164:165], v12 offset:52224
  v_add_u32 v4, s49, v1
  v_mfma_f32_16x16x32_bf16 v[152:155], v[172:175], a[72:75], v[152:155]
  ds_read_b64_tr_b16 v[166:167], v12 offset:52736
  s_add_u32 s49, s100, 0
  v_mfma_f32_16x16x32_bf16 v[140:143], v[168:171], a[76:79], v[140:143]
  buffer_load_dwordx4 v3, s[12:15], s77 offen offset:1024 lds
  v_mfma_f32_16x16x32_bf16 v[156:159], v[172:175], a[76:79], v[156:159]
  ds_read_b128 v[8:11], v4 offset:1024
  v_fma_f32 v43, v43, s50, v202
  v_mfma_f32_16x16x32_bf16 v[128:131], v[176:179], a[80:83], v[128:131]
  ds_read_b64_tr_b16 v[168:169], v12 offset:50176
  v_fma_f32 v44, v44, s50, v202
  v_mfma_f32_16x16x32_bf16 v[144:147], v[180:183], a[80:83], v[144:147]
  ds_read_b64_tr_b16 v[170:171], v12 offset:50688
  v_fma_f32 v45, v45, s50, v202
  v_mfma_f32_16x16x32_bf16 v[132:135], v[176:179], a[84:87], v[132:135]
  buffer_load_dwordx4 v3, s[12:15], s78 offen offset:2048 lds
  v_mfma_f32_16x16x32_bf16 v[148:151], v[180:183], a[84:87], v[148:151]
  s_add_u32 m0, s41, 27648
  ds_read_b128 v[4:7], v4
  v_mfma_f32_16x16x32_bf16 v[136:139], v[176:179], a[88:91], v[136:139]
  ds_read_b64_tr_b16 v[172:173], v12 offset:53248
  v_fma_f32 v46, v46, s50, v202
  v_mfma_f32_16x16x32_bf16 v[152:155], v[180:183], a[88:91], v[152:155]
  ds_read_b64_tr_b16 v[174:175], v12 offset:53760
  v_fma_f32 v47, v47, s50, v202
  v_mfma_f32_16x16x32_bf16 v[140:143], v[176:179], a[92:95], v[140:143]
  buffer_load_dwordx4 v3, s[16:19], s76 offen offset:0 lds
  v_mfma_f32_16x16x32_bf16 v[156:159], v[180:183], a[92:95], v[156:159]
  s_waitcnt lgkmcnt(6)
  v_exp_f32 v41, v41
  v_mfma_f32_16x16x32_bf16 v[96:99], v[160:163], a[96:99], v[96:99]
  ds_read_b64_tr_b16 v[176:177], v12 offset:51200
  v_add_f32 v203, v40, v41
  v_mfma_f32_16x16x32_bf16 v[112:115], v[164:167], a[96:99], v[112:115]
  ds_read_b64_tr_b16 v[178:179], v12 offset:51712
  v_fma_f32 v56, v56, s50, v202
  v_mfma_f32_16x16x32_bf16 v[100:103], v[160:163], a[100:103], v[100:103]
  buffer_load_dwordx4 v3, s[16:19], s77 offen offset:1024 lds
  v_mfma_f32_16x16x32_bf16 v[116:119], v[164:167], a[100:103], v[116:119]
  s_waitcnt lgkmcnt(2)
  v_exp_f32 v42, v42
  v_mfma_f32_16x16x32_bf16 v[104:107], v[160:163], a[104:107], v[104:107]
  ds_read_b64_tr_b16 v[180:181], v12 offset:54272
  v_add_f32 v203, v203, v42
  v_mfma_f32_16x16x32_bf16 v[120:123], v[164:167], a[104:107], v[120:123]
  ds_read_b64_tr_b16 v[182:183], v12 offset:54784
  v_fma_f32 v57, v57, s50, v202
  v_mfma_f32_16x16x32_bf16 v[108:111], v[160:163], a[108:111], v[108:111]
  buffer_load_dwordx4 v3, s[16:19], s78 offen offset:2048 lds
  v_mfma_f32_16x16x32_bf16 v[124:127], v[164:167], a[108:111], v[124:127]
  v_exp_f32 v43, v43
  v_mfma_f32_16x16x32_bf16 v[96:99], v[168:171], a[112:115], v[96:99]
  ds_read_b64_tr_b16 v[160:161], v13 offset:49152
  v_add_f32 v203, v203, v43
  v_mfma_f32_16x16x32_bf16 v[112:115], v[172:175], a[112:115], v[112:115]
  ds_read_b64_tr_b16 v[162:163], v13 offset:49664
  v_fma_f32 v58, v58, s50, v202
  v_mfma_f32_16x16x32_bf16 v[100:103], v[168:171], a[116:119], v[100:103]
  buffer_store_dwordx4 v[8:11], v1, s[4:7], s49 offen offset:1024 sc1
  v_mfma_f32_16x16x32_bf16 v[116:119], v[172:175], a[116:119], v[116:119]
  buffer_store_dwordx4 v[4:7], v1, s[4:7], s49 offen sc1
  v_mfma_f32_16x16x32_bf16 v[104:107], v[168:171], a[120:123], v[104:107]
  ds_read_b64_tr_b16 v[164:165], v13 offset:52224
  v_fma_f32 v59, v59, s50, v202
  v_mfma_f32_16x16x32_bf16 v[120:123], v[172:175], a[120:123], v[120:123]
  ds_read_b64_tr_b16 v[166:167], v13 offset:52736
  v_fma_f32 v60, v60, s50, v202
  v_mfma_f32_16x16x32_bf16 v[108:111], v[168:171], a[124:127], v[108:111]
  s_waitcnt lgkmcnt(4)
  v_exp_f32 v44, v44
  v_mfma_f32_16x16x32_bf16 v[124:127], v[172:175], a[124:127], v[124:127]
  v_exp_f32 v45, v45
  v_mfma_f32_16x16x32_bf16 v[96:99], v[176:179], a[128:131], v[96:99]
  ds_read_b64_tr_b16 v[168:169], v13 offset:50176
  v_add_f32 v203, v203, v44
  v_mfma_f32_16x16x32_bf16 v[112:115], v[180:183], a[128:131], v[112:115]
  ds_read_b64_tr_b16 v[170:171], v13 offset:50688
  v_add_f32 v203, v203, v45
  v_mfma_f32_16x16x32_bf16 v[100:103], v[176:179], a[132:135], v[100:103]
  v_exp_f32 v46, v46
  v_mfma_f32_16x16x32_bf16 v[116:119], v[180:183], a[132:135], v[116:119]
  s_waitcnt lgkmcnt(2)
  v_exp_f32 v47, v47
  v_mfma_f32_16x16x32_bf16 v[104:107], v[176:179], a[136:139], v[104:107]
  ds_read_b64_tr_b16 v[172:173], v13 offset:53248
  v_add_f32 v203, v203, v46
  v_mfma_f32_16x16x32_bf16 v[120:123], v[180:183], a[136:139], v[120:123]
  ds_read_b64_tr_b16 v[174:175], v13 offset:53760
  v_add_f32 v203, v203, v47
  v_mfma_f32_16x16x32_bf16 v[108:111], v[176:179], a[140:143], v[108:111]
  v_exp_f32 v56, v56
  v_mfma_f32_16x16x32_bf16 v[124:127], v[180:183], a[140:143], v[124:127]
  v_exp_f32 v57, v57
  v_mfma_f32_16x16x32_bf16 v[128:131], v[160:163], a[96:99], v[128:131]
  ds_read_b64_tr_b16 v[176:177], v13 offset:51200
  v_add_f32 v203, v203, v56
  v_mfma_f32_16x16x32_bf16 v[144:147], v[164:167], a[96:99], v[144:147]
  ds_read_b64_tr_b16 v[178:179], v13 offset:51712
  v_add_f32 v203, v203, v57
  v_mfma_f32_16x16x32_bf16 v[132:135], v[160:163], a[100:103], v[132:135]
  ds_read_b64_tr_b16 v[180:181], v13 offset:54272
  v_fma_f32 v61, v61, s50, v202
  v_mfma_f32_16x16x32_bf16 v[148:151], v[164:167], a[100:103], v[148:151]
  ds_read_b64_tr_b16 v[182:183], v13 offset:54784
  v_fma_f32 v62, v62, s50, v202
  v_mfma_f32_16x16x32_bf16 v[136:139], v[160:163], a[104:107], v[136:139]
  buffer_load_dword v29, v28, s[24:27], s95 offen
  v_mfma_f32_16x16x32_bf16 v[152:155], v[164:167], a[104:107], v[152:155]
  s_sub_u32 s95, s95, 3538944
  v_exp_f32 v58, v58
  v_mfma_f32_16x16x32_bf16 v[140:143], v[160:163], a[108:111], v[140:143]
  s_waitcnt vmcnt(10) lgkmcnt(0)
  v_exp_f32 v59, v59
  v_mfma_f32_16x16x32_bf16 v[156:159], v[164:167], a[108:111], v[156:159]
  s_barrier
  v_mfma_f32_16x16x32_bf16 v[128:131], v[168:171], a[112:115], v[128:131]
  ds_read_b64_tr_b16 v[160:161], v12 offset:0
  s_add_u32 m0, s41, 49152
  v_mfma_f32_16x16x32_bf16 v[144:147], v[172:175], a[112:115], v[144:147]
  ds_read_b64_tr_b16 v[162:163], v12 offset:512
  v_add_f32 v203, v203, v58
  v_mfma_f32_16x16x32_bf16 v[132:135], v[168:171], a[116:119], v[132:135]
  buffer_load_dwordx4 v3, s[12:15], s79 offen offset:0 lds
  v_mfma_f32_16x16x32_bf16 v[148:151], v[172:175], a[116:119], v[148:151]
  v_exp_f32 v60, v60
  v_mfma_f32_16x16x32_bf16 v[136:139], v[168:171], a[120:123], v[136:139]
  ds_read_b64_tr_b16 v[164:165], v12 offset:3072
  v_add_f32 v203, v203, v59
  v_mfma_f32_16x16x32_bf16 v[152:155], v[172:175], a[120:123], v[152:155]
  ds_read_b64_tr_b16 v[166:167], v12 offset:3584
  v_fma_f32 v63, v63, s50, v202
  v_mfma_f32_16x16x32_bf16 v[140:143], v[168:171], a[124:127], v[140:143]
  buffer_load_dwordx4 v3, s[12:15], s80 offen offset:1024 lds
  v_mfma_f32_16x16x32_bf16 v[156:159], v[172:175], a[124:127], v[156:159]
  v_exp_f32 v61, v61
  v_mfma_f32_16x16x32_bf16 v[128:131], v[176:179], a[128:131], v[128:131]
  ds_read_b64_tr_b16 v[168:169], v12 offset:1024
  v_add_f32 v203, v203, v60
  v_mfma_f32_16x16x32_bf16 v[144:147], v[180:183], a[128:131], v[144:147]
  ds_read_b64_tr_b16 v[170:171], v12 offset:1536
  v_fma_f32 v200, v200, s50, v202
  v_mfma_f32_16x16x32_bf16 v[132:135], v[176:179], a[132:135], v[132:135]
  buffer_load_dwordx4 v3, s[12:15], s81 offen offset:2048 lds
  v_mfma_f32_16x16x32_bf16 v[148:151], v[180:183], a[132:135], v[148:151]
  s_add_u32 m0, s41, 52224
  v_exp_f32 v62, v62
  v_mfma_f32_16x16x32_bf16 v[136:139], v[176:179], a[136:139], v[136:139]
  ds_read_b64_tr_b16 v[172:173], v12 offset:4096
  v_add_f32 v203, v203, v61
  v_mfma_f32_16x16x32_bf16 v[152:155], v[180:183], a[136:139], v[152:155]
  ds_read_b64_tr_b16 v[174:175], v12 offset:4608
  v_fma_f32 v201, v201, s50, v202
  v_mfma_f32_16x16x32_bf16 v[140:143], v[176:179], a[140:143], v[140:143]
  buffer_load_dwordx4 v3, s[16:19], s79 offen offset:0 lds
  v_mfma_f32_16x16x32_bf16 v[156:159], v[180:183], a[140:143], v[156:159]
  s_waitcnt lgkmcnt(4)
  v_exp_f32 v63, v63
  v_mfma_f32_16x16x32_bf16 v[96:99], v[160:163], a[144:147], v[96:99]
  ds_read_b64_tr_b16 v[176:177], v12 offset:2048
  v_add_f32 v203, v203, v62
  v_mfma_f32_16x16x32_bf16 v[112:115], v[164:167], a[144:147], v[112:115]
  ds_read_b64_tr_b16 v[178:179], v12 offset:2560
  v_add_f32 v203, v203, v63
  v_mfma_f32_16x16x32_bf16 v[100:103], v[160:163], a[148:151], v[100:103]
  buffer_load_dwordx4 v3, s[16:19], s80 offen offset:1024 lds
  v_mfma_f32_16x16x32_bf16 v[116:119], v[164:167], a[148:151], v[116:119]
  s_waitcnt lgkmcnt(2)
  v_exp_f32 v200, v200
  v_mfma_f32_16x16x32_bf16 v[104:107], v[160:163], a[152:155], v[104:107]
  ds_read_b64_tr_b16 v[180:181], v12 offset:5120
  v_add_f32 v203, v203, v200
  v_mfma_f32_16x16x32_bf16 v[120:123], v[164:167], a[152:155], v[120:123]
  ds_read_b64_tr_b16 v[182:183], v12 offset:5632
  v_max3_f32 v206, v72, v73, v74
  v_mfma_f32_16x16x32_bf16 v[108:111], v[160:163], a[156:159], v[108:111]
  buffer_load_dwordx4 v3, s[16:19], s81 offen offset:2048 lds
  v_mfma_f32_16x16x32_bf16 v[124:127], v[164:167], a[156:159], v[124:127]
  v_exp_f32 v201, v201
  v_mfma_f32_16x16x32_bf16 v[96:99], v[168:171], a[160:163], v[96:99]
  ds_read_b64_tr_b16 v[160:161], v13 offset:0
  v_add_f32 v203, v203, v201
  v_mfma_f32_16x16x32_bf16 v[112:115], v[172:175], a[160:163], v[112:115]
  ds_read_b64_tr_b16 v[162:163], v13 offset:512
  v_max3_f32 v207, v75, v76, v77
  v_mfma_f32_16x16x32_bf16 v[100:103], v[168:171], a[164:167], v[100:103]
  v_rcp_f32 v203, v203
  v_mfma_f32_16x16x32_bf16 v[116:119], v[172:175], a[164:167], v[116:119]
  s_waitcnt lgkmcnt(2)
  v_mul_f32 v40, v40, v203
  v_mul_f32 v41, v41, v203
  v_mfma_f32_16x16x32_bf16 v[104:107], v[168:171], a[168:171], v[104:107]
  ds_read_b64_tr_b16 v[164:165], v13 offset:3072
  v_mul_f32 v42, v42, v203
  v_mfma_f32_16x16x32_bf16 v[120:123], v[172:175], a[168:171], v[120:123]
  ds_read_b64_tr_b16 v[166:167], v13 offset:3584
  v_mul_f32 v43, v43, v203
  v_mfma_f32_16x16x32_bf16 v[108:111], v[168:171], a[172:175], v[108:111]
  v_mul_f32 v44, v44, v203
  v_mul_f32 v45, v45, v203
  v_mfma_f32_16x16x32_bf16 v[124:127], v[172:175], a[172:175], v[124:127]
  v_mul_f32 v46, v46, v203
  v_mul_f32 v47, v47, v203
  v_mfma_f32_16x16x32_bf16 v[96:99], v[176:179], a[176:179], v[96:99]
  ds_read_b64_tr_b16 v[168:169], v13 offset:1024
  v_mul_f32 v56, v56, v203
  v_mfma_f32_16x16x32_bf16 v[112:115], v[180:183], a[176:179], v[112:115]
  ds_read_b64_tr_b16 v[170:171], v13 offset:1536
  v_mul_f32 v57, v57, v203
  v_mfma_f32_16x16x32_bf16 v[100:103], v[176:179], a[180:183], v[100:103]
  v_mul_f32 v58, v58, v203
  v_mul_f32 v59, v59, v203
  v_mfma_f32_16x16x32_bf16 v[116:119], v[180:183], a[180:183], v[116:119]
  s_waitcnt lgkmcnt(2)
  v_mul_f32 v60, v60, v203
  v_mul_f32 v61, v61, v203
  v_mfma_f32_16x16x32_bf16 v[104:107], v[176:179], a[184:187], v[104:107]
  ds_read_b64_tr_b16 v[172:173], v13 offset:4096
  v_mul_f32 v62, v62, v203
  v_mfma_f32_16x16x32_bf16 v[120:123], v[180:183], a[184:187], v[120:123]
  ds_read_b64_tr_b16 v[174:175], v13 offset:4608
  v_mul_f32 v63, v63, v203
  v_mfma_f32_16x16x32_bf16 v[108:111], v[176:179], a[188:191], v[108:111]
  v_mul_f32 v200, v200, v203
  v_mul_f32 v201, v201, v203
  v_mfma_f32_16x16x32_bf16 v[124:127], v[180:183], a[188:191], v[124:127]
  v_cvt_pk_bf16_f32 v40, v40, v41
  v_cvt_pk_bf16_f32 v41, v42, v43
  v_mfma_f32_16x16x32_bf16 v[128:131], v[160:163], a[144:147], v[128:131]
  ds_read_b64_tr_b16 v[176:177], v13 offset:2048
  v_cvt_pk_bf16_f32 v42, v44, v45
  v_mfma_f32_16x16x32_bf16 v[144:147], v[164:167], a[144:147], v[144:147]
  ds_read_b64_tr_b16 v[178:179], v13 offset:2560
  v_cvt_pk_bf16_f32 v43, v46, v47
  v_mfma_f32_16x16x32_bf16 v[132:135], v[160:163], a[148:151], v[132:135]
  ds_read_b64_tr_b16 v[180:181], v13 offset:5120
  v_cvt_pk_bf16_f32 v44, v56, v57
  v_mfma_f32_16x16x32_bf16 v[148:151], v[164:167], a[148:151], v[148:151]
  ds_read_b64_tr_b16 v[182:183], v13 offset:5632
  v_cvt_pk_bf16_f32 v45, v58, v59
  v_mfma_f32_16x16x32_bf16 v[136:139], v[160:163], a[152:155], v[136:139]
  ds_write_b128 v18, v[40:43] offset:0
  v_mfma_f32_16x16x32_bf16 v[152:155], v[164:167], a[152:155], v[152:155]
  v_cvt_pk_bf16_f32 v46, v60, v61
  v_cvt_pk_bf16_f32 v47, v62, v63
  v_mfma_f32_16x16x32_bf16 v[140:143], v[160:163], a[156:159], v[140:143]
  s_waitcnt vmcnt(9) lgkmcnt(1)
  v_cvt_pk_bf16_f32 v38, v200, v201
  v_mov_b32 v39, 0
  v_mfma_f32_16x16x32_bf16 v[156:159], v[164:167], a[156:159], v[156:159]
  s_barrier
  v_mfma_f32_16x16x32_bf16 v[128:131], v[168:171], a[160:163], v[128:131]
  ds_read_b64_tr_b16 v[160:161], v12 offset:24576
  v_add_u32 v3, 128, v3
  v_mfma_f32_16x16x32_bf16 v[144:147], v[172:175], a[160:163], v[144:147]
  ds_read_b64_tr_b16 v[162:163], v12 offset:25088
  s_add_u32 m0, s41, 0
  v_mfma_f32_16x16x32_bf16 v[132:135], v[168:171], a[164:167], v[132:135]
  buffer_load_dwordx4 v3, s[12:15], s64 offen offset:0 lds
  v_mfma_f32_16x16x32_bf16 v[148:151], v[172:175], a[164:167], v[148:151]
  ds_write_b128 v18, v[44:47] offset:16
  v_mfma_f32_16x16x32_bf16 v[136:139], v[168:171], a[168:171], v[136:139]
  ds_read_b64_tr_b16 v[164:165], v12 offset:27648
  v_max3_f32 v206, v206, v78, v79
  v_mfma_f32_16x16x32_bf16 v[152:155], v[172:175], a[168:171], v[152:155]
  ds_read_b64_tr_b16 v[166:167], v12 offset:28160
  v_max3_f32 v207, v207, v88, v89
  v_mfma_f32_16x16x32_bf16 v[140:143], v[168:171], a[172:175], v[140:143]
  buffer_load_dwordx4 v3, s[12:15], s65 offen offset:1024 lds
  v_mfma_f32_16x16x32_bf16 v[156:159], v[172:175], a[172:175], v[156:159]
  ds_write_b64 v18, v[38:39] offset:32
  v_mfma_f32_16x16x32_bf16 v[128:131], v[176:179], a[176:179], v[128:131]
  ds_read_b64_tr_b16 v[168:169], v12 offset:25600
  v_max3_f32 v206, v206, v90, v91
  v_mfma_f32_16x16x32_bf16 v[144:147], v[180:183], a[176:179], v[144:147]
  ds_read_b64_tr_b16 v[170:171], v12 offset:26112
  v_max3_f32 v207, v207, v92, v93
  v_mfma_f32_16x16x32_bf16 v[132:135], v[176:179], a[180:183], v[132:135]
  buffer_load_dwordx4 v3, s[12:15], s66 offen offset:2048 lds
  v_mfma_f32_16x16x32_bf16 v[148:151], v[180:183], a[180:183], v[148:151]
  s_add_u32 m0, s41, 3072
  v_max3_f32 v206, v206, v94, v95
  v_max3_f32 v207, v207, v204, v205
  v_mfma_f32_16x16x32_bf16 v[136:139], v[176:179], a[184:187], v[136:139]
  ds_read_b64_tr_b16 v[172:173], v12 offset:28672
  v_max_f32 v206, v206, v207
  v_mfma_f32_16x16x32_bf16 v[152:155], v[180:183], a[184:187], v[152:155]
  ds_read_b64_tr_b16 v[174:175], v12 offset:29184
  v_mul_f32 v206, 0xbfb8aa3b, v206
  v_mfma_f32_16x16x32_bf16 v[140:143], v[176:179], a[188:191], v[140:143]
  buffer_load_dwordx4 v3, s[16:19], s64 offen offset:0 lds
  v_mfma_f32_16x16x32_bf16 v[156:159], v[180:183], a[188:191], v[156:159]
  s_waitcnt lgkmcnt(5)
  v_fma_f32 v72, v72, s50, v206
  v_fma_f32 v73, v73, s50, v206
  v_mfma_f32_16x16x32_bf16 v[96:99], v[160:163], a[192:195], v[96:99]
  ds_read_b64_tr_b16 v[176:177], v12 offset:26624
  v_fma_f32 v74, v74, s50, v206
  v_mfma_f32_16x16x32_bf16 v[112:115], v[164:167], a[192:195], v[112:115]
  ds_read_b64_tr_b16 v[178:179], v12 offset:27136
  v_fma_f32 v75, v75, s50, v206
  v_mfma_f32_16x16x32_bf16 v[100:103], v[160:163], a[196:199], v[100:103]
  buffer_load_dwordx4 v3, s[16:19], s65 offen offset:1024 lds
  v_mfma_f32_16x16x32_bf16 v[116:119], v[164:167], a[196:199], v[116:119]
  s_waitcnt lgkmcnt(2)
  v_exp_f32 v72, v72
  v_mfma_f32_16x16x32_bf16 v[104:107], v[160:163], a[200:203], v[104:107]
  ds_read_b64_tr_b16 v[180:181], v12 offset:29696
  v_fma_f32 v76, v76, s50, v206
  v_mfma_f32_16x16x32_bf16 v[120:123], v[164:167], a[200:203], v[120:123]
  ds_read_b64_tr_b16 v[182:183], v12 offset:30208
  v_fma_f32 v77, v77, s50, v206
  v_mfma_f32_16x16x32_bf16 v[108:111], v[160:163], a[204:207], v[108:111]
  buffer_load_dwordx4 v3, s[16:19], s66 offen offset:2048 lds
  v_mfma_f32_16x16x32_bf16 v[124:127], v[164:167], a[204:207], v[124:127]
  v_exp_f32 v73, v73
  v_mfma_f32_16x16x32_bf16 v[96:99], v[168:171], a[208:211], v[96:99]
  ds_read_b64_tr_b16 v[160:161], v13 offset:24576
  v_add_f32 v207, v72, v73
  v_mfma_f32_16x16x32_bf16 v[112:115], v[172:175], a[208:211], v[112:115]
  ds_read_b64_tr_b16 v[162:163], v13 offset:25088
  v_fma_f32 v78, v78, s50, v206
  v_mfma_f32_16x16x32_bf16 v[100:103], v[168:171], a[212:215], v[100:103]
  v_exp_f32 v74, v74
  v_mfma_f32_16x16x32_bf16 v[116:119], v[172:175], a[212:215], v[116:119]
  s_waitcnt lgkmcnt(2)
  v_exp_f32 v75, v75
  v_mfma_f32_16x16x32_bf16 v[104:107], v[168:171], a[216:219], v[104:107]
  ds_read_b64_tr_b16 v[164:165], v13 offset:27648
  v_add_f32 v207, v207, v74
  v_mfma_f32_16x16x32_bf16 v[120:123], v[172:175], a[216:219], v[120:123]
  ds_read_b64_tr_b16 v[166:167], v13 offset:28160
  v_min_u32 v28, 13, v0
  v_mfma_f32_16x16x32_bf16 v[108:111], v[168:171], a[220:223], v[108:111]
  s_lshl_b32 s44, s32, 2
  v_exp_f32 v76, v76
  v_mfma_f32_16x16x32_bf16 v[124:127], v[172:175], a[220:223], v[124:127]
  s_add_u32 s44, s44, s34
  v_exp_f32 v77, v77
  v_mfma_f32_16x16x32_bf16 v[96:99], v[176:179], a[224:227], v[96:99]
  ds_read_b64_tr_b16 v[168:169], v13 offset:25600
  v_lshlrev_b32 v28, 7, v28
  v_mfma_f32_16x16x32_bf16 v[112:115], v[180:183], a[224:227], v[112:115]
  ds_read_b64_tr_b16 v[170:171], v13 offset:26112
  s_mul_i32 s44, s44, 1792
  v_mfma_f32_16x16x32_bf16 v[100:103], v[176:179], a[228:231], v[100:103]
  s_add_u32 s98, s98, s44
  v_exp_f32 v78, v78
  v_mfma_f32_16x16x32_bf16 v[116:119], v[180:183], a[228:231], v[116:119]
  buffer_load_dword v29, v28, s[8:11], s98 offen
  v_mfma_f32_16x16x32_bf16 v[104:107], v[176:179], a[232:235], v[104:107]
  ds_read_b64_tr_b16 v[172:173], v13 offset:28672
  s_add_u32 s99, s99, s44
  v_mfma_f32_16x16x32_bf16 v[120:123], v[180:183], a[232:235], v[120:123]
  ds_read_b64_tr_b16 v[174:175], v13 offset:29184
  s_add_u32 s98, s98, 114688
  v_mfma_f32_16x16x32_bf16 v[108:111], v[176:179], a[236:239], v[108:111]
  s_waitcnt lgkmcnt(4)
  v_add_f32 v207, v207, v75
  v_fma_f32 v79, v79, s50, v206
  v_mfma_f32_16x16x32_bf16 v[124:127], v[180:183], a[236:239], v[124:127]
  v_exp_f32 v79, v79
  v_mfma_f32_16x16x32_bf16 v[128:131], v[160:163], a[192:195], v[128:131]
  ds_read_b64_tr_b16 v[176:177], v13 offset:26624
  v_add_f32 v207, v207, v76
  v_mfma_f32_16x16x32_bf16 v[144:147], v[164:167], a[192:195], v[144:147]
  ds_read_b64_tr_b16 v[178:179], v13 offset:27136
  v_fma_f32 v88, v88, s50, v206
  v_mfma_f32_16x16x32_bf16 v[132:135], v[160:163], a[196:199], v[132:135]
  ds_read_b64_tr_b16 v[180:181], v13 offset:29696
  v_add_f32 v207, v207, v77
  v_mfma_f32_16x16x32_bf16 v[148:151], v[164:167], a[196:199], v[148:151]
  ds_read_b64_tr_b16 v[182:183], v13 offset:30208
  v_fma_f32 v89, v89, s50, v206
  v_mfma_f32_16x16x32_bf16 v[136:139], v[160:163], a[200:203], v[136:139]
  v_exp_f32 v88, v88
  v_mfma_f32_16x16x32_bf16 v[152:155], v[164:167], a[200:203], v[152:155]
  v_exp_f32 v89, v89
  v_mfma_f32_16x16x32_bf16 v[140:143], v[160:163], a[204:207], v[140:143]
  s_waitcnt vmcnt(7) lgkmcnt(0)
  v_add_f32 v207, v207, v78
  v_fma_f32 v90, v90, s50, v206
  v_mfma_f32_16x16x32_bf16 v[156:159], v[164:167], a[204:207], v[156:159]
  s_barrier
  v_mfma_f32_16x16x32_bf16 v[128:131], v[168:171], a[208:211], v[128:131]
  ds_read_b64_tr_b16 v[160:161], v12 offset:49152
  s_add_u32 m0, s41, 24576
  v_mfma_f32_16x16x32_bf16 v[144:147], v[172:175], a[208:211], v[144:147]
  ds_read_b64_tr_b16 v[162:163], v12 offset:49664
  v_add_f32 v207, v207, v79
  v_mfma_f32_16x16x32_bf16 v[132:135], v[168:171], a[212:215], v[132:135]
  buffer_load_dwordx4 v3, s[12:15], s67 offen offset:0 lds
  v_mfma_f32_16x16x32_bf16 v[148:151], v[172:175], a[212:215], v[148:151]
  v_exp_f32 v90, v90
  v_mfma_f32_16x16x32_bf16 v[136:139], v[168:171], a[216:219], v[136:139]
  ds_read_b64_tr_b16 v[164:165], v12 offset:52224
  v_fma_f32 v91, v91, s50, v206
  v_mfma_f32_16x16x32_bf16 v[152:155], v[172:175], a[216:219], v[152:155]
  ds_read_b64_tr_b16 v[166:167], v12 offset:52736
  v_add_f32 v207, v207, v88
  v_mfma_f32_16x16x32_bf16 v[140:143], v[168:171], a[220:223], v[140:143]
  buffer_load_dwordx4 v3, s[12:15], s68 offen offset:1024 lds
  v_mfma_f32_16x16x32_bf16 v[156:159], v[172:175], a[220:223], v[156:159]
  v_exp_f32 v91, v91
  v_mfma_f32_16x16x32_bf16 v[128:131], v[176:179], a[224:227], v[128:131]
  ds_read_b64_tr_b16 v[168:169], v12 offset:50176
  v_fma_f32 v92, v92, s50, v206
  v_mfma_f32_16x16x32_bf16 v[144:147], v[180:183], a[224:227], v[144:147]
  ds_read_b64_tr_b16 v[170:171], v12 offset:50688
  v_add_f32 v207, v207, v89
  v_mfma_f32_16x16x32_bf16 v[132:135], v[176:179], a[228:231], v[132:135]
  buffer_load_dwordx4 v3, s[12:15], s69 offen offset:2048 lds
  v_mfma_f32_16x16x32_bf16 v[148:151], v[180:183], a[228:231], v[148:151]
  s_add_u32 m0, s41, 27648
  v_exp_f32 v92, v92
  v_mfma_f32_16x16x32_bf16 v[136:139], v[176:179], a[232:235], v[136:139]
  ds_read_b64_tr_b16 v[172:173], v12 offset:53248
  v_fma_f32 v93, v93, s50, v206
  v_mfma_f32_16x16x32_bf16 v[152:155], v[180:183], a[232:235], v[152:155]
  ds_read_b64_tr_b16 v[174:175], v12 offset:53760
  v_add_f32 v207, v207, v90
  v_mfma_f32_16x16x32_bf16 v[140:143], v[176:179], a[236:239], v[140:143]
  buffer_load_dwordx4 v3, s[16:19], s67 offen offset:0 lds
  v_mfma_f32_16x16x32_bf16 v[156:159], v[180:183], a[236:239], v[156:159]
  s_waitcnt lgkmcnt(4)
  v_exp_f32 v93, v93
  v_mfma_f32_16x16x32_bf16 v[96:99], v[160:163], a[240:243], v[96:99]
  ds_read_b64_tr_b16 v[176:177], v12 offset:51200
  v_fma_f32 v94, v94, s50, v206
  v_mfma_f32_16x16x32_bf16 v[112:115], v[164:167], a[240:243], v[112:115]
  ds_read_b64_tr_b16 v[178:179], v12 offset:51712
  v_add_f32 v207, v207, v91
  v_mfma_f32_16x16x32_bf16 v[100:103], v[160:163], a[244:247], v[100:103]
  buffer_load_dwordx4 v3, s[16:19], s68 offen offset:1024 lds
  v_mfma_f32_16x16x32_bf16 v[116:119], v[164:167], a[244:247], v[116:119]
  s_waitcnt lgkmcnt(2)
  v_exp_f32 v94, v94
  v_mfma_f32_16x16x32_bf16 v[104:107], v[160:163], a[248:251], v[104:107]
  ds_read_b64_tr_b16 v[180:181], v12 offset:54272
  v_fma_f32 v95, v95, s50, v206
  v_mfma_f32_16x16x32_bf16 v[120:123], v[164:167], a[248:251], v[120:123]
  ds_read_b64_tr_b16 v[182:183], v12 offset:54784
  v_add_f32 v207, v207, v92
  v_mfma_f32_16x16x32_bf16 v[108:111], v[160:163], a[252:255], v[108:111]
  buffer_load_dwordx4 v3, s[16:19], s69 offen offset:2048 lds
  v_mfma_f32_16x16x32_bf16 v[124:127], v[164:167], a[252:255], v[124:127]
  v_exp_f32 v95, v95
  v_mfma_f32_16x16x32_bf16 v[96:99], v[168:171], v[224:227], v[96:99]
  ds_read_b64_tr_b16 v[160:161], v13 offset:49152
  v_fma_f32 v204, v204, s50, v206
  v_mfma_f32_16x16x32_bf16 v[112:115], v[172:175], v[224:227], v[112:115]
  ds_read_b64_tr_b16 v[162:163], v13 offset:49664
  v_add_f32 v207, v207, v93
  v_mfma_f32_16x16x32_bf16 v[100:103], v[168:171], v[228:231], v[100:103]
  v_exp_f32 v204, v204
  v_mfma_f32_16x16x32_bf16 v[116:119], v[172:175], v[228:231], v[116:119]
  s_waitcnt lgkmcnt(2)
  v_fma_f32 v205, v205, s50, v206
  v_add_f32 v207, v207, v94
  v_mfma_f32_16x16x32_bf16 v[104:107], v[168:171], v[232:235], v[104:107]
  ds_read_b64_tr_b16 v[164:165], v13 offset:52224
  v_add_f32 v207, v207, v95
  v_mfma_f32_16x16x32_bf16 v[120:123], v[172:175], v[232:235], v[120:123]
  ds_read_b64_tr_b16 v[166:167], v13 offset:52736
  v_add_f32 v207, v207, v204
  v_mfma_f32_16x16x32_bf16 v[108:111], v[168:171], v[236:239], v[108:111]
  v_exp_f32 v205, v205
  v_mfma_f32_16x16x32_bf16 v[124:127], v[172:175], v[236:239], v[124:127]
  v_add_f32 v207, v207, v205
  v_mfma_f32_16x16x32_bf16 v[96:99], v[176:179], v[240:243], v[96:99]
  ds_read_b64_tr_b16 v[168:169], v13 offset:50176
  v_mfma_f32_16x16x32_bf16 v[112:115], v[180:183], v[240:243], v[112:115]
  ds_read_b64_tr_b16 v[170:171], v13 offset:50688
  v_mfma_f32_16x16x32_bf16 v[100:103], v[176:179], v[244:247], v[100:103]
  v_rcp_f32 v207, v207
  v_mfma_f32_16x16x32_bf16 v[116:119], v[180:183], v[244:247], v[116:119]
  s_waitcnt lgkmcnt(2)
  v_mul_f32 v72, v72, v207
  v_max_f32 v96, 0, v96
  v_mfma_f32_16x16x32_bf16 v[104:107], v[176:179], v[248:251], v[104:107]
  ds_read_b64_tr_b16 v[172:173], v13 offset:53248
  v_max_f32 v97, 0, v97
  v_mfma_f32_16x16x32_bf16 v[120:123], v[180:183], v[248:251], v[120:123]
  ds_read_b64_tr_b16 v[174:175], v13 offset:53760
  v_max_f32 v98, 0, v98
  v_mfma_f32_16x16x32_bf16 v[108:111], v[176:179], v[252:255], v[108:111]
  v_max_f32 v99, 0, v99
  v_mul_f32 v96, v96, v112
  v_mfma_f32_16x16x32_bf16 v[124:127], v[180:183], v[252:255], v[124:127]
  v_mul_f32 v97, v97, v113
  v_mul_f32 v98, v98, v114
  v_mfma_f32_16x16x32_bf16 v[128:131], v[160:163], a[240:243], v[128:131]
  ds_read_b64_tr_b16 v[176:177], v13 offset:51200
  v_mul_f32 v99, v99, v115
  v_mfma_f32_16x16x32_bf16 v[144:147], v[164:167], a[240:243], v[144:147]
  ds_read_b64_tr_b16 v[178:179], v13 offset:51712
  v_cvt_pk_bf16_f32 v4, v96, v97
  v_mfma_f32_16x16x32_bf16 v[132:135], v[160:163], a[244:247], v[132:135]
  ds_read_b64_tr_b16 v[180:181], v13 offset:54272
  v_cvt_pk_bf16_f32 v5, v98, v99
  v_mfma_f32_16x16x32_bf16 v[148:151], v[164:167], a[244:247], v[148:151]
  ds_read_b64_tr_b16 v[182:183], v13 offset:54784
  v_max_f32 v100, 0, v100
  v_mfma_f32_16x16x32_bf16 v[136:139], v[160:163], a[248:251], v[136:139]
  ds_write_b64 v16, v[4:5] offset:8192
  v_mfma_f32_16x16x32_bf16 v[152:155], v[164:167], a[248:251], v[152:155]
  v_max_f32 v101, 0, v101
  v_max_f32 v102, 0, v102
  v_mfma_f32_16x16x32_bf16 v[140:143], v[160:163], a[252:255], v[140:143]
  s_waitcnt vmcnt(7) lgkmcnt(1)
  v_max_f32 v103, 0, v103
  v_mul_f32 v100, v100, v116
  v_mfma_f32_16x16x32_bf16 v[156:159], v[164:167], a[252:255], v[156:159]
  s_barrier
  v_mfma_f32_16x16x32_bf16 v[128:131], v[168:171], v[224:227], v[128:131]
  ds_read_b64_tr_b16 v[160:161], v12 offset:0
  s_add_u32 m0, s41, 49152
  v_mfma_f32_16x16x32_bf16 v[144:147], v[172:175], v[224:227], v[144:147]
  ds_read_b64_tr_b16 v[162:163], v12 offset:512
  v_mul_f32 v101, v101, v117
  v_mfma_f32_16x16x32_bf16 v[132:135], v[168:171], v[228:231], v[132:135]
  buffer_load_dwordx4 v3, s[12:15], s70 offen offset:0 lds
  v_mfma_f32_16x16x32_bf16 v[148:151], v[172:175], v[228:231], v[148:151]
  v_mul_f32 v102, v102, v118
  v_mul_f32 v103, v103, v119
  v_mfma_f32_16x16x32_bf16 v[136:139], v[168:171], v[232:235], v[136:139]
  ds_read_b64_tr_b16 v[164:165], v12 offset:3072
  v_max_f32 v104, 0, v104
  v_mfma_f32_16x16x32_bf16 v[152:155], v[172:175], v[232:235], v[152:155]
  ds_read_b64_tr_b16 v[166:167], v12 offset:3584
  v_max_f32 v105, 0, v105
  v_mfma_f32_16x16x32_bf16 v[140:143], v[168:171], v[236:239], v[140:143]
  v_max_f32 v108, 0, v108
  v_cvt_pk_bf16_f32 v6, v100, v101
  v_mfma_f32_16x16x32_bf16 v[156:159], v[172:175], v[236:239], v[156:159]
  v_max_f32 v106, 0, v106
  v_max_f32 v109, 0, v109
  v_mfma_f32_16x16x32_bf16 v[128:131], v[176:179], v[240:243], v[128:131]
  ds_read_b64_tr_b16 v[168:169], v12 offset:1024
  v_max_f32 v107, 0, v107
  v_mfma_f32_16x16x32_bf16 v[144:147], v[180:183], v[240:243], v[144:147]
  ds_read_b64_tr_b16 v[170:171], v12 offset:1536
  v_max_f32 v110, 0, v110
  v_mfma_f32_16x16x32_bf16 v[132:135], v[176:179], v[244:247], v[132:135]
  buffer_load_dwordx4 v3, s[12:15], s71 offen offset:1024 lds
  v_mfma_f32_16x16x32_bf16 v[148:151], v[180:183], v[244:247], v[148:151]
  s_waitcnt lgkmcnt(2)
  v_mul_f32 v104, v104, v120
  v_max_f32 v111, 0, v111
  v_mfma_f32_16x16x32_bf16 v[136:139], v[176:179], v[248:251], v[136:139]
  ds_read_b64_tr_b16 v[172:173], v12 offset:4096
STUB4:
  s_cbranch_execz K1_back1
  v_mul_f32 v105, v105, v121
  v_mfma_f32_16x16x32_bf16 v[152:155], v[180:183], v[248:251], v[152:155]
  ds_read_b64_tr_b16 v[174:175], v12 offset:4608
  v_mul_f32 v106, v106, v122
  v_mfma_f32_16x16x32_bf16 v[140:143], v[176:179], v[252:255], v[140:143]
  v_mul_f32 v108, v108, v124
  v_mul_f32 v109, v109, v125
  v_mfma_f32_16x16x32_bf16 v[156:159], v[180:183], v[252:255], v[156:159]
  v_mul_f32 v107, v107, v123
  v_mul_f32 v110, v110, v126
  v_mfma_f32_16x16x32_bf16 v[96:99], v[160:163], a[0:3], 0
  ds_read_b64_tr_b16 v[176:177], v12 offset:2048
  v_cvt_pk_bf16_f32 v7, v102, v103
  v_mfma_f32_16x16x32_bf16 v[112:115], v[164:167], a[0:3], 0
  ds_read_b64_tr_b16 v[178:179], v12 offset:2560
  v_cvt_pk_bf16_f32 v8, v104, v105
  v_mfma_f32_16x16x32_bf16 v[100:103], v[160:163], a[4:7], 0
  ds_write_b64 v16, v[6:7] offset:9216
  v_mfma_f32_16x16x32_bf16 v[116:119], v[164:167], a[4:7], 0
  buffer_load_dwordx4 v3, s[12:15], s72 offen offset:2048 lds
  v_cvt_pk_bf16_f32 v9, v106, v107
  v_mfma_f32_16x16x32_bf16 v[104:107], v[160:163], a[8:11], 0
  ds_read_b64_tr_b16 v[180:181], v12 offset:5120
  s_add_u32 m0, s41, 52224
  v_mfma_f32_16x16x32_bf16 v[120:123], v[164:167], a[8:11], 0
  ds_read_b64_tr_b16 v[182:183], v12 offset:5632
  v_mul_f32 v111, v111, v127
  v_cvt_pk_bf16_f32 v10, v108, v109
  v_cvt_pk_bf16_f32 v11, v110, v111
  v_mfma_f32_16x16x32_bf16 v[108:111], v[160:163], a[12:15], 0
  ds_write_b64 v16, v[8:9] offset:10240
  v_mfma_f32_16x16x32_bf16 v[124:127], v[164:167], a[12:15], 0
  s_waitcnt lgkmcnt(6)
  v_max_f32 v128, 0, v128
  v_max_f32 v129, 0, v129
  v_mfma_f32_16x16x32_bf16 v[96:99], v[168:171], a[16:19], v[96:99]
  ds_read_b64_tr_b16 v[160:161], v13 offset:0
  v_max_f32 v130, 0, v130
  v_mfma_f32_16x16x32_bf16 v[112:115], v[172:175], a[16:19], v[112:115]
  ds_read_b64_tr_b16 v[162:163], v13 offset:512
  v_max_f32 v131, 0, v131
  v_mfma_f32_16x16x32_bf16 v[100:103], v[168:171], a[20:23], v[100:103]
  ds_write_b64 v16, v[10:11] offset:11264
  v_mfma_f32_16x16x32_bf16 v[116:119], v[172:175], a[20:23], v[116:119]
  buffer_load_dwordx4 v3, s[16:19], s70 offen offset:0 lds
  v_mfma_f32_16x16x32_bf16 v[104:107], v[168:171], a[24:27], v[104:107]
  ds_read_b64_tr_b16 v[164:165], v13 offset:3072
  v_max_f32 v132, 0, v132
  v_mfma_f32_16x16x32_bf16 v[120:123], v[172:175], a[24:27], v[120:123]
  ds_read_b64_tr_b16 v[166:167], v13 offset:3584
  v_max_f32 v133, 0, v133
  v_mfma_f32_16x16x32_bf16 v[108:111], v[168:171], a[28:31], v[108:111]
  s_waitcnt lgkmcnt(6)
  v_mul_f32 v128, v128, v144
  v_max_f32 v134, 0, v134
  v_mfma_f32_16x16x32_bf16 v[124:127], v[172:175], a[28:31], v[124:127]
  v_max_f32 v135, 0, v135
  v_max_f32 v136, 0, v136
  v_mfma_f32_16x16x32_bf16 v[96:99], v[176:179], a[32:35], v[96:99]
  ds_read_b64_tr_b16 v[168:169], v13 offset:1024
  v_mul_f32 v129, v129, v145
  v_mfma_f32_16x16x32_bf16 v[112:115], v[180:183], a[32:35], v[112:115]
  ds_read_b64_tr_b16 v[170:171], v13 offset:1536
  v_mul_f32 v130, v130, v146
  v_mfma_f32_16x16x32_bf16 v[100:103], v[176:179], a[36:39], v[100:103]
  buffer_load_dwordx4 v3, s[16:19], s71 offen offset:1024 lds
  v_mfma_f32_16x16x32_bf16 v[116:119], v[180:183], a[36:39], v[116:119]
  s_waitcnt lgkmcnt(2)
  v_mul_f32 v131, v131, v147
  v_mul_f32 v132, v132, v148
  v_mfma_f32_16x16x32_bf16 v[104:107], v[176:179], a[40:43], v[104:107]
  ds_read_b64_tr_b16 v[172:173], v13 offset:4096
  v_cvt_pk_bf16_f32 v4, v128, v129
  v_mfma_f32_16x16x32_bf16 v[120:123], v[180:183], a[40:43], v[120:123]
  ds_read_b64_tr_b16 v[174:175], v13 offset:4608
  v_mul_f32 v133, v133, v149
  v_mfma_f32_16x16x32_bf16 v[108:111], v[176:179], a[44:47], v[108:111]
  buffer_load_dwordx4 v3, s[16:19], s72 offen offset:2048 lds
  v_mfma_f32_16x16x32_bf16 v[124:127], v[180:183], a[44:47], v[124:127]
  v_cvt_pk_bf16_f32 v5, v130, v131
  v_mul_f32 v134, v134, v150
  v_mfma_f32_16x16x32_bf16 v[128:131], v[160:163], a[0:3], 0
  ds_read_b64_tr_b16 v[176:177], v13 offset:2048
  v_mul_f32 v135, v135, v151
  v_mfma_f32_16x16x32_bf16 v[144:147], v[164:167], a[0:3], 0
  ds_read_b64_tr_b16 v[178:179], v13 offset:2560
  v_cvt_pk_bf16_f32 v6, v132, v133
  v_cvt_pk_bf16_f32 v7, v134, v135
  v_mfma_f32_16x16x32_bf16 v[132:135], v[160:163], a[4:7], 0
  ds_read_b64_tr_b16 v[180:181], v13 offset:5120
  v_max_f32 v137, 0, v137
  v_mfma_f32_16x16x32_bf16 v[148:151], v[164:167], a[4:7], 0
  ds_read_b64_tr_b16 v[182:183], v13 offset:5632
  v_max_f32 v138, 0, v138
  v_max_f32 v139, 0, v139
  v_mul_f32 v136, v136, v152
  v_mul_f32 v137, v137, v153
  v_mul_f32 v138, v138, v154
  v_mul_f32 v139, v139, v155
  v_cvt_pk_bf16_f32 v8, v136, v137
  v_cvt_pk_bf16_f32 v9, v138, v139
  v_mfma_f32_16x16x32_bf16 v[136:139], v[160:163], a[8:11], 0
  ds_write_b64 v16, v[4:5] offset:16384
  v_mfma_f32_16x16x32_bf16 v[152:155], v[164:167], a[8:11], 0
  v_max_f32 v140, 0, v140
  v_max_f32 v141, 0, v141
  v_max_f32 v142, 0, v142
  v_max_f32 v143, 0, v143
  v_mul_f32 v140, v140, v156
  v_mul_f32 v141, v141, v157
  v_mul_f32 v142, v142, v158
  v_mul_f32 v143, v143, v159
  v_cvt_pk_bf16_f32 v10, v140, v141
  v_cvt_pk_bf16_f32 v11, v142, v143
  v_mfma_f32_16x16x32_bf16 v[140:143], v[160:163], a[12:15], 0
  s_waitcnt vmcnt(6) lgkmcnt(1)
  v_mul_f32 v73, v73, v207
  v_mul_f32 v74, v74, v207
  v_mfma_f32_16x16x32_bf16 v[156:159], v[164:167], a[12:15], 0
  s_barrier
  v_mfma_f32_16x16x32_bf16 v[128:131], v[168:171], a[16:19], v[128:131]
  ds_read_b64_tr_b16 v[160:161], v12 offset:24576
  s_add_u32 m0, s41, 0
  v_mfma_f32_16x16x32_bf16 v[144:147], v[172:175], a[16:19], v[144:147]
  ds_read_b64_tr_b16 v[162:163], v12 offset:25088
  v_mul_f32 v75, v75, v207
  v_mfma_f32_16x16x32_bf16 v[132:135], v[168:171], a[20:23], v[132:135]
  ds_write_b64 v16, v[6:7] offset:17408
  v_mfma_f32_16x16x32_bf16 v[148:151], v[172:175], a[20:23], v[148:151]
  buffer_load_dwordx4 v3, s[12:15], s73 offen offset:0 lds
  v_mfma_f32_16x16x32_bf16 v[136:139], v[168:171], a[24:27], v[136:139]
  ds_read_b64_tr_b16 v[164:165], v12 offset:27648
  v_mul_f32 v76, v76, v207
  v_mfma_f32_16x16x32_bf16 v[152:155], v[172:175], a[24:27], v[152:155]
  ds_read_b64_tr_b16 v[166:167], v12 offset:28160
  v_mul_f32 v77, v77, v207
  v_mfma_f32_16x16x32_bf16 v[140:143], v[168:171], a[28:31], v[140:143]
  ds_write_b64 v16, v[8:9] offset:18432
  v_mfma_f32_16x16x32_bf16 v[156:159], v[172:175], a[28:31], v[156:159]
  buffer_load_dwordx4 v3, s[12:15], s74 offen offset:1024 lds
  v_mfma_f32_16x16x32_bf16 v[128:131], v[176:179], a[32:35], v[128:131]
  ds_read_b64_tr_b16 v[168:169], v12 offset:25600
  v_mul_f32 v78, v78, v207
  v_mfma_f32_16x16x32_bf16 v[144:147], v[180:183], a[32:35], v[144:147]
  ds_read_b64_tr_b16 v[170:171], v12 offset:26112
  v_mul_f32 v79, v79, v207
  v_mfma_f32_16x16x32_bf16 v[132:135], v[176:179], a[36:39], v[132:135]
  ds_write_b64 v16, v[10:11] offset:19456
  v_mfma_f32_16x16x32_bf16 v[148:151], v[180:183], a[36:39], v[148:151]
  buffer_load_dwordx4 v3, s[12:15], s75 offen offset:2048 lds
  v_mfma_f32_16x16x32_bf16 v[136:139], v[176:179], a[40:43], v[136:139]
  ds_read_b64_tr_b16 v[172:173], v12 offset:28672
  s_add_u32 m0, s41, 3072
  v_mfma_f32_16x16x32_bf16 v[152:155], v[180:183], a[40:43], v[152:155]
  ds_read_b64_tr_b16 v[174:175], v12 offset:29184
  v_mul_f32 v88, v88, v207
  v_mfma_f32_16x16x32_bf16 v[140:143], v[176:179], a[44:47], v[140:143]
  buffer_load_dwordx4 v3, s[16:19], s73 offen offset:0 lds
  v_mfma_f32_16x16x32_bf16 v[156:159], v[180:183], a[44:47], v[156:159]
  s_waitcnt lgkmcnt(6)
  v_mul_f32 v89, v89, v207
  v_mul_f32 v90, v90, v207
  v_mfma_f32_16x16x32_bf16 v[96:99], v[160:163], a[48:51], v[96:99]
  ds_read_b64_tr_b16 v[176:177], v12 offset:26624
  v_mul_f32 v91, v91, v207
  v_mfma_f32_16x16x32_bf16 v[112:115], v[164:167], a[48:51], v[112:115]
  ds_read_b64_tr_b16 v[178:179], v12 offset:27136
  v_mul_f32 v92, v92, v207
  v_mfma_f32_16x16x32_bf16 v[100:103], v[160:163], a[52:55], v[100:103]
  buffer_load_dwordx4 v3, s[16:19], s74 offen offset:1024 lds
  v_mfma_f32_16x16x32_bf16 v[116:119], v[164:167], a[52:55], v[116:119]
  s_waitcnt lgkmcnt(2)
  v_mul_f32 v93, v93, v207
  v_mul_f32 v94, v94, v207
  v_mfma_f32_16x16x32_bf16 v[104:107], v[160:163], a[56:59], v[104:107]
  ds_read_b64_tr_b16 v[180:181], v12 offset:29696
  v_mul_f32 v95, v95, v207
  v_mfma_f32_16x16x32_bf16 v[120:123], v[164:167], a[56:59], v[120:123]
  ds_read_b64_tr_b16 v[182:183], v12 offset:30208
  v_mul_f32 v204, v204, v207
  v_mfma_f32_16x16x32_bf16 v[108:111], v[160:163], a[60:63], v[108:111]
  buffer_load_dwordx4 v3, s[16:19], s75 offen offset:2048 lds
  v_mfma_f32_16x16x32_bf16 v[124:127], v[164:167], a[60:63], v[124:127]
  buffer_load_dword v29, v28, s[8:11], s98 offen
  v_mfma_f32_16x16x32_bf16 v[96:99], v[168:171], a[64:67], v[96:99]
  ds_read_b64_tr_b16 v[160:161], v13 offset:24576
  s_add_u32 s98, s98, 114688
  v_mfma_f32_16x16x32_bf16 v[112:115], v[172:175], a[64:67], v[112:115]
  ds_read_b64_tr_b16 v[162:163], v13 offset:25088
  v_mul_f32 v205, v205, v207
  v_mfma_f32_16x16x32_bf16 v[100:103], v[168:171], a[68:71], v[100:103]
  v_cvt_pk_bf16_f32 v72, v72, v73
  v_cvt_pk_bf16_f32 v73, v74, v75
  v_mfma_f32_16x16x32_bf16 v[116:119], v[172:175], a[68:71], v[116:119]
  s_waitcnt lgkmcnt(2)
  v_cvt_pk_bf16_f32 v74, v76, v77
  v_cvt_pk_bf16_f32 v75, v78, v79
  v_mfma_f32_16x16x32_bf16 v[104:107], v[168:171], a[72:75], v[104:107]
  ds_read_b64_tr_b16 v[164:165], v13 offset:27648
  v_cvt_pk_bf16_f32 v76, v88, v89
  v_mfma_f32_16x16x32_bf16 v[120:123], v[172:175], a[72:75], v[120:123]
  ds_read_b64_tr_b16 v[166:167], v13 offset:28160
  v_cvt_pk_bf16_f32 v77, v90, v91
  v_mfma_f32_16x16x32_bf16 v[108:111], v[168:171], a[76:79], v[108:111]
  ds_write_b128 v18, v[72:75] offset:5120
  v_mfma_f32_16x16x32_bf16 v[124:127], v[172:175], a[76:79], v[124:127]
  v_cvt_pk_bf16_f32 v78, v92, v93
  v_cvt_pk_bf16_f32 v79, v94, v95
  v_mfma_f32_16x16x32_bf16 v[96:99], v[176:179], a[80:83], v[96:99]
  ds_read_b64_tr_b16 v[168:169], v13 offset:25600
  v_cvt_pk_bf16_f32 v70, v204, v205
  v_mfma_f32_16x16x32_bf16 v[112:115], v[180:183], a[80:83], v[112:115]
  ds_read_b64_tr_b16 v[170:171], v13 offset:26112
  v_mov_b32 v71, 0
  v_mfma_f32_16x16x32_bf16 v[100:103], v[176:179], a[84:87], v[100:103]
  ds_write_b128 v18, v[76:79] offset:5136
  v_mfma_f32_16x16x32_bf16 v[116:119], v[180:183], a[84:87], v[116:119]
  s_waitcnt lgkmcnt(4)
  v_mfma_f32_16x16x32_bf16 v[104:107], v[176:179], a[88:91], v[104:107]
  ds_read_b64_tr_b16 v[172:173], v13 offset:28672
  v_mfma_f32_16x16x32_bf16 v[120:123], v[180:183], a[88:91], v[120:123]
  ds_read_b64_tr_b16 v[174:175], v13 offset:29184
  v_mfma_f32_16x16x32_bf16 v[108:111], v[176:179], a[92:95], v[108:111]
  ds_write_b64 v18, v[70:71] offset:5152
  v_mfma_f32_16x16x32_bf16 v[124:127], v[180:183], a[92:95], v[124:127]
  ds_read_b128 v[184:187], v27 offset:0
  v_mfma_f32_16x16x32_bf16 v[128:131], v[160:163], a[48:51], v[128:131]
  ds_read_b64_tr_b16 v[176:177], v13 offset:26624
  v_mfma_f32_16x16x32_bf16 v[144:147], v[164:167], a[48:51], v[144:147]
  ds_read_b64_tr_b16 v[178:179], v13 offset:27136
  v_mfma_f32_16x16x32_bf16 v[132:135], v[160:163], a[52:55], v[132:135]
  ds_read_b64_tr_b16 v[180:181], v13 offset:29696
  v_mfma_f32_16x16x32_bf16 v[148:151], v[164:167], a[52:55], v[148:151]
  ds_read_b64_tr_b16 v[182:183], v13 offset:30208
  v_mfma_f32_16x16x32_bf16 v[136:139], v[160:163], a[56:59], v[136:139]
  ds_read_b128 v[188:191], v2 offset:0
  v_mfma_f32_16x16x32_bf16 v[152:155], v[164:167], a[56:59], v[152:155]
  s_waitcnt lgkmcnt(5)
  v_mfma_f32_16x16x32_bf16 v[40:43], v[184:187], v[32:35], 0
  v_mfma_f32_16x16x32_bf16 v[72:75], v[184:187], v[64:67], 0
  ds_read_b128 v[184:187], v27 offset:2048
  v_mfma_f32_16x16x32_bf16 v[140:143], v[160:163], a[60:63], v[140:143]
  s_waitcnt vmcnt(7) lgkmcnt(2)
  v_mfma_f32_16x16x32_bf16 v[156:159], v[164:167], a[60:63], v[156:159]
  s_barrier
  v_mfma_f32_16x16x32_bf16 v[128:131], v[168:171], a[64:67], v[128:131]
  ds_read_b64_tr_b16 v[160:161], v12 offset:49152
  s_add_u32 m0, s41, 24576
  s_waitcnt lgkmcnt(2)
  v_mfma_f32_16x16x32_bf16 v[40:43], v[188:191], v[48:51], v[40:43]
  s_add_u32 s49, s39, 81920
  v_add_u32 v4, s49, v1
  s_add_u32 s49, s100, 8192
  v_mfma_f32_16x16x32_bf16 v[72:75], v[188:191], v[80:83], v[72:75]
  ds_read_b128 v[8:11], v4 offset:1024
  v_mfma_f32_16x16x32_bf16 v[144:147], v[172:175], a[64:67], v[144:147]
  ds_read_b64_tr_b16 v[162:163], v12 offset:49664
  s_waitcnt lgkmcnt(3)
  v_mfma_f32_16x16x32_bf16 v[44:47], v[184:187], v[32:35], 0
  ds_read_b128 v[4:7], v4
  v_mfma_f32_16x16x32_bf16 v[76:79], v[184:187], v[64:67], 0
  ds_read_b64_tr_b16 v[208:209], v21 offset:96
  v_mfma_f32_16x16x32_bf16 v[132:135], v[168:171], a[68:71], v[132:135]
  buffer_load_dwordx4 v3, s[12:15], s76 offen offset:0 lds
  v_mfma_f32_16x16x32_bf16 v[148:151], v[172:175], a[68:71], v[148:151]
  ds_read_b64_tr_b16 v[210:211], v21 offset:2656
  v_mfma_f32_16x16x32_bf16 v[136:139], v[168:171], a[72:75], v[136:139]
  ds_read_b64_tr_b16 v[164:165], v12 offset:52224
  v_mfma_f32_16x16x32_bf16 v[152:155], v[172:175], a[72:75], v[152:155]
  ds_read_b64_tr_b16 v[166:167], v12 offset:52736
  v_mfma_f32_16x16x32_bf16 v[140:143], v[168:171], a[76:79], v[140:143]
  buffer_load_dwordx4 v3, s[12:15], s77 offen offset:1024 lds
  v_mfma_f32_16x16x32_bf16 v[156:159], v[172:175], a[76:79], v[156:159]
  ds_read_b64_tr_b16 v[192:193], v19 offset:0
  v_mfma_f32_16x16x32_bf16 v[128:131], v[176:179], a[80:83], v[128:131]
  ds_read_b64_tr_b16 v[168:169], v12 offset:50176
  v_mfma_f32_16x16x32_bf16 v[144:147], v[180:183], a[80:83], v[144:147]
  ds_read_b64_tr_b16 v[170:171], v12 offset:50688
  v_mfma_f32_16x16x32_bf16 v[132:135], v[176:179], a[84:87], v[132:135]
  buffer_load_dwordx4 v3, s[12:15], s78 offen offset:2048 lds
  v_mfma_f32_16x16x32_bf16 v[148:151], v[180:183], a[84:87], v[148:151]
  s_add_u32 m0, s41, 27648
  ds_read_b64_tr_b16 v[194:195], v19 offset:2560
  v_mfma_f32_16x16x32_bf16 v[136:139], v[176:179], a[88:91], v[136:139]
  ds_read_b64_tr_b16 v[172:173], v12 offset:53248
  v_mfma_f32_16x16x32_bf16 v[152:155], v[180:183], a[88:91], v[152:155]
  ds_read_b64_tr_b16 v[174:175], v12 offset:53760
  v_mfma_f32_16x16x32_bf16 v[140:143], v[176:179], a[92:95], v[140:143]
  buffer_load_dwordx4 v3, s[16:19], s76 offen offset:0 lds
  v_mfma_f32_16x16x32_bf16 v[156:159], v[180:183], a[92:95], v[156:159]
  ds_read_b64_tr_b16 v[196:197], v19 offset:48
  s_waitcnt lgkmcnt(7)
  v_mfma_f32_16x16x32_bf16 v[96:99], v[160:163], a[96:99], v[96:99]
  ds_read_b64_tr_b16 v[176:177], v12 offset:51200
  v_mfma_f32_16x16x32_bf16 v[112:115], v[164:167], a[96:99], v[112:115]
  ds_read_b64_tr_b16 v[178:179], v12 offset:51712
  s_waitcnt lgkmcnt(5)
  v_mfma_f32_16x16x32_bf16 v[212:215], v[192:195], v[208:211], 0
  ds_read_b64_tr_b16 v[198:199], v19 offset:2608
  v_mfma_f32_16x16x32_bf16 v[100:103], v[160:163], a[100:103], v[100:103]
  buffer_load_dwordx4 v3, s[16:19], s77 offen offset:1024 lds
  v_mfma_f32_16x16x32_bf16 v[116:119], v[164:167], a[100:103], v[116:119]
  ds_read_b64_tr_b16 v[192:193], v20 offset:32
  v_mfma_f32_16x16x32_bf16 v[104:107], v[160:163], a[104:107], v[104:107]
  ds_read_b64_tr_b16 v[180:181], v12 offset:54272
  v_mfma_f32_16x16x32_bf16 v[120:123], v[164:167], a[104:107], v[120:123]
  ds_read_b64_tr_b16 v[182:183], v12 offset:54784
  v_mfma_f32_16x16x32_bf16 v[108:111], v[160:163], a[108:111], v[108:111]
  buffer_load_dwordx4 v3, s[16:19], s78 offen offset:2048 lds
  v_mfma_f32_16x16x32_bf16 v[124:127], v[164:167], a[108:111], v[124:127]
  ds_read_b64_tr_b16 v[194:195], v20 offset:2592
  s_waitcnt lgkmcnt(8)
  s_waitcnt lgkmcnt(4)
  v_mfma_f32_16x16x32_bf16 v[216:219], v[196:199], v[208:211], 0
  buffer_store_dwordx4 v[8:11], v1, s[4:7], s49 offen offset:1024 sc1
  v_mfma_f32_16x16x32_bf16 v[96:99], v[168:171], a[112:115], v[96:99]
  ds_read_b64_tr_b16 v[160:161], v13 offset:49152
  v_mfma_f32_16x16x32_bf16 v[112:115], v[172:175], a[112:115], v[112:115]
  ds_read_b64_tr_b16 v[162:163], v13 offset:49664
  v_mfma_f32_16x16x32_bf16 v[100:103], v[168:171], a[116:119], v[100:103]
  buffer_store_dwordx4 v[4:7], v1, s[4:7], s49 offen sc1
  v_mfma_f32_16x16x32_bf16 v[116:119], v[172:175], a[116:119], v[116:119]
  ds_read_b64_tr_b16 v[196:197], v19 offset:5120
  s_add_u32 s49, s39, 90112
  v_mfma_f32_16x16x32_bf16 v[104:107], v[168:171], a[120:123], v[104:107]
  ds_read_b64_tr_b16 v[164:165], v13 offset:52224
  v_add_u32 v4, s49, v1
  s_waitcnt lgkmcnt(4)
  v_mfma_f32_16x16x32_bf16 v[220:223], v[192:195], v[208:211], 0
  ds_read_b128 v[8:11], v4 offset:1024
  s_add_u32 s49, s100, 16384
  v_mfma_f32_16x16x32_bf16 v[120:123], v[172:175], a[120:123], v[120:123]
  ds_read_b64_tr_b16 v[166:167], v13 offset:52736
  v_mfma_f32_16x16x32_bf16 v[108:111], v[168:171], a[124:127], v[108:111]
  ds_read_b128 v[4:7], v4
  v_mfma_f32_16x16x32_bf16 v[124:127], v[172:175], a[124:127], v[124:127]
  ds_read_b64_tr_b16 v[208:209], v21 offset:5216
  v_mfma_f32_16x16x32_bf16 v[96:99], v[176:179], a[128:131], v[96:99]
  ds_read_b64_tr_b16 v[168:169], v13 offset:50176
  v_mfma_f32_16x16x32_bf16 v[112:115], v[180:183], a[128:131], v[112:115]
  ds_read_b64_tr_b16 v[170:171], v13 offset:50688
  v_mfma_f32_16x16x32_bf16 v[100:103], v[176:179], a[132:135], v[100:103]
  s_waitcnt lgkmcnt(5)
  buffer_store_dwordx4 v[8:11], v1, s[4:7], s49 offen offset:1024 sc1
  v_mfma_f32_16x16x32_bf16 v[116:119], v[180:183], a[132:135], v[116:119]
  ds_read_b64_tr_b16 v[210:211], v21 offset:7776
  v_mfma_f32_16x16x32_bf16 v[104:107], v[176:179], a[136:139], v[104:107]
  ds_read_b64_tr_b16 v[172:173], v13 offset:53248
  v_mfma_f32_16x16x32_bf16 v[120:123], v[180:183], a[136:139], v[120:123]
  ds_read_b64_tr_b16 v[174:175], v13 offset:53760
  v_mfma_f32_16x16x32_bf16 v[108:111], v[176:179], a[140:143], v[108:111]
  s_waitcnt lgkmcnt(6)
  buffer_store_dwordx4 v[4:7], v1, s[4:7], s49 offen sc1
  v_mfma_f32_16x16x32_bf16 v[124:127], v[180:183], a[140:143], v[124:127]
  ds_read_b64_tr_b16 v[198:199], v19 offset:7680
  v_mfma_f32_16x16x32_bf16 v[128:131], v[160:163], a[96:99], v[128:131]
  ds_read_b64_tr_b16 v[176:177], v13 offset:51200
  v_mfma_f32_16x16x32_bf16 v[144:147], v[164:167], a[96:99], v[144:147]
  ds_read_b64_tr_b16 v[178:179], v13 offset:51712
  v_mfma_f32_16x16x32_bf16 v[132:135], v[160:163], a[100:103], v[132:135]
  ds_read_b64_tr_b16 v[180:181], v13 offset:54272
  v_mfma_f32_16x16x32_bf16 v[148:151], v[164:167], a[100:103], v[148:151]
  ds_read_b64_tr_b16 v[182:183], v13 offset:54784
  v_mfma_f32_16x16x32_bf16 v[136:139], v[160:163], a[104:107], v[136:139]
  ds_read_b64_tr_b16 v[192:193], v19 offset:5168
  v_mfma_f32_16x16x32_bf16 v[152:155], v[164:167], a[104:107], v[152:155]
  ds_read_b64_tr_b16 v[194:195], v19 offset:7728
  s_waitcnt lgkmcnt(6)
  v_mfma_f32_16x16x32_bf16 v[212:215], v[196:199], v[208:211], v[212:215]
  ds_read_b64_tr_b16 v[196:197], v20 offset:5152
  v_mfma_f32_16x16x32_bf16 v[140:143], v[160:163], a[108:111], v[140:143]
  s_waitcnt vmcnt(11) lgkmcnt(3)
  ds_read_b64_tr_b16 v[198:199], v20 offset:7712
  v_mfma_f32_16x16x32_bf16 v[156:159], v[164:167], a[108:111], v[156:159]
  s_barrier
  v_mfma_f32_16x16x32_bf16 v[128:131], v[168:171], a[112:115], v[128:131]
  ds_read_b64_tr_b16 v[160:161], v12 offset:0
  s_add_u32 m0, s41, 49152
  v_mfma_f32_16x16x32_bf16 v[144:147], v[172:175], a[112:115], v[144:147]
  ds_read_b64_tr_b16 v[162:163], v12 offset:512
  v_mfma_f32_16x16x32_bf16 v[132:135], v[168:171], a[116:119], v[132:135]
  buffer_load_dwordx4 v3, s[12:15], s79 offen offset:0 lds
  s_waitcnt lgkmcnt(4)
  v_mfma_f32_16x16x32_bf16 v[216:219], v[192:195], v[208:211], v[216:219]
  ds_read_b64_tr_b16 v[192:193], v19 offset:10240
  s_mov_b32 vcc_lo, -1
  v_mfma_f32_16x16x32_bf16 v[148:151], v[172:175], a[116:119], v[148:151]
  buffer_load_dwordx4 v3, s[12:15], s80 offen offset:1024 lds
  s_waitcnt lgkmcnt(3)
  v_mfma_f32_16x16x32_bf16 v[220:223], v[196:199], v[208:211], v[220:223]
  ds_read_b64_tr_b16 v[208:209], v21 offset:10336
  s_mov_b32 vcc_hi, 0
  v_mfma_f32_16x16x32_bf16 v[136:139], v[168:171], a[120:123], v[136:139]
  ds_read_b64_tr_b16 v[164:165], v12 offset:3072
  v_mfma_f32_16x16x32_bf16 v[152:155], v[172:175], a[120:123], v[152:155]
  ds_read_b64_tr_b16 v[166:167], v12 offset:3584
  v_mfma_f32_16x16x32_bf16 v[140:143], v[168:171], a[124:127], v[140:143]
  ds_read_b64_tr_b16 v[210:211], v21 offset:12896
  v_mfma_f32_16x16x32_bf16 v[156:159], v[172:175], a[124:127], v[156:159]
  ds_read_b64_tr_b16 v[194:195], v19 offset:12800
  v_mfma_f32_16x16x32_bf16 v[128:131], v[176:179], a[128:131], v[128:131]
  ds_read_b64_tr_b16 v[168:169], v12 offset:1024
  v_mfma_f32_16x16x32_bf16 v[144:147], v[180:183], a[128:131], v[144:147]
  ds_read_b64_tr_b16 v[170:171], v12 offset:1536
  v_mfma_f32_16x16x32_bf16 v[132:135], v[176:179], a[132:135], v[132:135]
  buffer_load_dwordx4 v3, s[12:15], s81 offen offset:2048 lds
  v_mfma_f32_16x16x32_bf16 v[148:151], v[180:183], a[132:135], v[148:151]
  s_add_u32 m0, s41, 52224
  ds_read_b64_tr_b16 v[196:197], v19 offset:10288
  v_mfma_f32_16x16x32_bf16 v[136:139], v[176:179], a[136:139], v[136:139]
  ds_read_b64_tr_b16 v[172:173], v12 offset:4096
  v_mfma_f32_16x16x32_bf16 v[152:155], v[180:183], a[136:139], v[152:155]
  ds_read_b64_tr_b16 v[174:175], v12 offset:4608
  s_waitcnt lgkmcnt(5)
  v_mfma_f32_16x16x32_bf16 v[212:215], v[192:195], v[208:211], v[212:215]
  ds_read_b64_tr_b16 v[198:199], v19 offset:12848
  v_mfma_f32_16x16x32_bf16 v[140:143], v[176:179], a[140:143], v[140:143]
  buffer_load_dwordx4 v3, s[16:19], s79 offen offset:0 lds
  v_mfma_f32_16x16x32_bf16 v[156:159], v[180:183], a[140:143], v[156:159]
  ds_read_b64_tr_b16 v[192:193], v20 offset:10272
  v_mfma_f32_16x16x32_bf16 v[96:99], v[160:163], a[144:147], v[96:99]
  ds_read_b64_tr_b16 v[176:177], v12 offset:2048
  v_mfma_f32_16x16x32_bf16 v[112:115], v[164:167], a[144:147], v[112:115]
  ds_read_b64_tr_b16 v[178:179], v12 offset:2560
  v_mfma_f32_16x16x32_bf16 v[100:103], v[160:163], a[148:151], v[100:103]
  buffer_load_dwordx4 v3, s[16:19], s80 offen offset:1024 lds
  v_mfma_f32_16x16x32_bf16 v[116:119], v[164:167], a[148:151], v[116:119]
  ds_read_b64_tr_b16 v[194:195], v20 offset:12832
  s_waitcnt lgkmcnt(4)
  v_mfma_f32_16x16x32_bf16 v[216:219], v[196:199], v[208:211], v[216:219]
  ds_read_b64_tr_b16 v[196:197], v19 offset:15360
  v_mfma_f32_16x16x32_bf16 v[104:107], v[160:163], a[152:155], v[104:107]
  ds_read_b64_tr_b16 v[180:181], v12 offset:5120
  v_mfma_f32_16x16x32_bf16 v[120:123], v[164:167], a[152:155], v[120:123]
  ds_read_b64_tr_b16 v[182:183], v12 offset:5632
  v_mfma_f32_16x16x32_bf16 v[108:111], v[160:163], a[156:159], v[108:111]
  buffer_load_dwordx4 v3, s[16:19], s81 offen offset:2048 lds
  v_mfma_f32_16x16x32_bf16 v[124:127], v[164:167], a[156:159], v[124:127]
  ds_read_b64_tr_b16 v[198:199], v19 offset:17920
  v_mfma_f32_16x16x32_bf16 v[96:99], v[168:171], a[160:163], v[96:99]
  ds_read_b64_tr_b16 v[160:161], v13 offset:0
  s_waitcnt lgkmcnt(5)
  v_mfma_f32_16x16x32_bf16 v[220:223], v[192:195], v[208:211], v[220:223]
  ds_read_b64_tr_b16 v[208:209], v21 offset:15456
  v_mfma_f32_16x16x32_bf16 v[112:115], v[172:175], a[160:163], v[112:115]
  ds_read_b64_tr_b16 v[162:163], v13 offset:512
  v_mfma_f32_16x16x32_bf16 v[100:103], v[168:171], a[164:167], v[100:103]
  ds_read_b64_tr_b16 v[210:211], v21 offset:18016
  v_mfma_f32_16x16x32_bf16 v[116:119], v[172:175], a[164:167], v[116:119]
  ds_read_b64_tr_b16 v[192:193], v19 offset:15408
  v_mfma_f32_16x16x32_bf16 v[104:107], v[168:171], a[168:171], v[104:107]
  ds_read_b64_tr_b16 v[164:165], v13 offset:3072
  v_mfma_f32_16x16x32_bf16 v[120:123], v[172:175], a[168:171], v[120:123]
  ds_read_b64_tr_b16 v[166:167], v13 offset:3584
  v_mfma_f32_16x16x32_bf16 v[108:111], v[168:171], a[172:175], v[108:111]
  ds_read_b64_tr_b16 v[194:195], v19 offset:17968
  v_mfma_f32_16x16x32_bf16 v[124:127], v[172:175], a[172:175], v[124:127]
  ds_read_b128 v[188:191], v2 offset:2048
  s_waitcnt lgkmcnt(10)
  v_mfma_f32_16x16x32_bf16 v[96:99], v[176:179], a[176:179], v[96:99]
  ds_read_b64_tr_b16 v[168:169], v13 offset:1024
  s_waitcnt lgkmcnt(6)
  v_mfma_f32_16x16x32_bf16 v[212:215], v[196:199], v[208:211], v[212:215]
  ds_read_b64_tr_b16 v[196:197], v20 offset:15392
  v_mfma_f32_16x16x32_bf16 v[112:115], v[180:183], a[176:179], v[112:115]
  ds_read_b64_tr_b16 v[170:171], v13 offset:1536
  v_mfma_f32_16x16x32_bf16 v[100:103], v[176:179], a[180:183], v[100:103]
  ds_read_b64_tr_b16 v[198:199], v20 offset:17952
  v_mfma_f32_16x16x32_bf16 v[116:119], v[180:183], a[180:183], v[116:119]
  ds_read_b128 v[184:187], v27 offset:4096
  s_waitcnt lgkmcnt(6)
  v_mfma_f32_16x16x32_bf16 v[216:219], v[192:195], v[208:211], v[216:219]
  v_cvt_pk_bf16_f32 v212, v212, v213
  v_cvt_pk_bf16_f32 v213, v214, v215
  s_waitcnt lgkmcnt(5)
  v_mfma_f32_16x16x32_bf16 v[44:47], v[188:191], v[48:51], v[44:47]
  buffer_store_dwordx2 v[212:213], v22, s[4:7], s52 offen offset:0 sc1
  v_mfma_f32_16x16x32_bf16 v[76:79], v[188:191], v[80:83], v[76:79]
  ds_read_b128 v[188:191], v2 offset:4096
  v_mfma_f32_16x16x32_bf16 v[104:107], v[176:179], a[184:187], v[104:107]
  ds_read_b64_tr_b16 v[172:173], v13 offset:4096
  v_cvt_pk_bf16_f32 v216, v216, v217
  v_mfma_f32_16x16x32_bf16 v[120:123], v[180:183], a[184:187], v[120:123]
  ds_read_b64_tr_b16 v[174:175], v13 offset:4608
  v_cvt_pk_bf16_f32 v217, v218, v219
  s_waitcnt lgkmcnt(4)
  v_mfma_f32_16x16x32_bf16 v[220:223], v[196:199], v[208:211], v[220:223]
  buffer_store_dwordx2 v[216:217], v22, s[4:7], s52 offen offset:48 sc1
  s_waitcnt lgkmcnt(3)
  v_mfma_f32_16x16x32_bf16 v[56:59], v[184:187], v[32:35], 0
  buffer_load_dword v29, v28, s[8:11], s98 offen
  v_mfma_f32_16x16x32_bf16 v[88:91], v[184:187], v[64:67], 0
  s_add_u32 s98, s98, 114688
  ds_read_b128 v[184:187], v27 offset:6144
  v_mfma_f32_16x16x32_bf16 v[108:111], v[176:179], a[188:191], v[108:111]
  v_cvt_pk_bf16_f32 v220, v220, v221
  v_cvt_pk_bf16_f32 v221, v222, v223
  s_waitcnt lgkmcnt(3)
  v_mfma_f32_16x16x32_bf16 v[56:59], v[188:191], v[48:51], v[56:59]
  v_cndmask_b32 v220, 0, v220, vcc
  v_cndmask_b32 v221, 0, v221, vcc
  v_mfma_f32_16x16x32_bf16 v[88:91], v[188:191], v[80:83], v[88:91]
  buffer_store_dwordx2 v[220:221], v23, s[4:7], s52 offen offset:0 sc1
  v_mfma_f32_16x16x32_bf16 v[124:127], v[180:183], a[188:191], v[124:127]
  ds_read_b128 v[188:191], v2 offset:6144
  v_mfma_f32_16x16x32_bf16 v[128:131], v[160:163], a[144:147], v[128:131]
  ds_read_b64_tr_b16 v[176:177], v13 offset:2048
  v_mfma_f32_16x16x32_bf16 v[144:147], v[164:167], a[144:147], v[144:147]
  ds_read_b64_tr_b16 v[178:179], v13 offset:2560
  s_waitcnt lgkmcnt(3)
  v_mfma_f32_16x16x32_bf16 v[60:63], v[184:187], v[32:35], 0
  v_mfma_f32_16x16x32_bf16 v[92:95], v[184:187], v[64:67], 0
  ds_read_b128 v[184:187], v27 offset:8192
  v_mfma_f32_16x16x32_bf16 v[132:135], v[160:163], a[148:151], v[132:135]
  ds_read_b64_tr_b16 v[180:181], v13 offset:5120
  v_mfma_f32_16x16x32_bf16 v[148:151], v[164:167], a[148:151], v[148:151]
  ds_read_b64_tr_b16 v[182:183], v13 offset:5632
  s_waitcnt lgkmcnt(5)
  v_mfma_f32_16x16x32_bf16 v[60:63], v[188:191], v[48:51], v[60:63]
  v_mfma_f32_16x16x32_bf16 v[92:95], v[188:191], v[80:83], v[92:95]
  ds_read_b128 v[188:191], v2 offset:8192
  v_mfma_f32_16x16x32_bf16 v[136:139], v[160:163], a[152:155], v[136:139]
  v_mfma_f32_16x16x32_bf16 v[152:155], v[164:167], a[152:155], v[152:155]
  s_waitcnt lgkmcnt(3)
  v_mfma_f32_16x16x32_bf16 v[200:203], v[184:187], v[32:35], 0
  v_mfma_f32_16x16x32_bf16 v[204:207], v[184:187], v[64:67], 0
  v_mfma_f32_16x16x32_bf16 v[140:143], v[160:163], a[156:159], v[140:143]
  s_waitcnt vmcnt(14) lgkmcnt(1)
  v_mfma_f32_16x16x32_bf16 v[156:159], v[164:167], a[156:159], v[156:159]
  s_barrier
  v_mfma_f32_16x16x32_bf16 v[128:131], v[168:171], a[160:163], v[128:131]
  ds_read_b64_tr_b16 v[160:161], v12 offset:24576
  v_add_u32 v3, 128, v3
  s_waitcnt lgkmcnt(1)
  v_mfma_f32_16x16x32_bf16 v[200:203], v[188:191], v[48:51], v[200:203]
  v_mov_b32 v17, 1
  v_lshl_add_u32 v30, s34, 6, v0
  v_mfma_f32_16x16x32_bf16 v[204:207], v[188:191], v[80:83], v[204:207]
  v_min_u32 v30, 1, v30
  v_lshlrev_b32 v30, 30, v30
  v_mfma_f32_16x16x32_bf16 v[144:147], v[172:175], a[160:163], v[144:147]
  ds_read_b64_tr_b16 v[162:163], v12 offset:25088
  s_add_u32 m0, s41, 0
  v_mfma_f32_16x16x32_bf16 v[132:135], v[168:171], a[164:167], v[132:135]
  buffer_load_dwordx4 v3, s[12:15], s64 offen offset:0 lds
  v_mfma_f32_16x16x32_bf16 v[148:151], v[172:175], a[164:167], v[148:151]
  v_max3_f32 v202, v40, v41, v42
  v_max3_f32 v203, v43, v44, v45
  v_mfma_f32_16x16x32_bf16 v[136:139], v[168:171], a[168:171], v[136:139]
  ds_read_b64_tr_b16 v[164:165], v12 offset:27648
  v_max3_f32 v202, v202, v46, v47
  v_mfma_f32_16x16x32_bf16 v[152:155], v[172:175], a[168:171], v[152:155]
  ds_read_b64_tr_b16 v[166:167], v12 offset:28160
  v_max3_f32 v203, v203, v56, v57
  v_mfma_f32_16x16x32_bf16 v[140:143], v[168:171], a[172:175], v[140:143]
  buffer_load_dwordx4 v3, s[12:15], s65 offen offset:1024 lds
  v_mfma_f32_16x16x32_bf16 v[156:159], v[172:175], a[172:175], v[156:159]
  v_max3_f32 v202, v202, v58, v59
  v_max3_f32 v203, v203, v60, v61
  v_mfma_f32_16x16x32_bf16 v[128:131], v[176:179], a[176:179], v[128:131]
  ds_read_b64_tr_b16 v[168:169], v12 offset:25600
  v_max3_f32 v202, v202, v62, v63
  v_mfma_f32_16x16x32_bf16 v[144:147], v[180:183], a[176:179], v[144:147]
  ds_read_b64_tr_b16 v[170:171], v12 offset:26112
  v_max3_f32 v203, v203, v200, v201
  v_mfma_f32_16x16x32_bf16 v[132:135], v[176:179], a[180:183], v[132:135]
  buffer_load_dwordx4 v3, s[12:15], s66 offen offset:2048 lds
STUB5:
  s_cbranch_execz K1_back1
  v_mfma_f32_16x16x32_bf16 v[148:151], v[180:183], a[180:183], v[148:151]
  s_add_u32 m0, s41, 3072
  v_max_f32 v202, v202, v203
  v_mul_f32 v202, 0xbfb8aa3b, v202
  v_mfma_f32_16x16x32_bf16 v[136:139], v[176:179], a[184:187], v[136:139]
  ds_read_b64_tr_b16 v[172:173], v12 offset:28672
  v_fma_f32 v40, v40, s50, v202
  v_mfma_f32_16x16x32_bf16 v[152:155], v[180:183], a[184:187], v[152:155]
  ds_read_b64_tr_b16 v[174:175], v12 offset:29184
  v_fma_f32 v41, v41, s50, v202
  v_mfma_f32_16x16x32_bf16 v[140:143], v[176:179], a[188:191], v[140:143]
  buffer_load_dwordx4 v3, s[16:19], s64 offen offset:0 lds
  v_mfma_f32_16x16x32_bf16 v[156:159], v[180:183], a[188:191], v[156:159]
  s_waitcnt lgkmcnt(4)
  v_exp_f32 v40, v40
  v_mfma_f32_16x16x32_bf16 v[96:99], v[160:163], a[192:195], v[96:99]
  ds_read_b64_tr_b16 v[176:177], v12 offset:26624
  v_fma_f32 v42, v42, s50, v202
  v_mfma_f32_16x16x32_bf16 v[112:115], v[164:167], a[192:195], v[112:115]
  ds_read_b64_tr_b16 v[178:179], v12 offset:27136
  v_fma_f32 v43, v43, s50, v202
  v_mfma_f32_16x16x32_bf16 v[100:103], v[160:163], a[196:199], v[100:103]
  buffer_load_dwordx4 v3, s[16:19], s65 offen offset:1024 lds
  v_mfma_f32_16x16x32_bf16 v[116:119], v[164:167], a[196:199], v[116:119]
  s_waitcnt lgkmcnt(2)
  v_exp_f32 v41, v41
  v_mfma_f32_16x16x32_bf16 v[104:107], v[160:163], a[200:203], v[104:107]
  ds_read_b64_tr_b16 v[180:181], v12 offset:29696
  v_fma_f32 v44, v44, s50, v202
  v_mfma_f32_16x16x32_bf16 v[120:123], v[164:167], a[200:203], v[120:123]
  ds_read_b64_tr_b16 v[182:183], v12 offset:30208
  v_add_f32 v203, v40, v41
  v_mfma_f32_16x16x32_bf16 v[108:111], v[160:163], a[204:207], v[108:111]
  buffer_load_dwordx4 v3, s[16:19], s66 offen offset:2048 lds
  v_mfma_f32_16x16x32_bf16 v[124:127], v[164:167], a[204:207], v[124:127]
  v_exp_f32 v42, v42
  v_mfma_f32_16x16x32_bf16 v[96:99], v[168:171], a[208:211], v[96:99]
  ds_read_b64_tr_b16 v[160:161], v13 offset:24576
  v_fma_f32 v45, v45, s50, v202
  v_mfma_f32_16x16x32_bf16 v[112:115], v[172:175], a[208:211], v[112:115]
  ds_read_b64_tr_b16 v[162:163], v13 offset:25088
  v_add_f32 v203, v203, v42
  v_mfma_f32_16x16x32_bf16 v[100:103], v[168:171], a[212:215], v[100:103]
  v_exp_f32 v43, v43
  v_mfma_f32_16x16x32_bf16 v[116:119], v[172:175], a[212:215], v[116:119]
  s_waitcnt lgkmcnt(2)
  v_exp_f32 v44, v44
  v_mfma_f32_16x16x32_bf16 v[104:107], v[168:171], a[216:219], v[104:107]
  ds_read_b64_tr_b16 v[164:165], v13 offset:27648
  v_fma_f32 v46, v46, s50, v202
  v_mfma_f32_16x16x32_bf16 v[120:123], v[172:175], a[216:219], v[120:123]
  ds_read_b64_tr_b16 v[166:167], v13 offset:28160
  v_add_f32 v203, v203, v43
  v_mfma_f32_16x16x32_bf16 v[108:111], v[168:171], a[220:223], v[108:111]
  v_exp_f32 v45, v45
  v_mfma_f32_16x16x32_bf16 v[124:127], v[172:175], a[220:223], v[124:127]
  v_exp_f32 v46, v46
  v_mfma_f32_16x16x32_bf16 v[96:99], v[176:179], a[224:227], v[96:99]
  ds_read_b64_tr_b16 v[168:169], v13 offset:25600
  v_fma_f32 v47, v47, s50, v202
  v_mfma_f32_16x16x32_bf16 v[112:115], v[180:183], a[224:227], v[112:115]
  ds_read_b64_tr_b16 v[170:171], v13 offset:26112
  v_add_f32 v203, v203, v44
  v_mfma_f32_16x16x32_bf16 v[100:103], v[176:179], a[228:231], v[100:103]
  v_exp_f32 v47, v47
  v_mfma_f32_16x16x32_bf16 v[116:119], v[180:183], a[228:231], v[116:119]
  s_waitcnt lgkmcnt(2)
  v_fma_f32 v56, v56, s50, v202
  v_add_f32 v203, v203, v45
  v_mfma_f32_16x16x32_bf16 v[104:107], v[176:179], a[232:235], v[104:107]
  ds_read_b64_tr_b16 v[172:173], v13 offset:28672
  v_fma_f32 v57, v57, s50, v202
  v_mfma_f32_16x16x32_bf16 v[120:123], v[180:183], a[232:235], v[120:123]
  ds_read_b64_tr_b16 v[174:175], v13 offset:29184
  v_add_f32 v203, v203, v46
  v_mfma_f32_16x16x32_bf16 v[108:111], v[176:179], a[236:239], v[108:111]
  v_exp_f32 v56, v56
  v_mfma_f32_16x16x32_bf16 v[124:127], v[180:183], a[236:239], v[124:127]
  v_exp_f32 v57, v57
  v_mfma_f32_16x16x32_bf16 v[128:131], v[160:163], a[192:195], v[128:131]
  ds_read_b64_tr_b16 v[176:177], v13 offset:26624
  v_fma_f32 v58, v58, s50, v202
  v_mfma_f32_16x16x32_bf16 v[144:147], v[164:167], a[192:195], v[144:147]
  ds_read_b64_tr_b16 v[178:179], v13 offset:27136
  v_add_f32 v203, v203, v47
  v_mfma_f32_16x16x32_bf16 v[132:135], v[160:163], a[196:199], v[132:135]
  ds_read_b64_tr_b16 v[180:181], v13 offset:29696
  v_fma_f32 v59, v59, s50, v202
  v_mfma_f32_16x16x32_bf16 v[148:151], v[164:167], a[196:199], v[148:151]
  ds_read_b64_tr_b16 v[182:183], v13 offset:30208
  v_add_f32 v203, v203, v56
  v_mfma_f32_16x16x32_bf16 v[136:139], v[160:163], a[200:203], v[136:139]
  v_exp_f32 v58, v58
  v_mfma_f32_16x16x32_bf16 v[152:155], v[164:167], a[200:203], v[152:155]
  v_exp_f32 v59, v59
  v_mfma_f32_16x16x32_bf16 v[140:143], v[160:163], a[204:207], v[140:143]
  s_waitcnt vmcnt(10) lgkmcnt(0)
  v_fma_f32 v60, v60, s50, v202
  v_add_f32 v203, v203, v57
  v_mfma_f32_16x16x32_bf16 v[156:159], v[164:167], a[204:207], v[156:159]
  s_barrier
  v_mfma_f32_16x16x32_bf16 v[128:131], v[168:171], a[208:211], v[128:131]
  ds_read_b64_tr_b16 v[160:161], v12 offset:49152
  s_add_u32 m0, s41, 24576
  v_mfma_f32_16x16x32_bf16 v[144:147], v[172:175], a[208:211], v[144:147]
  ds_read_b64_tr_b16 v[162:163], v12 offset:49664
  v_fma_f32 v61, v61, s50, v202
  v_mfma_f32_16x16x32_bf16 v[132:135], v[168:171], a[212:215], v[132:135]
  buffer_load_dwordx4 v3, s[12:15], s67 offen offset:0 lds
  v_mfma_f32_16x16x32_bf16 v[148:151], v[172:175], a[212:215], v[148:151]
  v_exp_f32 v60, v60
  v_mfma_f32_16x16x32_bf16 v[136:139], v[168:171], a[216:219], v[136:139]
  ds_read_b64_tr_b16 v[164:165], v12 offset:52224
  v_add_f32 v203, v203, v58
  v_mfma_f32_16x16x32_bf16 v[152:155], v[172:175], a[216:219], v[152:155]
  ds_read_b64_tr_b16 v[166:167], v12 offset:52736
  v_fma_f32 v62, v62, s50, v202
  v_mfma_f32_16x16x32_bf16 v[140:143], v[168:171], a[220:223], v[140:143]
  buffer_load_dwordx4 v3, s[12:15], s68 offen offset:1024 lds
  v_mfma_f32_16x16x32_bf16 v[156:159], v[172:175], a[220:223], v[156:159]
  v_exp_f32 v61, v61
  v_mfma_f32_16x16x32_bf16 v[128:131], v[176:179], a[224:227], v[128:131]
  ds_read_b64_tr_b16 v[168:169], v12 offset:50176
  v_add_f32 v203, v203, v59
  v_mfma_f32_16x16x32_bf16 v[144:147], v[180:183], a[224:227], v[144:147]
  ds_read_b64_tr_b16 v[170:171], v12 offset:50688
  v_fma_f32 v63, v63, s50, v202
  v_mfma_f32_16x16x32_bf16 v[132:135], v[176:179], a[228:231], v[132:135]
  buffer_load_dwordx4 v3, s[12:15], s69 offen offset:2048 lds
  v_mfma_f32_16x16x32_bf16 v[148:151], v[180:183], a[228:231], v[148:151]
  s_add_u32 m0, s41, 27648
  v_exp_f32 v62, v62
  v_mfma_f32_16x16x32_bf16 v[136:139], v[176:179], a[232:235], v[136:139]
  ds_read_b64_tr_b16 v[172:173], v12 offset:53248
  v_add_f32 v203, v203, v60
  v_mfma_f32_16x16x32_bf16 v[152:155], v[180:183], a[232:235], v[152:155]
  ds_read_b64_tr_b16 v[174:175], v12 offset:53760
  v_fma_f32 v200, v200, s50, v202
  v_mfma_f32_16x16x32_bf16 v[140:143], v[176:179], a[236:239], v[140:143]
  buffer_load_dwordx4 v3, s[16:19], s67 offen offset:0 lds
  v_mfma_f32_16x16x32_bf16 v[156:159], v[180:183], a[236:239], v[156:159]
  s_waitcnt lgkmcnt(4)
  v_exp_f32 v63, v63
  v_mfma_f32_16x16x32_bf16 v[96:99], v[160:163], a[240:243], v[96:99]
  ds_read_b64_tr_b16 v[176:177], v12 offset:51200
  v_add_f32 v203, v203, v61
  v_mfma_f32_16x16x32_bf16 v[112:115], v[164:167], a[240:243], v[112:115]
  ds_read_b64_tr_b16 v[178:179], v12 offset:51712
  v_fma_f32 v201, v201, s50, v202
  v_mfma_f32_16x16x32_bf16 v[100:103], v[160:163], a[244:247], v[100:103]
  ds_read_b64_tr_b16 v[180:181], v12 offset:54272
  v_add_f32 v203, v203, v62
  v_mfma_f32_16x16x32_bf16 v[116:119], v[164:167], a[244:247], v[116:119]
  ds_read_b64_tr_b16 v[182:183], v12 offset:54784
  v_add_f32 v203, v203, v63
  v_mfma_f32_16x16x32_bf16 v[104:107], v[160:163], a[248:251], v[104:107]
  buffer_load_dwordx4 v3, s[16:19], s68 offen offset:1024 lds
  v_mfma_f32_16x16x32_bf16 v[120:123], v[164:167], a[248:251], v[120:123]
  v_exp_f32 v200, v200
  v_mfma_f32_16x16x32_bf16 v[108:111], v[160:163], a[252:255], v[108:111]
  s_waitcnt vmcnt(11) lgkmcnt(0)
  v_exp_f32 v201, v201
  v_mfma_f32_16x16x32_bf16 v[124:127], v[164:167], a[252:255], v[124:127]
  s_barrier
  v_mfma_f32_16x16x32_bf16 v[96:99], v[168:171], v[224:227], v[96:99]
  ds_read_b64_tr_b16 v[160:161], v13 offset:49152
  v_and_b32 v14, 15, v0
  v_mfma_f32_16x16x32_bf16 v[112:115], v[172:175], v[224:227], v[112:115]
  ds_read_b64_tr_b16 v[162:163], v13 offset:49664
  v_mul_u32_u24 v19, s35, v14
  v_mfma_f32_16x16x32_bf16 v[100:103], v[168:171], v[228:231], v[100:103]
  buffer_store_dword v17, v30, s[4:7], s54 offen sc1
  v_mfma_f32_16x16x32_bf16 v[116:119], v[172:175], v[228:231], v[116:119]
  buffer_load_dwordx4 v3, s[16:19], s69 offen offset:2048 lds
  v_mfma_f32_16x16x32_bf16 v[104:107], v[168:171], v[232:235], v[104:107]
  ds_read_b64_tr_b16 v[164:165], v13 offset:52224
  v_mov_b32 v20, 0x40000000
  v_mfma_f32_16x16x32_bf16 v[120:123], v[172:175], v[232:235], v[120:123]
  ds_read_b64_tr_b16 v[166:167], v13 offset:52736
  v_cmp_lt_u32 vcc, 1, v19
  v_mfma_f32_16x16x32_bf16 v[108:111], v[168:171], v[236:239], v[108:111]
  s_lshl_b32 s52, s36, 11
  v_cndmask_b32 v18, v24, v20, vcc
  s_add_u32 s52, s52, 100128
  v_mfma_f32_16x16x32_bf16 v[124:127], v[172:175], v[236:239], v[124:127]
  s_lshl_b32 s42, s35, 10
  s_add_u32 s42, s42, s52
  s_sub_u32 s42, s42, 1824
  v_mfma_f32_16x16x32_bf16 v[96:99], v[176:179], v[240:243], v[96:99]
  ds_read_b64_tr_b16 v[168:169], v13 offset:50176
  v_lshlrev_b32 v22, 4, v14
  v_mfma_f32_16x16x32_bf16 v[112:115], v[180:183], v[240:243], v[112:115]
  ds_read_b64_tr_b16 v[170:171], v13 offset:50688
  v_lshlrev_b32 v14, 2, v14
  v_mfma_f32_16x16x32_bf16 v[100:103], v[176:179], v[244:247], v[100:103]
  s_lshl_b32 s43, s35, 12
  v_bfe_u32 v19, v0, 4, 1
  v_max_f32 v96, 0, v96
  v_mfma_f32_16x16x32_bf16 v[116:119], v[180:183], v[244:247], v[116:119]
  s_waitcnt lgkmcnt(2)
  v_max_f32 v97, 0, v97
  v_max_f32 v98, 0, v98
  v_mfma_f32_16x16x32_bf16 v[104:107], v[176:179], v[248:251], v[104:107]
  ds_read_b64_tr_b16 v[172:173], v13 offset:53248
  v_max_f32 v99, 0, v99
  v_mfma_f32_16x16x32_bf16 v[120:123], v[180:183], v[248:251], v[120:123]
  ds_read_b64_tr_b16 v[174:175], v13 offset:53760
  v_mul_f32 v96, v96, v112
  v_mfma_f32_16x16x32_bf16 v[108:111], v[176:179], v[252:255], v[108:111]
  v_mul_f32 v97, v97, v113
  v_mul_f32 v98, v98, v114
  v_mfma_f32_16x16x32_bf16 v[124:127], v[180:183], v[252:255], v[124:127]
  v_mul_f32 v99, v99, v115
  v_cvt_pk_bf16_f32 v4, v96, v97
  v_mfma_f32_16x16x32_bf16 v[128:131], v[160:163], a[240:243], v[128:131]
  ds_read_b64_tr_b16 v[176:177], v13 offset:51200
  v_cvt_pk_bf16_f32 v5, v98, v99
  v_mfma_f32_16x16x32_bf16 v[144:147], v[164:167], a[240:243], v[144:147]
  ds_read_b64_tr_b16 v[178:179], v13 offset:51712
  v_max_f32 v100, 0, v100
  v_mfma_f32_16x16x32_bf16 v[132:135], v[160:163], a[244:247], v[132:135]
  ds_read_b64_tr_b16 v[180:181], v13 offset:54272
  v_max_f32 v101, 0, v101
  v_mfma_f32_16x16x32_bf16 v[148:151], v[164:167], a[244:247], v[148:151]
  ds_read_b64_tr_b16 v[182:183], v13 offset:54784
  v_max_f32 v102, 0, v102
  v_mfma_f32_16x16x32_bf16 v[136:139], v[160:163], a[248:251], v[136:139]
  ds_write_b64 v16, v[4:5] offset:24576
  v_mfma_f32_16x16x32_bf16 v[152:155], v[164:167], a[248:251], v[152:155]
  v_max_f32 v103, 0, v103
  v_mul_f32 v100, v100, v116
  v_mfma_f32_16x16x32_bf16 v[140:143], v[160:163], a[252:255], v[140:143]
  s_waitcnt vmcnt(7) lgkmcnt(1)
  v_mul_f32 v101, v101, v117
  v_mul_f32 v102, v102, v118
  v_mfma_f32_16x16x32_bf16 v[156:159], v[164:167], a[252:255], v[156:159]
  s_barrier
  v_mfma_f32_16x16x32_bf16 v[128:131], v[168:171], v[224:227], v[128:131]
  ds_read_b64_tr_b16 v[160:161], v12 offset:0
  s_add_u32 m0, s41, 49152
  v_mfma_f32_16x16x32_bf16 v[144:147], v[172:175], v[224:227], v[144:147]
  ds_read_b64_tr_b16 v[162:163], v12 offset:512
  v_mul_f32 v103, v103, v119
  v_mfma_f32_16x16x32_bf16 v[132:135], v[168:171], v[228:231], v[132:135]
  buffer_load_dwordx4 v3, s[12:15], s70 offen offset:0 lds
  v_mfma_f32_16x16x32_bf16 v[148:151], v[172:175], v[228:231], v[148:151]
  v_cvt_pk_bf16_f32 v6, v100, v101
  v_cvt_pk_bf16_f32 v7, v102, v103
  v_mfma_f32_16x16x32_bf16 v[136:139], v[168:171], v[232:235], v[136:139]
  ds_read_b64_tr_b16 v[164:165], v12 offset:3072
  v_max_f32 v104, 0, v104
  v_mfma_f32_16x16x32_bf16 v[152:155], v[172:175], v[232:235], v[152:155]
  ds_read_b64_tr_b16 v[166:167], v12 offset:3584
  v_max_f32 v105, 0, v105
  v_mfma_f32_16x16x32_bf16 v[140:143], v[168:171], v[236:239], v[140:143]
  ds_write_b64 v16, v[6:7] offset:25600
  v_mfma_f32_16x16x32_bf16 v[156:159], v[172:175], v[236:239], v[156:159]
  v_max_f32 v106, 0, v106
  v_max_f32 v108, 0, v108
  v_mfma_f32_16x16x32_bf16 v[128:131], v[176:179], v[240:243], v[128:131]
  ds_read_b64_tr_b16 v[168:169], v12 offset:1024
  v_max_f32 v107, 0, v107
  v_mfma_f32_16x16x32_bf16 v[144:147], v[180:183], v[240:243], v[144:147]
  ds_read_b64_tr_b16 v[170:171], v12 offset:1536
  v_max_f32 v109, 0, v109
  v_mfma_f32_16x16x32_bf16 v[132:135], v[176:179], v[244:247], v[132:135]
  buffer_load_dwordx4 v3, s[12:15], s71 offen offset:1024 lds
  v_mfma_f32_16x16x32_bf16 v[148:151], v[180:183], v[244:247], v[148:151]
  s_waitcnt lgkmcnt(3)
  v_mul_f32 v104, v104, v120
  v_max_f32 v110, 0, v110
  v_mfma_f32_16x16x32_bf16 v[136:139], v[176:179], v[248:251], v[136:139]
  ds_read_b64_tr_b16 v[172:173], v12 offset:4096
  v_mul_f32 v105, v105, v121
  v_mfma_f32_16x16x32_bf16 v[152:155], v[180:183], v[248:251], v[152:155]
  ds_read_b64_tr_b16 v[174:175], v12 offset:4608
  v_mul_f32 v106, v106, v122
  v_mfma_f32_16x16x32_bf16 v[140:143], v[176:179], v[252:255], v[140:143]
  v_max_f32 v111, 0, v111
  v_mul_f32 v108, v108, v124
  v_mfma_f32_16x16x32_bf16 v[156:159], v[180:183], v[252:255], v[156:159]
  v_mul_f32 v107, v107, v123
  v_mul_f32 v109, v109, v125
  v_mfma_f32_16x16x32_bf16 v[96:99], v[160:163], a[0:3], 0
  ds_read_b64_tr_b16 v[176:177], v12 offset:2048
  v_cvt_pk_bf16_f32 v8, v104, v105
  v_mfma_f32_16x16x32_bf16 v[112:115], v[164:167], a[0:3], 0
  ds_read_b64_tr_b16 v[178:179], v12 offset:2560
  v_mul_f32 v110, v110, v126
  v_mfma_f32_16x16x32_bf16 v[100:103], v[160:163], a[4:7], 0
  buffer_load_dwordx4 v3, s[12:15], s72 offen offset:2048 lds
  v_mfma_f32_16x16x32_bf16 v[116:119], v[164:167], a[4:7], 0
  s_add_u32 m0, s41, 52224
  v_cvt_pk_bf16_f32 v9, v106, v107
  v_mul_f32 v111, v111, v127
  v_mfma_f32_16x16x32_bf16 v[104:107], v[160:163], a[8:11], 0
  ds_read_b64_tr_b16 v[180:181], v12 offset:5120
  v_cvt_pk_bf16_f32 v10, v108, v109
  v_mfma_f32_16x16x32_bf16 v[120:123], v[164:167], a[8:11], 0
  ds_read_b64_tr_b16 v[182:183], v12 offset:5632
  v_cvt_pk_bf16_f32 v11, v110, v111
  v_mfma_f32_16x16x32_bf16 v[108:111], v[160:163], a[12:15], 0
  ds_write_b64 v16, v[8:9] offset:26624
  v_mfma_f32_16x16x32_bf16 v[124:127], v[164:167], a[12:15], 0
  s_waitcnt lgkmcnt(5)
  v_max_f32 v128, 0, v128
  v_max_f32 v129, 0, v129
  v_mfma_f32_16x16x32_bf16 v[96:99], v[168:171], a[16:19], v[96:99]
  ds_read_b64_tr_b16 v[160:161], v13 offset:0
  v_max_f32 v130, 0, v130
  v_mfma_f32_16x16x32_bf16 v[112:115], v[172:175], a[16:19], v[112:115]
  ds_read_b64_tr_b16 v[162:163], v13 offset:512
  v_max_f32 v131, 0, v131
  v_mfma_f32_16x16x32_bf16 v[100:103], v[168:171], a[20:23], v[100:103]
  ds_write_b64 v16, v[10:11] offset:27648
  v_mfma_f32_16x16x32_bf16 v[116:119], v[172:175], a[20:23], v[116:119]
  buffer_load_dwordx4 v3, s[16:19], s70 offen offset:0 lds
  v_mfma_f32_16x16x32_bf16 v[104:107], v[168:171], a[24:27], v[104:107]
  ds_read_b64_tr_b16 v[164:165], v13 offset:3072
  v_max_f32 v132, 0, v132
  v_mfma_f32_16x16x32_bf16 v[120:123], v[172:175], a[24:27], v[120:123]
  ds_read_b64_tr_b16 v[166:167], v13 offset:3584
  v_max_f32 v133, 0, v133
  v_mfma_f32_16x16x32_bf16 v[108:111], v[168:171], a[28:31], v[108:111]
  s_waitcnt lgkmcnt(6)
  v_mul_f32 v128, v128, v144
  v_max_f32 v134, 0, v134
  v_mfma_f32_16x16x32_bf16 v[124:127], v[172:175], a[28:31], v[124:127]
  v_max_f32 v135, 0, v135
  v_max_f32 v136, 0, v136
  v_mfma_f32_16x16x32_bf16 v[96:99], v[176:179], a[32:35], v[96:99]
  ds_read_b64_tr_b16 v[168:169], v13 offset:1024
  v_mul_f32 v129, v129, v145
  v_mfma_f32_16x16x32_bf16 v[112:115], v[180:183], a[32:35], v[112:115]
  ds_read_b64_tr_b16 v[170:171], v13 offset:1536
  v_mul_f32 v130, v130, v146
  v_mfma_f32_16x16x32_bf16 v[100:103], v[176:179], a[36:39], v[100:103]
  buffer_load_dwordx4 v3, s[16:19], s71 offen offset:1024 lds
  v_mfma_f32_16x16x32_bf16 v[116:119], v[180:183], a[36:39], v[116:119]
  s_waitcnt lgkmcnt(2)
  v_mul_f32 v131, v131, v147
  v_mul_f32 v132, v132, v148
  v_mfma_f32_16x16x32_bf16 v[104:107], v[176:179], a[40:43], v[104:107]
  ds_read_b64_tr_b16 v[172:173], v13 offset:4096
  v_cvt_pk_bf16_f32 v4, v128, v129
  v_mfma_f32_16x16x32_bf16 v[120:123], v[180:183], a[40:43], v[120:123]
  ds_read_b64_tr_b16 v[174:175], v13 offset:4608
  v_mul_f32 v133, v133, v149
  v_mfma_f32_16x16x32_bf16 v[108:111], v[176:179], a[44:47], v[108:111]
  buffer_load_dwordx4 v3, s[16:19], s72 offen offset:2048 lds
  v_mfma_f32_16x16x32_bf16 v[124:127], v[180:183], a[44:47], v[124:127]
  v_cvt_pk_bf16_f32 v5, v130, v131
  v_mul_f32 v134, v134, v150
  v_mfma_f32_16x16x32_bf16 v[128:131], v[160:163], a[0:3], 0
  ds_read_b64_tr_b16 v[176:177], v13 offset:2048
  v_mul_f32 v135, v135, v151
  v_mfma_f32_16x16x32_bf16 v[144:147], v[164:167], a[0:3], 0
  ds_read_b64_tr_b16 v[178:179], v13 offset:2560
  v_cvt_pk_bf16_f32 v6, v132, v133
  v_cvt_pk_bf16_f32 v7, v134, v135
  v_mfma_f32_16x16x32_bf16 v[132:135], v[160:163], a[4:7], 0
  ds_read_b64_tr_b16 v[180:181], v13 offset:5120
  v_max_f32 v137, 0, v137
  v_mfma_f32_16x16x32_bf16 v[148:151], v[164:167], a[4:7], 0
  ds_read_b64_tr_b16 v[182:183], v13 offset:5632
  v_max_f32 v138, 0, v138
  v_max_f32 v139, 0, v139
  v_mul_f32 v136, v136, v152
  v_mul_f32 v137, v137, v153
  v_mul_f32 v138, v138, v154
  v_mul_f32 v139, v139, v155
  v_cvt_pk_bf16_f32 v8, v136, v137
  v_cvt_pk_bf16_f32 v9, v138, v139
  v_mfma_f32_16x16x32_bf16 v[136:139], v[160:163], a[8:11], 0
  ds_write_b64 v16, v[4:5] offset:32768
  v_mfma_f32_16x16x32_bf16 v[152:155], v[164:167], a[8:11], 0
  v_max_f32 v140, 0, v140
  v_max_f32 v141, 0, v141
  v_max_f32 v142, 0, v142
  v_max_f32 v143, 0, v143
  v_mul_f32 v140, v140, v156
  v_mul_f32 v141, v141, v157
  v_mul_f32 v142, v142, v158
  v_mul_f32 v143, v143, v159
  v_cvt_pk_bf16_f32 v10, v140, v141
  v_cvt_pk_bf16_f32 v11, v142, v143
  v_mfma_f32_16x16x32_bf16 v[140:143], v[160:163], a[12:15], 0
  s_waitcnt vmcnt(6) lgkmcnt(1)
  v_lshl_add_u32 v22, v19, 3, v22
  v_lshrrev_b32 v19, 5, v0
  v_mfma_f32_16x16x32_bf16 v[156:159], v[164:167], a[12:15], 0
  s_barrier
  v_mfma_f32_16x16x32_bf16 v[128:131], v[168:171], a[16:19], v[128:131]
  ds_read_b64_tr_b16 v[160:161], v12 offset:24576
  s_add_u32 m0, s41, 0
  v_mfma_f32_16x16x32_bf16 v[144:147], v[172:175], a[16:19], v[144:147]
  ds_read_b64_tr_b16 v[162:163], v12 offset:25088
  v_lshl_add_u32 v22, v19, 8, v22
  v_mfma_f32_16x16x32_bf16 v[132:135], v[168:171], a[20:23], v[132:135]
  ds_write_b64 v16, v[6:7] offset:33792
  v_mfma_f32_16x16x32_bf16 v[148:151], v[172:175], a[20:23], v[148:151]
  buffer_load_dwordx4 v3, s[12:15], s73 offen offset:0 lds
  v_mfma_f32_16x16x32_bf16 v[136:139], v[168:171], a[24:27], v[136:139]
  ds_read_b64_tr_b16 v[164:165], v12 offset:27648
  v_add_u32 v22, s42, v22
  v_mfma_f32_16x16x32_bf16 v[152:155], v[172:175], a[24:27], v[152:155]
  ds_read_b64_tr_b16 v[166:167], v12 offset:28160
  s_lshl_b32 s42, s36, 13
  v_mfma_f32_16x16x32_bf16 v[140:143], v[168:171], a[28:31], v[140:143]
  ds_write_b64 v16, v[8:9] offset:34816
  v_mfma_f32_16x16x32_bf16 v[156:159], v[172:175], a[28:31], v[156:159]
  buffer_load_dwordx4 v3, s[12:15], s74 offen offset:1024 lds
  v_mfma_f32_16x16x32_bf16 v[128:131], v[176:179], a[32:35], v[128:131]
  ds_read_b64_tr_b16 v[168:169], v12 offset:25600
  s_add_u32 s42, s42, s43
  v_mfma_f32_16x16x32_bf16 v[144:147], v[180:183], a[32:35], v[144:147]
  ds_read_b64_tr_b16 v[170:171], v12 offset:26112
  s_add_u32 s42, s42, 147456
  v_mfma_f32_16x16x32_bf16 v[132:135], v[176:179], a[36:39], v[132:135]
  ds_write_b64 v16, v[10:11] offset:35840
  v_mfma_f32_16x16x32_bf16 v[148:151], v[180:183], a[36:39], v[148:151]
  buffer_load_dwordx4 v3, s[12:15], s75 offen offset:2048 lds
  v_mfma_f32_16x16x32_bf16 v[136:139], v[176:179], a[40:43], v[136:139]
  ds_read_b64_tr_b16 v[172:173], v12 offset:28672
  s_add_u32 m0, s41, 3072
  v_mfma_f32_16x16x32_bf16 v[152:155], v[180:183], a[40:43], v[152:155]
  ds_read_b64_tr_b16 v[174:175], v12 offset:29184
  v_add_u32 v23, s42, v1
  v_mfma_f32_16x16x32_bf16 v[140:143], v[176:179], a[44:47], v[140:143]
  buffer_load_dwordx4 v3, s[16:19], s73 offen offset:0 lds
  v_mfma_f32_16x16x32_bf16 v[156:159], v[180:183], a[44:47], v[156:159]
  s_waitcnt lgkmcnt(6)
  v_add_f32 v203, v203, v200
  v_add_f32 v203, v203, v201
  v_mfma_f32_16x16x32_bf16 v[96:99], v[160:163], a[48:51], v[96:99]
  ds_read_b64_tr_b16 v[176:177], v12 offset:26624
  v_max3_f32 v206, v72, v73, v74
  v_mfma_f32_16x16x32_bf16 v[112:115], v[164:167], a[48:51], v[112:115]
  ds_read_b64_tr_b16 v[178:179], v12 offset:27136
  v_max3_f32 v207, v75, v76, v77
  v_mfma_f32_16x16x32_bf16 v[100:103], v[160:163], a[52:55], v[100:103]
  buffer_load_dwordx4 v3, s[16:19], s74 offen offset:1024 lds
  v_mfma_f32_16x16x32_bf16 v[116:119], v[164:167], a[52:55], v[116:119]
  s_waitcnt lgkmcnt(2)
  v_rcp_f32 v203, v203
  v_mfma_f32_16x16x32_bf16 v[104:107], v[160:163], a[56:59], v[104:107]
  ds_read_b64_tr_b16 v[180:181], v12 offset:29696
  v_mul_f32 v40, v40, v203
  v_mfma_f32_16x16x32_bf16 v[120:123], v[164:167], a[56:59], v[120:123]
  ds_read_b64_tr_b16 v[182:183], v12 offset:30208
  v_mul_f32 v41, v41, v203
  v_mfma_f32_16x16x32_bf16 v[108:111], v[160:163], a[60:63], v[108:111]
  buffer_load_dwordx4 v3, s[16:19], s75 offen offset:2048 lds
  v_mfma_f32_16x16x32_bf16 v[124:127], v[164:167], a[60:63], v[124:127]
  buffer_load_dword v29, v28, s[20:23], s99 offen
  v_mfma_f32_16x16x32_bf16 v[96:99], v[168:171], a[64:67], v[96:99]
  ds_read_b64_tr_b16 v[160:161], v13 offset:24576
  v_mul_f32 v42, v42, v203
  v_mfma_f32_16x16x32_bf16 v[112:115], v[172:175], a[64:67], v[112:115]
  ds_read_b64_tr_b16 v[162:163], v13 offset:25088
  v_mul_f32 v43, v43, v203
  v_mfma_f32_16x16x32_bf16 v[100:103], v[168:171], a[68:71], v[100:103]
  s_and_b32 s99, s33, 1
  v_mul_f32 v44, v44, v203
  v_mul_f32 v45, v45, v203
  v_mfma_f32_16x16x32_bf16 v[116:119], v[172:175], a[68:71], v[116:119]
  s_waitcnt lgkmcnt(2)
  v_mul_f32 v46, v46, v203
  v_mul_f32 v47, v47, v203
  v_mfma_f32_16x16x32_bf16 v[104:107], v[168:171], a[72:75], v[104:107]
  ds_read_b64_tr_b16 v[164:165], v13 offset:27648
  v_mul_f32 v56, v56, v203
  v_mfma_f32_16x16x32_bf16 v[120:123], v[172:175], a[72:75], v[120:123]
  ds_read_b64_tr_b16 v[166:167], v13 offset:28160
  v_mul_f32 v57, v57, v203
  v_mfma_f32_16x16x32_bf16 v[108:111], v[168:171], a[76:79], v[108:111]
  s_mul_i32 s99, s99, 640
  v_mul_f32 v58, v58, v203
  v_mul_f32 v59, v59, v203
  v_mfma_f32_16x16x32_bf16 v[124:127], v[172:175], a[76:79], v[124:127]
  v_mul_f32 v60, v60, v203
  v_mul_f32 v61, v61, v203
  v_mfma_f32_16x16x32_bf16 v[96:99], v[176:179], a[80:83], v[96:99]
  ds_read_b64_tr_b16 v[168:169], v13 offset:25600
  v_mul_f32 v62, v62, v203
  v_mfma_f32_16x16x32_bf16 v[112:115], v[180:183], a[80:83], v[112:115]
  ds_read_b64_tr_b16 v[170:171], v13 offset:26112
  v_mul_f32 v63, v63, v203
  v_mfma_f32_16x16x32_bf16 v[100:103], v[176:179], a[84:87], v[100:103]
  v_mul_f32 v200, v200, v203
  v_mul_f32 v201, v201, v203
  v_mfma_f32_16x16x32_bf16 v[116:119], v[180:183], a[84:87], v[116:119]
  s_waitcnt lgkmcnt(2)
  v_cvt_pk_bf16_f32 v40, v40, v41
  v_cvt_pk_bf16_f32 v41, v42, v43
  v_mfma_f32_16x16x32_bf16 v[104:107], v[176:179], a[88:91], v[104:107]
  ds_read_b64_tr_b16 v[172:173], v13 offset:28672
  v_cvt_pk_bf16_f32 v42, v44, v45
  v_mfma_f32_16x16x32_bf16 v[120:123], v[180:183], a[88:91], v[120:123]
  ds_read_b64_tr_b16 v[174:175], v13 offset:29184
  v_cvt_pk_bf16_f32 v43, v46, v47
  v_mfma_f32_16x16x32_bf16 v[108:111], v[176:179], a[92:95], v[108:111]
  v_cvt_pk_bf16_f32 v44, v56, v57
  v_cvt_pk_bf16_f32 v45, v58, v59
  v_mfma_f32_16x16x32_bf16 v[124:127], v[180:183], a[92:95], v[124:127]
  v_cvt_pk_bf16_f32 v46, v60, v61
  v_cvt_pk_bf16_f32 v47, v62, v63
  v_mfma_f32_16x16x32_bf16 v[128:131], v[160:163], a[48:51], v[128:131]
  ds_read_b64_tr_b16 v[176:177], v13 offset:26624
  v_cvt_pk_bf16_f32 v38, v200, v201
  v_mfma_f32_16x16x32_bf16 v[144:147], v[164:167], a[48:51], v[144:147]
  ds_read_b64_tr_b16 v[178:179], v13 offset:27136
  v_max3_f32 v206, v206, v78, v79
  v_mfma_f32_16x16x32_bf16 v[132:135], v[160:163], a[52:55], v[132:135]
  ds_read_b64_tr_b16 v[180:181], v13 offset:29696
  v_max3_f32 v207, v207, v88, v89
  v_mfma_f32_16x16x32_bf16 v[148:151], v[164:167], a[52:55], v[148:151]
  ds_read_b64_tr_b16 v[182:183], v13 offset:30208
  v_max3_f32 v206, v206, v90, v91
  v_mfma_f32_16x16x32_bf16 v[136:139], v[160:163], a[56:59], v[136:139]
  v_max3_f32 v207, v207, v92, v93
  v_max3_f32 v206, v206, v94, v95
  v_mfma_f32_16x16x32_bf16 v[152:155], v[164:167], a[56:59], v[152:155]
  v_max3_f32 v207, v207, v204, v205
  v_max_f32 v206, v206, v207
  v_mfma_f32_16x16x32_bf16 v[140:143], v[160:163], a[60:63], v[140:143]
  s_waitcnt vmcnt(7) lgkmcnt(0)
  v_mul_f32 v206, 0xbfb8aa3b, v206
  v_fma_f32 v72, v72, s50, v206
  v_mfma_f32_16x16x32_bf16 v[156:159], v[164:167], a[60:63], v[156:159]
  s_barrier
  v_mfma_f32_16x16x32_bf16 v[128:131], v[168:171], a[64:67], v[128:131]
  ds_read_b64_tr_b16 v[160:161], v12 offset:49152
  s_add_u32 m0, s41, 24576
  v_mfma_f32_16x16x32_bf16 v[144:147], v[172:175], a[64:67], v[144:147]
  ds_read_b64_tr_b16 v[162:163], v12 offset:49664
  s_add_u32 s49, s39, 98304
  v_mfma_f32_16x16x32_bf16 v[132:135], v[168:171], a[68:71], v[132:135]
  buffer_load_dwordx4 v3, s[12:15], s76 offen offset:0 lds
  v_mfma_f32_16x16x32_bf16 v[148:151], v[172:175], a[68:71], v[148:151]
  v_exp_f32 v72, v72
  v_mfma_f32_16x16x32_bf16 v[136:139], v[168:171], a[72:75], v[136:139]
  ds_read_b64_tr_b16 v[164:165], v12 offset:52224
  v_add_u32 v4, s49, v1
  v_mfma_f32_16x16x32_bf16 v[152:155], v[172:175], a[72:75], v[152:155]
  ds_read_b64_tr_b16 v[166:167], v12 offset:52736
  s_add_u32 s49, s100, 24576
  v_mfma_f32_16x16x32_bf16 v[140:143], v[168:171], a[76:79], v[140:143]
  buffer_load_dwordx4 v3, s[12:15], s77 offen offset:1024 lds
  v_mfma_f32_16x16x32_bf16 v[156:159], v[172:175], a[76:79], v[156:159]
  ds_read_b128 v[8:11], v4 offset:1024
  v_fma_f32 v73, v73, s50, v206
  v_mfma_f32_16x16x32_bf16 v[128:131], v[176:179], a[80:83], v[128:131]
  ds_read_b64_tr_b16 v[168:169], v12 offset:50176
  v_fma_f32 v74, v74, s50, v206
  v_mfma_f32_16x16x32_bf16 v[144:147], v[180:183], a[80:83], v[144:147]
  ds_read_b64_tr_b16 v[170:171], v12 offset:50688
  v_fma_f32 v75, v75, s50, v206
  v_mfma_f32_16x16x32_bf16 v[132:135], v[176:179], a[84:87], v[132:135]
  buffer_load_dwordx4 v3, s[12:15], s78 offen offset:2048 lds
  v_mfma_f32_16x16x32_bf16 v[148:151], v[180:183], a[84:87], v[148:151]
  s_add_u32 m0, s41, 27648
  ds_read_b128 v[4:7], v4
  v_mfma_f32_16x16x32_bf16 v[136:139], v[176:179], a[88:91], v[136:139]
  ds_read_b64_tr_b16 v[172:173], v12 offset:53248
  v_fma_f32 v76, v76, s50, v206
  v_mfma_f32_16x16x32_bf16 v[152:155], v[180:183], a[88:91], v[152:155]
  ds_read_b64_tr_b16 v[174:175], v12 offset:53760
  v_fma_f32 v77, v77, s50, v206
  v_mfma_f32_16x16x32_bf16 v[140:143], v[176:179], a[92:95], v[140:143]
  buffer_load_dwordx4 v3, s[16:19], s76 offen offset:0 lds
  v_mfma_f32_16x16x32_bf16 v[156:159], v[180:183], a[92:95], v[156:159]
  s_waitcnt lgkmcnt(6)
  v_exp_f32 v73, v73
  v_mfma_f32_16x16x32_bf16 v[96:99], v[160:163], a[96:99], v[96:99]
  ds_read_b64_tr_b16 v[176:177], v12 offset:51200
  v_add_f32 v207, v72, v73
  v_mfma_f32_16x16x32_bf16 v[112:115], v[164:167], a[96:99], v[112:115]
  ds_read_b64_tr_b16 v[178:179], v12 offset:51712
  v_fma_f32 v78, v78, s50, v206
  v_mfma_f32_16x16x32_bf16 v[100:103], v[160:163], a[100:103], v[100:103]
  buffer_load_dwordx4 v3, s[16:19], s77 offen offset:1024 lds
  v_mfma_f32_16x16x32_bf16 v[116:119], v[164:167], a[100:103], v[116:119]
  s_waitcnt lgkmcnt(2)
  v_exp_f32 v74, v74
  v_mfma_f32_16x16x32_bf16 v[104:107], v[160:163], a[104:107], v[104:107]
  ds_read_b64_tr_b16 v[180:181], v12 offset:54272
  v_add_f32 v207, v207, v74
  v_mfma_f32_16x16x32_bf16 v[120:123], v[164:167], a[104:107], v[120:123]
  ds_read_b64_tr_b16 v[182:183], v12 offset:54784
  v_fma_f32 v79, v79, s50, v206
  v_mfma_f32_16x16x32_bf16 v[108:111], v[160:163], a[108:111], v[108:111]
  buffer_load_dwordx4 v3, s[16:19], s78 offen offset:2048 lds
  v_mfma_f32_16x16x32_bf16 v[124:127], v[164:167], a[108:111], v[124:127]
  v_exp_f32 v75, v75
  v_mfma_f32_16x16x32_bf16 v[96:99], v[168:171], a[112:115], v[96:99]
  ds_read_b64_tr_b16 v[160:161], v13 offset:49152
STUB6:
  s_cbranch_execz K1_back1
  v_add_f32 v207, v207, v75
  v_mfma_f32_16x16x32_bf16 v[112:115], v[172:175], a[112:115], v[112:115]
  ds_read_b64_tr_b16 v[162:163], v13 offset:49664
  v_fma_f32 v88, v88, s50, v206
  v_mfma_f32_16x16x32_bf16 v[100:103], v[168:171], a[116:119], v[100:103]
  buffer_store_dwordx4 v[8:11], v1, s[4:7], s49 offen offset:1024 sc1
  v_mfma_f32_16x16x32_bf16 v[116:119], v[172:175], a[116:119], v[116:119]
  buffer_store_dwordx4 v[4:7], v1, s[4:7], s49 offen sc1
  v_mfma_f32_16x16x32_bf16 v[104:107], v[168:171], a[120:123], v[104:107]
  ds_read_b64_tr_b16 v[164:165], v13 offset:52224
  s_add_u32 s49, s39, 106496
  v_mfma_f32_16x16x32_bf16 v[120:123], v[172:175], a[120:123], v[120:123]
  ds_read_b64_tr_b16 v[166:167], v13 offset:52736
  v_add_u32 v4, s49, v1
  v_mfma_f32_16x16x32_bf16 v[108:111], v[168:171], a[124:127], v[108:111]
  ds_read_b128 v[8:11], v4 offset:1024
  s_add_u32 s49, s100, 32768
  v_mfma_f32_16x16x32_bf16 v[124:127], v[172:175], a[124:127], v[124:127]
  ds_read_b128 v[4:7], v4
  s_waitcnt lgkmcnt(6)
  v_mfma_f32_16x16x32_bf16 v[96:99], v[176:179], a[128:131], v[96:99]
  ds_read_b64_tr_b16 v[168:169], v13 offset:50176
  v_fma_f32 v89, v89, s50, v206
  v_mfma_f32_16x16x32_bf16 v[112:115], v[180:183], a[128:131], v[112:115]
  ds_read_b64_tr_b16 v[170:171], v13 offset:50688
  v_fma_f32 v90, v90, s50, v206
  v_mfma_f32_16x16x32_bf16 v[100:103], v[176:179], a[132:135], v[100:103]
  v_exp_f32 v76, v76
  v_mfma_f32_16x16x32_bf16 v[116:119], v[180:183], a[132:135], v[116:119]
  s_waitcnt lgkmcnt(4)
  v_exp_f32 v77, v77
  v_mfma_f32_16x16x32_bf16 v[104:107], v[176:179], a[136:139], v[104:107]
  ds_read_b64_tr_b16 v[172:173], v13 offset:53248
  v_add_f32 v207, v207, v76
  v_mfma_f32_16x16x32_bf16 v[120:123], v[180:183], a[136:139], v[120:123]
  ds_read_b64_tr_b16 v[174:175], v13 offset:53760
  v_add_f32 v207, v207, v77
  v_mfma_f32_16x16x32_bf16 v[108:111], v[176:179], a[140:143], v[108:111]
  s_waitcnt lgkmcnt(5)
  buffer_store_dwordx4 v[8:11], v1, s[4:7], s49 offen offset:1024 sc1
  v_mfma_f32_16x16x32_bf16 v[124:127], v[180:183], a[140:143], v[124:127]
  s_waitcnt lgkmcnt(4)
  buffer_store_dwordx4 v[4:7], v1, s[4:7], s49 offen sc1
  v_mfma_f32_16x16x32_bf16 v[128:131], v[160:163], a[96:99], v[128:131]
  ds_read_b64_tr_b16 v[176:177], v13 offset:51200
  v_fma_f32 v91, v91, s50, v206
  v_mfma_f32_16x16x32_bf16 v[144:147], v[164:167], a[96:99], v[144:147]
  ds_read_b64_tr_b16 v[178:179], v13 offset:51712
  v_fma_f32 v92, v92, s50, v206
  v_mfma_f32_16x16x32_bf16 v[132:135], v[160:163], a[100:103], v[132:135]
  ds_read_b64_tr_b16 v[180:181], v13 offset:54272
  v_fma_f32 v93, v93, s50, v206
  v_mfma_f32_16x16x32_bf16 v[148:151], v[164:167], a[100:103], v[148:151]
  ds_read_b64_tr_b16 v[182:183], v13 offset:54784
  v_fma_f32 v94, v94, s50, v206
  v_mfma_f32_16x16x32_bf16 v[136:139], v[160:163], a[104:107], v[136:139]
  v_exp_f32 v78, v78
  v_mfma_f32_16x16x32_bf16 v[152:155], v[164:167], a[104:107], v[152:155]
  v_exp_f32 v79, v79
  v_mfma_f32_16x16x32_bf16 v[140:143], v[160:163], a[108:111], v[140:143]
  s_waitcnt vmcnt(11) lgkmcnt(0)
  v_exp_f32 v88, v88
  v_mfma_f32_16x16x32_bf16 v[156:159], v[164:167], a[108:111], v[156:159]
  s_barrier
  v_mfma_f32_16x16x32_bf16 v[128:131], v[168:171], a[112:115], v[128:131]
  ds_read_b64_tr_b16 v[160:161], v12 offset:0
  s_add_u32 m0, s41, 49152
  v_mfma_f32_16x16x32_bf16 v[144:147], v[172:175], a[112:115], v[144:147]
  ds_read_b64_tr_b16 v[162:163], v12 offset:512
  v_add_f32 v207, v207, v78
  v_mfma_f32_16x16x32_bf16 v[132:135], v[168:171], a[116:119], v[132:135]
  buffer_load_dwordx4 v3, s[12:15], s79 offen offset:0 lds
  v_mfma_f32_16x16x32_bf16 v[148:151], v[172:175], a[116:119], v[148:151]
  v_exp_f32 v89, v89
  v_mfma_f32_16x16x32_bf16 v[136:139], v[168:171], a[120:123], v[136:139]
  ds_read_b64_tr_b16 v[164:165], v12 offset:3072
  v_add_f32 v207, v207, v79
  v_mfma_f32_16x16x32_bf16 v[152:155], v[172:175], a[120:123], v[152:155]
  ds_read_b64_tr_b16 v[166:167], v12 offset:3584
  v_add_f32 v207, v207, v88
  v_mfma_f32_16x16x32_bf16 v[140:143], v[168:171], a[124:127], v[140:143]
  buffer_load_dwordx4 v3, s[12:15], s80 offen offset:1024 lds
  v_mfma_f32_16x16x32_bf16 v[156:159], v[172:175], a[124:127], v[156:159]
  buffer_load_dword v21, v14, s[4:7], s53 offen sc1
  v_mfma_f32_16x16x32_bf16 v[128:131], v[176:179], a[128:131], v[128:131]
  ds_read_b64_tr_b16 v[168:169], v12 offset:1024
  v_add_f32 v207, v207, v89
  v_mfma_f32_16x16x32_bf16 v[144:147], v[180:183], a[128:131], v[144:147]
  ds_read_b64_tr_b16 v[170:171], v12 offset:1536
  v_fma_f32 v95, v95, s50, v206
  v_mfma_f32_16x16x32_bf16 v[132:135], v[176:179], a[132:135], v[132:135]
  buffer_load_dwordx4 v3, s[12:15], s81 offen offset:2048 lds
  v_mfma_f32_16x16x32_bf16 v[148:151], v[180:183], a[132:135], v[148:151]
  s_add_u32 m0, s41, 52224
  v_exp_f32 v90, v90
  v_mfma_f32_16x16x32_bf16 v[136:139], v[176:179], a[136:139], v[136:139]
  ds_read_b64_tr_b16 v[172:173], v12 offset:4096
  v_add_f32 v207, v207, v90
  v_mfma_f32_16x16x32_bf16 v[152:155], v[180:183], a[136:139], v[152:155]
  ds_read_b64_tr_b16 v[174:175], v12 offset:4608
  v_fma_f32 v204, v204, s50, v206
  v_mfma_f32_16x16x32_bf16 v[140:143], v[176:179], a[140:143], v[140:143]
  buffer_load_dwordx4 v3, s[16:19], s79 offen offset:0 lds
  v_mfma_f32_16x16x32_bf16 v[156:159], v[180:183], a[140:143], v[156:159]
  s_waitcnt lgkmcnt(4)
  v_exp_f32 v91, v91
  v_mfma_f32_16x16x32_bf16 v[96:99], v[160:163], a[144:147], v[96:99]
  ds_read_b64_tr_b16 v[176:177], v12 offset:2048
  v_add_f32 v207, v207, v91
  v_mfma_f32_16x16x32_bf16 v[112:115], v[164:167], a[144:147], v[112:115]
  ds_read_b64_tr_b16 v[178:179], v12 offset:2560
  v_fma_f32 v205, v205, s50, v206
  v_mfma_f32_16x16x32_bf16 v[100:103], v[160:163], a[148:151], v[100:103]
  buffer_load_dwordx4 v3, s[16:19], s80 offen offset:1024 lds
  v_mfma_f32_16x16x32_bf16 v[116:119], v[164:167], a[148:151], v[116:119]
  s_waitcnt lgkmcnt(2)
  v_exp_f32 v92, v92
  v_mfma_f32_16x16x32_bf16 v[104:107], v[160:163], a[152:155], v[104:107]
  ds_read_b64_tr_b16 v[180:181], v12 offset:5120
  v_add_f32 v207, v207, v92
  v_mfma_f32_16x16x32_bf16 v[120:123], v[164:167], a[152:155], v[120:123]
  ds_read_b64_tr_b16 v[182:183], v12 offset:5632
  v_lshrrev_b32 v27, 3, v0
  v_mfma_f32_16x16x32_bf16 v[108:111], v[160:163], a[156:159], v[108:111]
  buffer_load_dwordx4 v3, s[16:19], s81 offen offset:2048 lds
  v_mfma_f32_16x16x32_bf16 v[124:127], v[164:167], a[156:159], v[124:127]
  v_exp_f32 v93, v93
  v_mfma_f32_16x16x32_bf16 v[96:99], v[168:171], a[160:163], v[96:99]
  ds_read_b64_tr_b16 v[160:161], v13 offset:0
  v_add_f32 v207, v207, v93
  v_mfma_f32_16x16x32_bf16 v[112:115], v[172:175], a[160:163], v[112:115]
  ds_read_b64_tr_b16 v[162:163], v13 offset:512
  v_lshl_add_u32 v27, s34, 3, v27
  v_mfma_f32_16x16x32_bf16 v[100:103], v[168:171], a[164:167], v[100:103]
  v_exp_f32 v94, v94
  v_mfma_f32_16x16x32_bf16 v[116:119], v[172:175], a[164:167], v[116:119]
  s_waitcnt lgkmcnt(2)
  v_exp_f32 v95, v95
  v_mfma_f32_16x16x32_bf16 v[104:107], v[168:171], a[168:171], v[104:107]
  ds_read_b64_tr_b16 v[164:165], v13 offset:3072
  v_add_f32 v207, v207, v94
  v_mfma_f32_16x16x32_bf16 v[120:123], v[172:175], a[168:171], v[120:123]
  ds_read_b64_tr_b16 v[166:167], v13 offset:3584
  v_add_f32 v207, v207, v95
  v_mfma_f32_16x16x32_bf16 v[108:111], v[168:171], a[172:175], v[108:111]
  v_exp_f32 v204, v204
  v_mfma_f32_16x16x32_bf16 v[124:127], v[172:175], a[172:175], v[124:127]
  v_exp_f32 v205, v205
  v_mfma_f32_16x16x32_bf16 v[96:99], v[176:179], a[176:179], v[96:99]
  ds_read_b64_tr_b16 v[168:169], v13 offset:1024
  v_add_f32 v207, v207, v204
  v_mfma_f32_16x16x32_bf16 v[112:115], v[180:183], a[176:179], v[112:115]
  ds_read_b64_tr_b16 v[170:171], v13 offset:1536
  v_add_f32 v207, v207, v205
  v_mfma_f32_16x16x32_bf16 v[100:103], v[176:179], a[180:183], v[100:103]
  v_rcp_f32 v207, v207
  v_mfma_f32_16x16x32_bf16 v[116:119], v[180:183], a[180:183], v[116:119]
  s_waitcnt lgkmcnt(2)
  v_mul_f32 v72, v72, v207
  v_mul_f32 v73, v73, v207
  v_mfma_f32_16x16x32_bf16 v[104:107], v[176:179], a[184:187], v[104:107]
  ds_read_b64_tr_b16 v[172:173], v13 offset:4096
  v_mul_f32 v74, v74, v207
  v_mfma_f32_16x16x32_bf16 v[120:123], v[180:183], a[184:187], v[120:123]
  ds_read_b64_tr_b16 v[174:175], v13 offset:4608
  v_mul_f32 v75, v75, v207
  v_mfma_f32_16x16x32_bf16 v[108:111], v[176:179], a[188:191], v[108:111]
  v_mul_f32 v76, v76, v207
  v_mul_f32 v77, v77, v207
  v_mfma_f32_16x16x32_bf16 v[124:127], v[180:183], a[188:191], v[124:127]
  v_mul_f32 v78, v78, v207
  v_mul_f32 v79, v79, v207
  v_mfma_f32_16x16x32_bf16 v[128:131], v[160:163], a[144:147], v[128:131]
  ds_read_b64_tr_b16 v[176:177], v13 offset:2048
  v_mul_f32 v88, v88, v207
  v_mfma_f32_16x16x32_bf16 v[144:147], v[164:167], a[144:147], v[144:147]
  ds_read_b64_tr_b16 v[178:179], v13 offset:2560
  v_mul_f32 v89, v89, v207
  v_mfma_f32_16x16x32_bf16 v[132:135], v[160:163], a[148:151], v[132:135]
  ds_read_b64_tr_b16 v[180:181], v13 offset:5120
  v_mul_f32 v90, v90, v207
  v_mfma_f32_16x16x32_bf16 v[148:151], v[164:167], a[148:151], v[148:151]
  ds_read_b64_tr_b16 v[182:183], v13 offset:5632
  v_mul_f32 v91, v91, v207
  v_mfma_f32_16x16x32_bf16 v[136:139], v[160:163], a[152:155], v[136:139]
  v_mul_f32 v92, v92, v207
  v_mul_f32 v93, v93, v207
  v_mfma_f32_16x16x32_bf16 v[152:155], v[164:167], a[152:155], v[152:155]
  v_mul_f32 v94, v94, v207
  v_mul_f32 v95, v95, v207
  v_mfma_f32_16x16x32_bf16 v[140:143], v[160:163], a[156:159], v[140:143]
  s_waitcnt vmcnt(11) lgkmcnt(0)
  v_mul_f32 v204, v204, v207
  v_mul_f32 v205, v205, v207
  v_mfma_f32_16x16x32_bf16 v[156:159], v[164:167], a[156:159], v[156:159]
  s_barrier
  v_mfma_f32_16x16x32_bf16 v[128:131], v[168:171], a[160:163], v[128:131]
  ds_read_b64_tr_b16 v[160:161], v12 offset:24576
  v_add_u32 v3, 128, v3
  v_mfma_f32_16x16x32_bf16 v[144:147], v[172:175], a[160:163], v[144:147]
  ds_read_b64_tr_b16 v[162:163], v12 offset:25088
  s_add_u32 m0, s41, 0
  v_mfma_f32_16x16x32_bf16 v[132:135], v[168:171], a[164:167], v[132:135]
  buffer_load_dwordx4 v3, s[12:15], s64 offen offset:0 lds
  v_mfma_f32_16x16x32_bf16 v[148:151], v[172:175], a[164:167], v[148:151]
  v_cvt_pk_bf16_f32 v72, v72, v73
  v_cvt_pk_bf16_f32 v73, v74, v75
  v_mfma_f32_16x16x32_bf16 v[136:139], v[168:171], a[168:171], v[136:139]
  ds_read_b64_tr_b16 v[164:165], v12 offset:27648
  v_cvt_pk_bf16_f32 v74, v76, v77
  v_mfma_f32_16x16x32_bf16 v[152:155], v[172:175], a[168:171], v[152:155]
  ds_read_b64_tr_b16 v[166:167], v12 offset:28160
  v_cvt_pk_bf16_f32 v75, v78, v79
  v_mfma_f32_16x16x32_bf16 v[140:143], v[168:171], a[172:175], v[140:143]
  buffer_load_dwordx4 v3, s[12:15], s65 offen offset:1024 lds
  v_mfma_f32_16x16x32_bf16 v[156:159], v[172:175], a[172:175], v[156:159]
  v_cvt_pk_bf16_f32 v76, v88, v89
  v_cvt_pk_bf16_f32 v77, v90, v91
  v_mfma_f32_16x16x32_bf16 v[128:131], v[176:179], a[176:179], v[128:131]
  ds_read_b64_tr_b16 v[168:169], v12 offset:25600
  v_cvt_pk_bf16_f32 v78, v92, v93
  v_mfma_f32_16x16x32_bf16 v[144:147], v[180:183], a[176:179], v[144:147]
  ds_read_b64_tr_b16 v[170:171], v12 offset:26112
  v_cvt_pk_bf16_f32 v79, v94, v95
  v_mfma_f32_16x16x32_bf16 v[132:135], v[176:179], a[180:183], v[132:135]
  buffer_load_dwordx4 v3, s[12:15], s66 offen offset:2048 lds
  v_mfma_f32_16x16x32_bf16 v[148:151], v[180:183], a[180:183], v[148:151]
  s_add_u32 m0, s41, 3072
  v_cvt_pk_bf16_f32 v70, v204, v205
  v_mul_u32_u24 v27, 1152, v27
  v_mfma_f32_16x16x32_bf16 v[136:139], v[176:179], a[184:187], v[136:139]
  ds_read_b64_tr_b16 v[172:173], v12 offset:28672
  v_lshrrev_b32 v2, 4, v0
  v_mfma_f32_16x16x32_bf16 v[152:155], v[180:183], a[184:187], v[152:155]
  ds_read_b64_tr_b16 v[174:175], v12 offset:29184
  v_lshlrev_b32 v2, 1, v2
  v_mfma_f32_16x16x32_bf16 v[140:143], v[176:179], a[188:191], v[140:143]
  buffer_load_dwordx4 v3, s[16:19], s64 offen offset:0 lds
  v_mfma_f32_16x16x32_bf16 v[156:159], v[180:183], a[188:191], v[156:159]
  s_waitcnt lgkmcnt(4)
  v_and_b32 v28, 7, v0
  v_xor_b32 v2, v2, v28
  v_mfma_f32_16x16x32_bf16 v[96:99], v[160:163], a[192:195], v[96:99]
  ds_read_b64_tr_b16 v[176:177], v12 offset:26624
  v_lshl_add_u32 v27, v2, 4, v27
  v_mfma_f32_16x16x32_bf16 v[112:115], v[164:167], a[192:195], v[112:115]
  ds_read_b64_tr_b16 v[178:179], v12 offset:27136
  v_add_u32 v27, s99, v27
  v_mfma_f32_16x16x32_bf16 v[100:103], v[160:163], a[196:199], v[100:103]
  buffer_load_dwordx4 v3, s[16:19], s65 offen offset:1024 lds
  v_mfma_f32_16x16x32_bf16 v[116:119], v[164:167], a[196:199], v[116:119]
  s_waitcnt lgkmcnt(2)
  v_bfe_u32 v28, v0, 3, 2
  v_xor_b32 v28, s36, v28
  v_mfma_f32_16x16x32_bf16 v[104:107], v[160:163], a[200:203], v[104:107]
  ds_read_b64_tr_b16 v[180:181], v12 offset:29696
  v_lshlrev_b32 v28, 5, v28
  v_mfma_f32_16x16x32_bf16 v[120:123], v[164:167], a[200:203], v[120:123]
  ds_read_b64_tr_b16 v[182:183], v12 offset:30208
  v_bfe_u32 v2, v0, 2, 3
  v_mfma_f32_16x16x32_bf16 v[108:111], v[160:163], a[204:207], v[108:111]
  buffer_load_dwordx4 v3, s[16:19], s66 offen offset:2048 lds
  v_mfma_f32_16x16x32_bf16 v[124:127], v[164:167], a[204:207], v[124:127]
  v_lshl_add_u32 v28, v2, 7, v28
  v_and_b32 v2, 3, v0
  v_mfma_f32_16x16x32_bf16 v[96:99], v[168:171], a[208:211], v[96:99]
  ds_read_b64_tr_b16 v[160:161], v13 offset:24576
  v_lshl_add_u32 v28, v2, 3, v28
  v_mfma_f32_16x16x32_bf16 v[112:115], v[172:175], a[208:211], v[112:115]
  ds_read_b64_tr_b16 v[162:163], v13 offset:25088
  v_lshrrev_b32 v2, 5, v0
  v_mfma_f32_16x16x32_bf16 v[100:103], v[168:171], a[212:215], v[100:103]
  v_mul_u32_u24 v2, 3072, v2
  v_add_u32 v2, v2, v28
  v_mfma_f32_16x16x32_bf16 v[116:119], v[172:175], a[212:215], v[116:119]
  s_waitcnt lgkmcnt(2)
  v_xor_b32 v28, 64, v2
  v_mfma_f32_16x16x32_bf16 v[104:107], v[168:171], a[216:219], v[104:107]
  ds_read_b64_tr_b16 v[164:165], v13 offset:27648
  v_mfma_f32_16x16x32_bf16 v[120:123], v[172:175], a[216:219], v[120:123]
  ds_read_b64_tr_b16 v[166:167], v13 offset:28160
  v_mfma_f32_16x16x32_bf16 v[108:111], v[168:171], a[220:223], v[108:111]
  v_mfma_f32_16x16x32_bf16 v[124:127], v[172:175], a[220:223], v[124:127]
  v_mfma_f32_16x16x32_bf16 v[96:99], v[176:179], a[224:227], v[96:99]
  ds_read_b64_tr_b16 v[168:169], v13 offset:25600
  v_mfma_f32_16x16x32_bf16 v[112:115], v[180:183], a[224:227], v[112:115]
  ds_read_b64_tr_b16 v[170:171], v13 offset:26112
  v_mfma_f32_16x16x32_bf16 v[100:103], v[176:179], a[228:231], v[100:103]
  v_mfma_f32_16x16x32_bf16 v[116:119], v[180:183], a[228:231], v[116:119]
  s_waitcnt lgkmcnt(2)
  v_mfma_f32_16x16x32_bf16 v[104:107], v[176:179], a[232:235], v[104:107]
  ds_read_b64_tr_b16 v[172:173], v13 offset:28672
  v_mfma_f32_16x16x32_bf16 v[120:123], v[180:183], a[232:235], v[120:123]
  ds_read_b64_tr_b16 v[174:175], v13 offset:29184
  v_mfma_f32_16x16x32_bf16 v[108:111], v[176:179], a[236:239], v[108:111]
  v_mfma_f32_16x16x32_bf16 v[124:127], v[180:183], a[236:239], v[124:127]
  s_waitcnt vmcnt(10)
  v_cmp_le_u32 s[60:61], 1, v21
  v_mfma_f32_16x16x32_bf16 v[128:131], v[160:163], a[192:195], v[128:131]
  ds_read_b64_tr_b16 v[176:177], v13 offset:26624
  v_mfma_f32_16x16x32_bf16 v[144:147], v[164:167], a[192:195], v[144:147]
  ds_read_b64_tr_b16 v[178:179], v13 offset:27136
  v_mfma_f32_16x16x32_bf16 v[132:135], v[160:163], a[196:199], v[132:135]
  ds_read_b64_tr_b16 v[180:181], v13 offset:29696
  v_mfma_f32_16x16x32_bf16 v[148:151], v[164:167], a[196:199], v[148:151]
  ds_read_b64_tr_b16 v[182:183], v13 offset:30208
  v_mfma_f32_16x16x32_bf16 v[136:139], v[160:163], a[200:203], v[136:139]
  s_cmp_eq_u64 s[60:61], -1
  s_cbranch_scc0 SLOW0
RES0:
  v_and_b32 v19, 1, v0
  v_mfma_f32_16x16x32_bf16 v[152:155], v[164:167], a[200:203], v[152:155]
  buffer_load_dwordx4 v[200:203], v24, s[4:7], s51 offen offset:0 sc1
  v_mfma_f32_16x16x32_bf16 v[140:143], v[160:163], a[204:207], v[140:143]
  s_waitcnt vmcnt(7) lgkmcnt(0)
  v_lshlrev_b32 v19, 4, v19
  v_mov_b32 v20, 0x3f80
  v_mfma_f32_16x16x32_bf16 v[156:159], v[164:167], a[204:207], v[156:159]
  s_barrier
  v_mfma_f32_16x16x32_bf16 v[128:131], v[168:171], a[208:211], v[128:131]
  ds_read_b64_tr_b16 v[160:161], v12 offset:49152
  s_add_u32 m0, s41, 24576
  v_mfma_f32_16x16x32_bf16 v[144:147], v[172:175], a[208:211], v[144:147]
  ds_read_b64_tr_b16 v[162:163], v12 offset:49664
  v_lshlrev_b32 v19, v19, v20
  v_mfma_f32_16x16x32_bf16 v[132:135], v[168:171], a[212:215], v[132:135]
  buffer_store_dword v15, v30, s[4:7], s101 offen offset:0 sc1
  v_mfma_f32_16x16x32_bf16 v[148:151], v[172:175], a[212:215], v[148:151]
  buffer_load_dwordx4 v3, s[12:15], s67 offen offset:0 lds
  v_mfma_f32_16x16x32_bf16 v[136:139], v[168:171], a[216:219], v[136:139]
  ds_read_b64_tr_b16 v[164:165], v12 offset:52224
  v_bfe_u32 v20, v0, 1, 3
  v_mfma_f32_16x16x32_bf16 v[152:155], v[172:175], a[216:219], v[152:155]
  ds_read_b64_tr_b16 v[166:167], v12 offset:52736
  v_cmp_eq_u32 vcc, 0, v20
  v_mfma_f32_16x16x32_bf16 v[140:143], v[168:171], a[220:223], v[140:143]
  buffer_load_dwordx4 v3, s[12:15], s68 offen offset:1024 lds
  v_mfma_f32_16x16x32_bf16 v[156:159], v[172:175], a[220:223], v[156:159]
  v_cndmask_b32 v184, 0, v19, vcc
  v_cmp_eq_u32 vcc, 1, v20
  v_mfma_f32_16x16x32_bf16 v[128:131], v[176:179], a[224:227], v[128:131]
  ds_read_b64_tr_b16 v[168:169], v12 offset:50176
  v_cndmask_b32 v185, 0, v19, vcc
  v_mfma_f32_16x16x32_bf16 v[144:147], v[180:183], a[224:227], v[144:147]
  ds_read_b64_tr_b16 v[170:171], v12 offset:50688
  v_cmp_eq_u32 vcc, 2, v20
  v_mfma_f32_16x16x32_bf16 v[132:135], v[176:179], a[228:231], v[132:135]
  buffer_load_dwordx4 v3, s[12:15], s69 offen offset:2048 lds
  v_mfma_f32_16x16x32_bf16 v[148:151], v[180:183], a[228:231], v[148:151]
  s_add_u32 m0, s41, 27648
  v_cndmask_b32 v186, 0, v19, vcc
  v_cmp_eq_u32 vcc, 3, v20
  v_mfma_f32_16x16x32_bf16 v[136:139], v[176:179], a[232:235], v[136:139]
  ds_read_b64_tr_b16 v[172:173], v12 offset:53248
  v_cndmask_b32 v187, 0, v19, vcc
  v_mfma_f32_16x16x32_bf16 v[152:155], v[180:183], a[232:235], v[152:155]
  ds_read_b64_tr_b16 v[174:175], v12 offset:53760
  v_cmp_eq_u32 vcc, 4, v20
  v_mfma_f32_16x16x32_bf16 v[140:143], v[176:179], a[236:239], v[140:143]
  buffer_load_dwordx4 v3, s[16:19], s67 offen offset:0 lds
  v_mfma_f32_16x16x32_bf16 v[156:159], v[180:183], a[236:239], v[156:159]
  s_waitcnt lgkmcnt(4)
  v_cndmask_b32 v188, 0, v19, vcc
  v_cmp_eq_u32 vcc, 5, v20
  v_mfma_f32_16x16x32_bf16 v[96:99], v[160:163], a[240:243], v[96:99]
  ds_read_b64_tr_b16 v[176:177], v12 offset:51200
  v_cndmask_b32 v189, 0, v19, vcc
  v_mfma_f32_16x16x32_bf16 v[112:115], v[164:167], a[240:243], v[112:115]
  ds_read_b64_tr_b16 v[178:179], v12 offset:51712
  v_cmp_eq_u32 vcc, 6, v20
  v_mfma_f32_16x16x32_bf16 v[100:103], v[160:163], a[244:247], v[100:103]
  buffer_load_dwordx4 v3, s[16:19], s68 offen offset:1024 lds
  v_mfma_f32_16x16x32_bf16 v[116:119], v[164:167], a[244:247], v[116:119]
  s_waitcnt lgkmcnt(2)
  v_cndmask_b32 v190, 0, v19, vcc
  v_cmp_eq_u32 vcc, 7, v20
  v_mfma_f32_16x16x32_bf16 v[104:107], v[160:163], a[248:251], v[104:107]
  ds_read_b64_tr_b16 v[180:181], v12 offset:54272
  v_cndmask_b32 v191, 0, v19, vcc
  v_mfma_f32_16x16x32_bf16 v[120:123], v[164:167], a[248:251], v[120:123]
  ds_read_b64_tr_b16 v[182:183], v12 offset:54784
  v_mfma_f32_16x16x32_bf16 v[108:111], v[160:163], a[252:255], v[108:111]
  buffer_load_dwordx4 v3, s[16:19], s69 offen offset:2048 lds
  v_mfma_f32_16x16x32_bf16 v[124:127], v[164:167], a[252:255], v[124:127]
  v_mfma_f32_16x16x32_bf16 v[96:99], v[168:171], v[224:227], v[96:99]
  ds_read_b64_tr_b16 v[160:161], v13 offset:49152
  v_mfma_f32_16x16x32_bf16 v[112:115], v[172:175], v[224:227], v[112:115]
  ds_read_b64_tr_b16 v[162:163], v13 offset:49664
  v_mfma_f32_16x16x32_bf16 v[100:103], v[168:171], v[228:231], v[100:103]
  buffer_load_dwordx4 v[204:207], v24, s[4:7], s51 offen offset:256 sc1
  v_mfma_f32_16x16x32_bf16 v[116:119], v[172:175], v[228:231], v[116:119]
  s_waitcnt lgkmcnt(2)
  v_mfma_f32_16x16x32_bf16 v[104:107], v[168:171], v[232:235], v[104:107]
  ds_read_b64_tr_b16 v[164:165], v13 offset:52224
  v_mfma_f32_16x16x32_bf16 v[120:123], v[172:175], v[232:235], v[120:123]
  ds_read_b64_tr_b16 v[166:167], v13 offset:52736
  v_mfma_f32_16x16x32_bf16 v[108:111], v[168:171], v[236:239], v[108:111]
  buffer_load_dwordx4 v[208:211], v24, s[4:7], s51 offen offset:512 sc1
  v_mfma_f32_16x16x32_bf16 v[124:127], v[172:175], v[236:239], v[124:127]
  v_mfma_f32_16x16x32_bf16 v[96:99], v[176:179], v[240:243], v[96:99]
  ds_read_b64_tr_b16 v[168:169], v13 offset:50176
  v_mfma_f32_16x16x32_bf16 v[112:115], v[180:183], v[240:243], v[112:115]
  ds_read_b64_tr_b16 v[170:171], v13 offset:50688
  v_mfma_f32_16x16x32_bf16 v[100:103], v[176:179], v[244:247], v[100:103]
  buffer_load_dwordx4 v[212:215], v18, s[4:7], s51 offen offset:768 sc1
  v_mfma_f32_16x16x32_bf16 v[116:119], v[180:183], v[244:247], v[116:119]
  s_waitcnt lgkmcnt(2)
  s_add_u32 s51, s51, 8192
  v_max_f32 v96, 0, v96
  v_mfma_f32_16x16x32_bf16 v[104:107], v[176:179], v[248:251], v[104:107]
  ds_read_b64_tr_b16 v[172:173], v13 offset:53248
  v_max_f32 v97, 0, v97
  v_mfma_f32_16x16x32_bf16 v[120:123], v[180:183], v[248:251], v[120:123]
  ds_read_b64_tr_b16 v[174:175], v13 offset:53760
  v_max_f32 v98, 0, v98
  v_mfma_f32_16x16x32_bf16 v[108:111], v[176:179], v[252:255], v[108:111]
  buffer_load_dwordx4 v[216:219], v24, s[4:7], s51 offen offset:0 sc1
  v_mfma_f32_16x16x32_bf16 v[124:127], v[180:183], v[252:255], v[124:127]
  v_max_f32 v99, 0, v99
  v_mul_f32 v96, v96, v112
  v_mfma_f32_16x16x32_bf16 v[128:131], v[160:163], a[240:243], v[128:131]
  ds_read_b64_tr_b16 v[176:177], v13 offset:51200
  v_mul_f32 v97, v97, v113
  v_mfma_f32_16x16x32_bf16 v[144:147], v[164:167], a[240:243], v[144:147]
  ds_read_b64_tr_b16 v[178:179], v13 offset:51712
  v_mul_f32 v98, v98, v114
  v_mfma_f32_16x16x32_bf16 v[132:135], v[160:163], a[244:247], v[132:135]
  ds_read_b64_tr_b16 v[180:181], v13 offset:54272
  v_mul_f32 v99, v99, v115
  v_mfma_f32_16x16x32_bf16 v[148:151], v[164:167], a[244:247], v[148:151]
  ds_read_b64_tr_b16 v[182:183], v13 offset:54784
  v_cvt_pk_bf16_f32 v4, v96, v97
  v_mfma_f32_16x16x32_bf16 v[136:139], v[160:163], a[248:251], v[136:139]
  buffer_load_dwordx4 v[220:223], v24, s[4:7], s51 offen offset:256 sc1
  v_mfma_f32_16x16x32_bf16 v[152:155], v[164:167], a[248:251], v[152:155]
  v_cvt_pk_bf16_f32 v5, v98, v99
  v_max_f32 v100, 0, v100
  v_mfma_f32_16x16x32_bf16 v[140:143], v[160:163], a[252:255], v[140:143]
  s_waitcnt vmcnt(13) lgkmcnt(0)
  v_max_f32 v101, 0, v101
  v_max_f32 v102, 0, v102
  v_mfma_f32_16x16x32_bf16 v[156:159], v[164:167], a[252:255], v[156:159]
  s_barrier
  v_mfma_f32_16x16x32_bf16 v[128:131], v[168:171], v[224:227], v[128:131]
  ds_read_b64_tr_b16 v[160:161], v12 offset:0
  s_add_u32 m0, s41, 49152
  v_mfma_f32_16x16x32_bf16 v[144:147], v[172:175], v[224:227], v[144:147]
  ds_read_b64_tr_b16 v[162:163], v12 offset:512
  v_max_f32 v103, 0, v103
  v_mfma_f32_16x16x32_bf16 v[132:135], v[168:171], v[228:231], v[132:135]
  ds_write_b64 v16, v[4:5] offset:40960
  v_mfma_f32_16x16x32_bf16 v[148:151], v[172:175], v[228:231], v[148:151]
  buffer_load_dwordx4 v3, s[12:15], s70 offen offset:0 lds
  v_mfma_f32_16x16x32_bf16 v[136:139], v[168:171], v[232:235], v[136:139]
  ds_read_b64_tr_b16 v[164:165], v12 offset:3072
  v_max_f32 v104, 0, v104
  v_mfma_f32_16x16x32_bf16 v[152:155], v[172:175], v[232:235], v[152:155]
  ds_read_b64_tr_b16 v[166:167], v12 offset:3584
  v_max_f32 v105, 0, v105
  v_mfma_f32_16x16x32_bf16 v[140:143], v[168:171], v[236:239], v[140:143]
  buffer_load_dwordx4 v[48:51], v24, s[4:7], s51 offen offset:512 sc1
  v_mfma_f32_16x16x32_bf16 v[156:159], v[172:175], v[236:239], v[156:159]
  v_max_f32 v106, 0, v106
  v_max_f32 v108, 0, v108
  v_mfma_f32_16x16x32_bf16 v[128:131], v[176:179], v[240:243], v[128:131]
  ds_read_b64_tr_b16 v[168:169], v12 offset:1024
  v_mul_f32 v100, v100, v116
  v_mfma_f32_16x16x32_bf16 v[144:147], v[180:183], v[240:243], v[144:147]
  ds_read_b64_tr_b16 v[170:171], v12 offset:1536
  v_max_f32 v107, 0, v107
  v_mfma_f32_16x16x32_bf16 v[132:135], v[176:179], v[244:247], v[132:135]
  buffer_load_dwordx4 v3, s[12:15], s71 offen offset:1024 lds
  v_mfma_f32_16x16x32_bf16 v[148:151], v[180:183], v[244:247], v[148:151]
  s_waitcnt lgkmcnt(2)
  v_mul_f32 v101, v101, v117
  v_mul_f32 v102, v102, v118
  v_mfma_f32_16x16x32_bf16 v[136:139], v[176:179], v[248:251], v[136:139]
  ds_read_b64_tr_b16 v[172:173], v12 offset:4096
  v_mul_f32 v104, v104, v120
  v_mfma_f32_16x16x32_bf16 v[152:155], v[180:183], v[248:251], v[152:155]
  ds_read_b64_tr_b16 v[174:175], v12 offset:4608
  v_mul_f32 v103, v103, v119
  v_mfma_f32_16x16x32_bf16 v[140:143], v[176:179], v[252:255], v[140:143]
  buffer_load_dwordx4 v[52:55], v18, s[4:7], s51 offen offset:768 sc1
  v_mfma_f32_16x16x32_bf16 v[156:159], v[180:183], v[252:255], v[156:159]
  s_add_u32 s51, s51, 8192
  v_cvt_pk_bf16_f32 v6, v100, v101
  v_mul_f32 v105, v105, v121
  v_mfma_f32_16x16x32_bf16 v[96:99], v[160:163], a[0:3], 0
  ds_read_b64_tr_b16 v[176:177], v12 offset:2048
  v_cvt_pk_bf16_f32 v7, v102, v103
  v_mfma_f32_16x16x32_bf16 v[112:115], v[164:167], a[0:3], 0
  ds_read_b64_tr_b16 v[178:179], v12 offset:2560
  v_mul_f32 v106, v106, v122
  v_mfma_f32_16x16x32_bf16 v[100:103], v[160:163], a[4:7], 0
  ds_write_b64 v16, v[6:7] offset:41984
  v_mfma_f32_16x16x32_bf16 v[116:119], v[164:167], a[4:7], 0
  buffer_load_dwordx4 v3, s[12:15], s72 offen offset:2048 lds
  v_mul_f32 v107, v107, v123
  v_cvt_pk_bf16_f32 v8, v104, v105
  v_cvt_pk_bf16_f32 v9, v106, v107
  v_mfma_f32_16x16x32_bf16 v[104:107], v[160:163], a[8:11], 0
  ds_read_b64_tr_b16 v[180:181], v12 offset:5120
  s_add_u32 m0, s41, 52224
  v_mfma_f32_16x16x32_bf16 v[120:123], v[164:167], a[8:11], 0
  ds_read_b64_tr_b16 v[182:183], v12 offset:5632
  v_max_f32 v109, 0, v109
  v_max_f32 v110, 0, v110
  v_max_f32 v111, 0, v111
  v_mul_f32 v108, v108, v124
  v_mul_f32 v109, v109, v125
  v_mul_f32 v110, v110, v126
  v_mul_f32 v111, v111, v127
  v_cvt_pk_bf16_f32 v10, v108, v109
  v_cvt_pk_bf16_f32 v11, v110, v111
  v_mfma_f32_16x16x32_bf16 v[108:111], v[160:163], a[12:15], 0
  ds_write_b64 v16, v[8:9] offset:43008
  v_mfma_f32_16x16x32_bf16 v[124:127], v[164:167], a[12:15], 0
  buffer_load_dwordx4 v[56:59], v24, s[4:7], s51 offen offset:0 sc1
  s_waitcnt lgkmcnt(6)
  v_mfma_f32_16x16x32_bf16 v[96:99], v[168:171], a[16:19], v[96:99]
  ds_read_b64_tr_b16 v[160:161], v13 offset:0
  v_max_f32 v128, 0, v128
  v_mfma_f32_16x16x32_bf16 v[112:115], v[172:175], a[16:19], v[112:115]
  ds_read_b64_tr_b16 v[162:163], v13 offset:512
  v_max_f32 v129, 0, v129
  v_mfma_f32_16x16x32_bf16 v[100:103], v[168:171], a[20:23], v[100:103]
  ds_write_b64 v16, v[10:11] offset:44032
  v_mfma_f32_16x16x32_bf16 v[116:119], v[172:175], a[20:23], v[116:119]
  buffer_load_dwordx4 v3, s[16:19], s70 offen offset:0 lds
  v_mfma_f32_16x16x32_bf16 v[104:107], v[168:171], a[24:27], v[104:107]
  ds_read_b64_tr_b16 v[164:165], v13 offset:3072
  v_max_f32 v130, 0, v130
  v_mfma_f32_16x16x32_bf16 v[120:123], v[172:175], a[24:27], v[120:123]
  ds_read_b64_tr_b16 v[166:167], v13 offset:3584
  v_max_f32 v131, 0, v131
  s_waitcnt vmcnt(19)
  v_mfma_f32_16x16x32_bf16 v[192:195], v[184:187], v[200:203], 0
  buffer_load_dwordx4 v[60:63], v24, s[4:7], s51 offen offset:256 sc1
  v_mfma_f32_16x16x32_bf16 v[108:111], v[168:171], a[28:31], v[108:111]
  s_waitcnt lgkmcnt(6)
  v_mul_f32 v128, v128, v144
  v_max_f32 v132, 0, v132
  v_mfma_f32_16x16x32_bf16 v[124:127], v[172:175], a[28:31], v[124:127]
  v_max_f32 v133, 0, v133
  v_max_f32 v134, 0, v134
  v_mfma_f32_16x16x32_bf16 v[96:99], v[176:179], a[32:35], v[96:99]
  ds_read_b64_tr_b16 v[168:169], v13 offset:1024
  v_mul_f32 v129, v129, v145
  v_mfma_f32_16x16x32_bf16 v[112:115], v[180:183], a[32:35], v[112:115]
  ds_read_b64_tr_b16 v[170:171], v13 offset:1536
  v_mul_f32 v130, v130, v146
  v_mfma_f32_16x16x32_bf16 v[100:103], v[176:179], a[36:39], v[100:103]
  buffer_load_dwordx4 v3, s[16:19], s71 offen offset:1024 lds
  v_mfma_f32_16x16x32_bf16 v[116:119], v[180:183], a[36:39], v[116:119]
  s_waitcnt lgkmcnt(2)
  v_mul_f32 v131, v131, v147
  v_max_f32 v135, 0, v135
  v_mfma_f32_16x16x32_bf16 v[104:107], v[176:179], a[40:43], v[104:107]
  ds_read_b64_tr_b16 v[172:173], v13 offset:4096
  v_cvt_pk_bf16_f32 v4, v128, v129
  v_mfma_f32_16x16x32_bf16 v[120:123], v[180:183], a[40:43], v[120:123]
  ds_read_b64_tr_b16 v[174:175], v13 offset:4608
  v_mul_f32 v132, v132, v148
  v_mfma_f32_16x16x32_bf16 v[108:111], v[176:179], a[44:47], v[108:111]
  buffer_load_dwordx4 v3, s[16:19], s72 offen offset:2048 lds
  v_mfma_f32_16x16x32_bf16 v[124:127], v[180:183], a[44:47], v[124:127]
  v_cvt_pk_bf16_f32 v5, v130, v131
  v_mul_f32 v133, v133, v149
  v_mfma_f32_16x16x32_bf16 v[128:131], v[160:163], a[0:3], 0
  ds_read_b64_tr_b16 v[176:177], v13 offset:2048
  v_mul_f32 v134, v134, v150
  v_mfma_f32_16x16x32_bf16 v[144:147], v[164:167], a[0:3], 0
  ds_read_b64_tr_b16 v[178:179], v13 offset:2560
  v_mul_f32 v135, v135, v151
  v_cvt_pk_bf16_f32 v6, v132, v133
  v_cvt_pk_bf16_f32 v7, v134, v135
  v_mfma_f32_16x16x32_bf16 v[132:135], v[160:163], a[4:7], 0
  ds_read_b64_tr_b16 v[180:181], v13 offset:5120
  v_max_f32 v136, 0, v136
  v_mfma_f32_16x16x32_bf16 v[148:151], v[164:167], a[4:7], 0
  ds_read_b64_tr_b16 v[182:183], v13 offset:5632
  v_max_f32 v137, 0, v137
  v_max_f32 v138, 0, v138
  v_max_f32 v139, 0, v139
  v_mul_f32 v136, v136, v152
  v_mul_f32 v137, v137, v153
  v_mul_f32 v138, v138, v154
  v_mul_f32 v139, v139, v155
  v_cvt_pk_bf16_f32 v8, v136, v137
  v_cvt_pk_bf16_f32 v9, v138, v139
  v_mfma_f32_16x16x32_bf16 v[136:139], v[160:163], a[8:11], 0
  ds_write_b64 v16, v[4:5] offset:49152
  v_mfma_f32_16x16x32_bf16 v[152:155], v[164:167], a[8:11], 0
  buffer_load_dwordx4 v[80:83], v24, s[4:7], s51 offen offset:512 sc1
  v_max_f32 v140, 0, v140
  v_max_f32 v141, 0, v141
  v_max_f32 v142, 0, v142
STUB7:
  s_cbranch_execz K1_back1
  v_max_f32 v143, 0, v143
  v_mul_f32 v140, v140, v156
  v_mul_f32 v141, v141, v157
  v_mul_f32 v142, v142, v158
  v_mul_f32 v143, v143, v159
  v_cvt_pk_bf16_f32 v10, v140, v141
  v_cvt_pk_bf16_f32 v11, v142, v143
  v_mfma_f32_16x16x32_bf16 v[140:143], v[160:163], a[12:15], 0
  s_waitcnt vmcnt(16) lgkmcnt(1)
  v_mfma_f32_16x16x32_bf16 v[156:159], v[164:167], a[12:15], 0
  s_barrier
  v_mfma_f32_16x16x32_bf16 v[128:131], v[168:171], a[16:19], v[128:131]
  ds_read_b64_tr_b16 v[160:161], v12 offset:24576
  s_add_u32 m0, s41, 0
  v_mfma_f32_16x16x32_bf16 v[144:147], v[172:175], a[16:19], v[144:147]
  ds_read_b64_tr_b16 v[162:163], v12 offset:25088
  v_mfma_f32_16x16x32_bf16 v[132:135], v[168:171], a[20:23], v[132:135]
  ds_write_b64 v16, v[6:7] offset:50176
  v_mfma_f32_16x16x32_bf16 v[148:151], v[172:175], a[20:23], v[148:151]
  buffer_load_dwordx4 v3, s[12:15], s73 offen offset:0 lds
  v_mfma_f32_16x16x32_bf16 v[136:139], v[168:171], a[24:27], v[136:139]
  ds_read_b64_tr_b16 v[164:165], v12 offset:27648
  v_mfma_f32_16x16x32_bf16 v[152:155], v[172:175], a[24:27], v[152:155]
  ds_read_b64_tr_b16 v[166:167], v12 offset:28160
  v_mfma_f32_16x16x32_bf16 v[140:143], v[168:171], a[28:31], v[140:143]
  ds_write_b64 v16, v[8:9] offset:51200
  v_mfma_f32_16x16x32_bf16 v[156:159], v[172:175], a[28:31], v[156:159]
  buffer_load_dwordx4 v3, s[12:15], s74 offen offset:1024 lds
  v_mfma_f32_16x16x32_bf16 v[128:131], v[176:179], a[32:35], v[128:131]
  ds_read_b64_tr_b16 v[168:169], v12 offset:25600
  v_mfma_f32_16x16x32_bf16 v[144:147], v[180:183], a[32:35], v[144:147]
  ds_read_b64_tr_b16 v[170:171], v12 offset:26112
  s_waitcnt vmcnt(17)
  v_mfma_f32_16x16x32_bf16 v[192:195], v[188:191], v[204:207], v[192:195]
  ds_write_b64 v16, v[10:11] offset:52224
  v_mfma_f32_16x16x32_bf16 v[132:135], v[176:179], a[36:39], v[132:135]
  buffer_load_dwordx4 v3, s[12:15], s75 offen offset:2048 lds
  v_mfma_f32_16x16x32_bf16 v[148:151], v[180:183], a[36:39], v[148:151]
  s_add_u32 m0, s41, 3072
  ds_read_b128 a[16:19], v15 offset:8192
  v_mfma_f32_16x16x32_bf16 v[136:139], v[176:179], a[40:43], v[136:139]
  ds_read_b64_tr_b16 v[172:173], v12 offset:28672
  s_waitcnt vmcnt(17)
  v_mfma_f32_16x16x32_bf16 v[196:199], v[184:187], v[208:211], 0
  buffer_load_dwordx4 v[84:87], v18, s[4:7], s51 offen offset:768 sc1
  v_mfma_f32_16x16x32_bf16 v[152:155], v[180:183], a[40:43], v[152:155]
  ds_read_b64_tr_b16 v[174:175], v12 offset:29184
  s_add_u32 s51, s51, 8192
  v_mfma_f32_16x16x32_bf16 v[140:143], v[176:179], a[44:47], v[140:143]
  ds_read_b128 a[20:23], v15 offset:9216
  v_mov_b32 v21, s52
  v_mfma_f32_16x16x32_bf16 v[156:159], v[180:183], a[44:47], v[156:159]
  buffer_load_dwordx4 v3, s[16:19], s73 offen offset:0 lds
  s_waitcnt lgkmcnt(8)
  s_waitcnt vmcnt(18)
  v_mfma_f32_16x16x32_bf16 v[196:199], v[188:191], v[212:215], v[196:199]
  s_mov_b32 vcc_lo, -1
  s_mov_b32 vcc_hi, 0
  v_cndmask_b32 v17, v21, v25, vcc
  v_mfma_f32_16x16x32_bf16 v[96:99], v[160:163], a[48:51], v[96:99]
  ds_read_b64_tr_b16 v[176:177], v12 offset:26624
  v_cndmask_b32 v19, v25, v21, vcc
  v_mfma_f32_16x16x32_bf16 v[112:115], v[164:167], a[48:51], v[112:115]
  ds_read_b64_tr_b16 v[178:179], v12 offset:27136
  v_cndmask_b32 v20, v26, v21, vcc
  v_mfma_f32_16x16x32_bf16 v[100:103], v[160:163], a[52:55], v[100:103]
  buffer_load_dwordx4 v3, s[16:19], s74 offen offset:1024 lds
  s_waitcnt vmcnt(18)
  v_mfma_f32_16x16x32_bf16 v[192:195], v[184:187], v[216:219], v[192:195]
  s_mul_i32 s54, s36, 6144
  s_add_u32 s54, s54, s100
  s_add_u32 s54, s54, 73728
  v_mfma_f32_16x16x32_bf16 v[116:119], v[164:167], a[52:55], v[116:119]
  ds_read_b128 a[24:27], v15 offset:10240
  s_lshl_b32 s50, s36, 13
  v_mfma_f32_16x16x32_bf16 v[104:107], v[160:163], a[56:59], v[104:107]
  ds_read_b64_tr_b16 v[180:181], v12 offset:29696
  v_subrev_u32 v25, s50, v23
  v_mfma_f32_16x16x32_bf16 v[120:123], v[164:167], a[56:59], v[120:123]
  ds_read_b64_tr_b16 v[182:183], v12 offset:30208
  v_mfma_f32_16x16x32_bf16 v[108:111], v[160:163], a[60:63], v[108:111]
  buffer_load_dwordx4 v3, s[16:19], s75 offen offset:2048 lds
  v_mfma_f32_16x16x32_bf16 v[124:127], v[164:167], a[60:63], v[124:127]
  ds_read_b128 a[28:31], v15 offset:11264
  s_waitcnt lgkmcnt(7)
  s_waitcnt vmcnt(18)
  v_mfma_f32_16x16x32_bf16 v[192:195], v[188:191], v[220:223], v[192:195]
  ds_read_b128 a[0:3], v15 offset:0
  v_mfma_f32_16x16x32_bf16 v[96:99], v[168:171], a[64:67], v[96:99]
  ds_read_b64_tr_b16 v[160:161], v13 offset:24576
  v_mfma_f32_16x16x32_bf16 v[112:115], v[172:175], a[64:67], v[112:115]
  ds_read_b64_tr_b16 v[162:163], v13 offset:25088
  v_mfma_f32_16x16x32_bf16 v[100:103], v[168:171], a[68:71], v[100:103]
  buffer_load_dwordx4 v[88:91], v24, s[4:7], s51 offen offset:0 sc1
  v_mfma_f32_16x16x32_bf16 v[116:119], v[172:175], a[68:71], v[116:119]
  ds_read_b128 a[4:7], v15 offset:1024
  v_mfma_f32_16x16x32_bf16 v[104:107], v[168:171], a[72:75], v[104:107]
  ds_read_b64_tr_b16 v[164:165], v13 offset:27648
  v_mfma_f32_16x16x32_bf16 v[120:123], v[172:175], a[72:75], v[120:123]
  ds_read_b64_tr_b16 v[166:167], v13 offset:28160
  v_mfma_f32_16x16x32_bf16 v[108:111], v[168:171], a[76:79], v[108:111]
  buffer_load_dwordx4 v[92:95], v24, s[4:7], s51 offen offset:256 sc1
  v_mfma_f32_16x16x32_bf16 v[124:127], v[172:175], a[76:79], v[124:127]
  ds_read_b128 a[8:11], v15 offset:2048
  s_waitcnt lgkmcnt(8)
  v_mfma_f32_16x16x32_bf16 v[96:99], v[176:179], a[80:83], v[96:99]
  ds_read_b64_tr_b16 v[168:169], v13 offset:25600
  s_waitcnt vmcnt(18)
  v_mfma_f32_16x16x32_bf16 v[196:199], v[184:187], v[48:51], v[196:199]
  buffer_load_dwordx4 v[32:35], v24, s[4:7], s51 offen offset:512 sc1
  v_mfma_f32_16x16x32_bf16 v[112:115], v[180:183], a[80:83], v[112:115]
  ds_read_b64_tr_b16 v[170:171], v13 offset:26112
  v_mfma_f32_16x16x32_bf16 v[100:103], v[176:179], a[84:87], v[100:103]
  ds_read_b128 a[12:15], v15 offset:3072
  v_mfma_f32_16x16x32_bf16 v[116:119], v[180:183], a[84:87], v[116:119]
  buffer_load_dwordx4 v[64:67], v18, s[4:7], s51 offen offset:768 sc1
  v_mfma_f32_16x16x32_bf16 v[104:107], v[176:179], a[88:91], v[104:107]
  ds_read_b64_tr_b16 v[172:173], v13 offset:28672
  v_cndmask_b32 v18, v21, v26, vcc
  v_mfma_f32_16x16x32_bf16 v[120:123], v[180:183], a[88:91], v[120:123]
  ds_read_b64_tr_b16 v[174:175], v13 offset:29184
  v_lshrrev_b32 v26, 5, v0
  v_mfma_f32_16x16x32_bf16 v[108:111], v[176:179], a[92:95], v[108:111]
  ds_read_b128 a[32:35], v15 offset:16384
  v_mul_u32_u24 v26, 7680, v26
  v_mfma_f32_16x16x32_bf16 v[124:127], v[180:183], a[92:95], v[124:127]
  ds_read_b128 a[36:39], v15 offset:17408
  s_waitcnt lgkmcnt(8)
  s_waitcnt vmcnt(18)
  v_mfma_f32_16x16x32_bf16 v[196:199], v[188:191], v[52:55], v[196:199]
  s_xor_b32 s53, s101, 16
  v_add_u32 v26, v26, v25
  s_and_b32 s43, s33, 1
  v_mfma_f32_16x16x32_bf16 v[128:131], v[160:163], a[48:51], v[128:131]
  ds_read_b64_tr_b16 v[176:177], v13 offset:26624
  s_mul_i32 s42, s43, 180224
  v_mfma_f32_16x16x32_bf16 v[144:147], v[164:167], a[48:51], v[144:147]
  ds_read_b64_tr_b16 v[178:179], v13 offset:27136
  s_add_u32 s38, s100, 90112
  v_mfma_f32_16x16x32_bf16 v[132:135], v[160:163], a[52:55], v[132:135]
  ds_read_b64_tr_b16 v[180:181], v13 offset:29696
  s_sub_u32 s38, s38, s42
  v_mfma_f32_16x16x32_bf16 v[148:151], v[164:167], a[52:55], v[148:151]
  ds_read_b64_tr_b16 v[182:183], v13 offset:30208
  v_mfma_f32_16x16x32_bf16 v[136:139], v[160:163], a[56:59], v[136:139]
  buffer_load_dword v24, off, s[4:7], s53 offset:0 sc1
  v_mfma_f32_16x16x32_bf16 v[152:155], v[164:167], a[56:59], v[152:155]
  ds_read_b128 a[40:43], v15 offset:18432
  v_mfma_f32_16x16x32_bf16 v[140:143], v[160:163], a[60:63], v[140:143]
  s_waitcnt vmcnt(13) lgkmcnt(1)
  ds_read_b128 a[44:47], v15 offset:19456
  v_mfma_f32_16x16x32_bf16 v[192:195], v[184:187], v[56:59], v[192:195]
  v_mfma_f32_16x16x32_bf16 v[192:195], v[188:191], v[60:63], v[192:195]
  v_mfma_f32_16x16x32_bf16 v[156:159], v[164:167], a[60:63], v[156:159]
  s_barrier
  v_mfma_f32_16x16x32_bf16 v[128:131], v[168:171], a[64:67], v[128:131]
  ds_read_b64_tr_b16 v[160:161], v12 offset:49152
  s_add_u32 m0, s41, 24576
  v_mfma_f32_16x16x32_bf16 v[144:147], v[172:175], a[64:67], v[144:147]
  ds_read_b64_tr_b16 v[162:163], v12 offset:49664
  s_add_u32 s49, s39, 114688
  v_mfma_f32_16x16x32_bf16 v[132:135], v[168:171], a[68:71], v[132:135]
  buffer_load_dwordx4 v3, s[12:15], s76 offen offset:0 lds
  v_mfma_f32_16x16x32_bf16 v[148:151], v[172:175], a[68:71], v[148:151]
  ds_read_b128 a[48:51], v15 offset:24576
  v_add_u32 v4, s49, v1
  v_mfma_f32_16x16x32_bf16 v[136:139], v[168:171], a[72:75], v[136:139]
  ds_read_b64_tr_b16 v[164:165], v12 offset:52224
  s_add_u32 s49, s100, 40960
  v_mfma_f32_16x16x32_bf16 v[152:155], v[172:175], a[72:75], v[152:155]
  ds_read_b64_tr_b16 v[166:167], v12 offset:52736
  v_mfma_f32_16x16x32_bf16 v[140:143], v[168:171], a[76:79], v[140:143]
  buffer_load_dwordx4 v3, s[12:15], s77 offen offset:1024 lds
  v_mfma_f32_16x16x32_bf16 v[156:159], v[172:175], a[76:79], v[156:159]
  ds_read_b128 v[8:11], v4 offset:1024
  v_mfma_f32_16x16x32_bf16 v[128:131], v[176:179], a[80:83], v[128:131]
  ds_read_b64_tr_b16 v[168:169], v12 offset:50176
  v_mfma_f32_16x16x32_bf16 v[144:147], v[180:183], a[80:83], v[144:147]
  ds_read_b64_tr_b16 v[170:171], v12 offset:50688
  v_mfma_f32_16x16x32_bf16 v[132:135], v[176:179], a[84:87], v[132:135]
  buffer_load_dwordx4 v3, s[12:15], s78 offen offset:2048 lds
  v_mfma_f32_16x16x32_bf16 v[148:151], v[180:183], a[84:87], v[148:151]
  s_add_u32 m0, s41, 27648
  ds_read_b128 v[4:7], v4
  v_mfma_f32_16x16x32_bf16 v[136:139], v[176:179], a[88:91], v[136:139]
  ds_read_b64_tr_b16 v[172:173], v12 offset:53248
  v_mfma_f32_16x16x32_bf16 v[152:155], v[180:183], a[88:91], v[152:155]
  ds_read_b64_tr_b16 v[174:175], v12 offset:53760
  v_mfma_f32_16x16x32_bf16 v[140:143], v[176:179], a[92:95], v[140:143]
  buffer_load_dwordx4 v3, s[16:19], s76 offen offset:0 lds
  v_mfma_f32_16x16x32_bf16 v[156:159], v[180:183], a[92:95], v[156:159]
  ds_read_b128 a[52:55], v15 offset:25600
  s_waitcnt lgkmcnt(7)
  v_mfma_f32_16x16x32_bf16 v[96:99], v[160:163], a[96:99], v[96:99]
  ds_read_b64_tr_b16 v[176:177], v12 offset:51200
  v_mfma_f32_16x16x32_bf16 v[112:115], v[164:167], a[96:99], v[112:115]
  ds_read_b64_tr_b16 v[178:179], v12 offset:51712
  v_mfma_f32_16x16x32_bf16 v[100:103], v[160:163], a[100:103], v[100:103]
  buffer_load_dwordx4 v3, s[16:19], s77 offen offset:1024 lds
  v_mfma_f32_16x16x32_bf16 v[116:119], v[164:167], a[100:103], v[116:119]
  ds_read_b128 a[56:59], v15 offset:26624
  v_mfma_f32_16x16x32_bf16 v[104:107], v[160:163], a[104:107], v[104:107]
  ds_read_b64_tr_b16 v[180:181], v12 offset:54272
  s_waitcnt vmcnt(17)
  v_mfma_f32_16x16x32_bf16 v[196:199], v[184:187], v[80:83], v[196:199]
  ds_read_b128 a[60:63], v15 offset:27648
  v_mfma_f32_16x16x32_bf16 v[120:123], v[164:167], a[104:107], v[120:123]
  ds_read_b64_tr_b16 v[182:183], v12 offset:54784
  v_mfma_f32_16x16x32_bf16 v[108:111], v[160:163], a[108:111], v[108:111]
  buffer_load_dwordx4 v3, s[16:19], s78 offen offset:2048 lds
  v_mfma_f32_16x16x32_bf16 v[124:127], v[164:167], a[108:111], v[124:127]
  ds_read_b128 a[64:67], v15 offset:32768
  s_waitcnt lgkmcnt(8)
  v_mfma_f32_16x16x32_bf16 v[96:99], v[168:171], a[112:115], v[96:99]
  ds_read_b64_tr_b16 v[160:161], v13 offset:49152
  v_mfma_f32_16x16x32_bf16 v[112:115], v[172:175], a[112:115], v[112:115]
  ds_read_b64_tr_b16 v[162:163], v13 offset:49664
  v_mfma_f32_16x16x32_bf16 v[100:103], v[168:171], a[116:119], v[100:103]
  buffer_store_dwordx4 v[8:11], v1, s[4:7], s49 offen offset:1024 sc1
  v_mfma_f32_16x16x32_bf16 v[116:119], v[172:175], a[116:119], v[116:119]
  buffer_store_dwordx4 v[4:7], v1, s[4:7], s49 offen sc1
  v_mfma_f32_16x16x32_bf16 v[104:107], v[168:171], a[120:123], v[104:107]
  ds_read_b64_tr_b16 v[164:165], v13 offset:52224
  s_add_u32 s49, s39, 122880
  v_mfma_f32_16x16x32_bf16 v[120:123], v[172:175], a[120:123], v[120:123]
  ds_read_b64_tr_b16 v[166:167], v13 offset:52736
  v_add_u32 v4, s49, v1
  v_mfma_f32_16x16x32_bf16 v[108:111], v[168:171], a[124:127], v[108:111]
  ds_read_b128 v[8:11], v4 offset:1024
  s_add_u32 s49, s100, 49152
  v_mfma_f32_16x16x32_bf16 v[124:127], v[172:175], a[124:127], v[124:127]
  ds_read_b128 v[4:7], v4
  s_waitcnt lgkmcnt(7)
  v_mfma_f32_16x16x32_bf16 v[96:99], v[176:179], a[128:131], v[96:99]
  ds_read_b64_tr_b16 v[168:169], v13 offset:50176
  v_mfma_f32_16x16x32_bf16 v[112:115], v[180:183], a[128:131], v[112:115]
  ds_read_b64_tr_b16 v[170:171], v13 offset:50688
  v_mfma_f32_16x16x32_bf16 v[100:103], v[176:179], a[132:135], v[100:103]
  ds_read_b128 a[68:71], v15 offset:33792
  v_mfma_f32_16x16x32_bf16 v[116:119], v[180:183], a[132:135], v[116:119]
  ds_read_b128 a[72:75], v15 offset:34816
  v_mfma_f32_16x16x32_bf16 v[104:107], v[176:179], a[136:139], v[104:107]
  ds_read_b64_tr_b16 v[172:173], v13 offset:53248
  s_waitcnt vmcnt(16)
  v_mfma_f32_16x16x32_bf16 v[196:199], v[188:191], v[84:87], v[196:199]
  s_waitcnt lgkmcnt(6)
  buffer_store_dwordx4 v[8:11], v1, s[4:7], s49 offen offset:1024 sc1
  v_mfma_f32_16x16x32_bf16 v[120:123], v[180:183], a[136:139], v[120:123]
  ds_read_b64_tr_b16 v[174:175], v13 offset:53760
  v_mfma_f32_16x16x32_bf16 v[108:111], v[176:179], a[140:143], v[108:111]
  s_waitcnt lgkmcnt(6)
  buffer_store_dwordx4 v[4:7], v1, s[4:7], s49 offen sc1
  v_mfma_f32_16x16x32_bf16 v[124:127], v[180:183], a[140:143], v[124:127]
  ds_read_b128 a[76:79], v15 offset:35840
  v_mfma_f32_16x16x32_bf16 v[128:131], v[160:163], a[96:99], v[128:131]
  ds_read_b64_tr_b16 v[176:177], v13 offset:51200
  v_mfma_f32_16x16x32_bf16 v[144:147], v[164:167], a[96:99], v[144:147]
  ds_read_b64_tr_b16 v[178:179], v13 offset:51712
  v_mfma_f32_16x16x32_bf16 v[132:135], v[160:163], a[100:103], v[132:135]
  ds_read_b64_tr_b16 v[180:181], v13 offset:54272
  v_mfma_f32_16x16x32_bf16 v[148:151], v[164:167], a[100:103], v[148:151]
  ds_read_b64_tr_b16 v[182:183], v13 offset:54784
  v_mfma_f32_16x16x32_bf16 v[136:139], v[160:163], a[104:107], v[136:139]
  ds_read_b128 a[80:83], v15 offset:40960
  v_mfma_f32_16x16x32_bf16 v[152:155], v[164:167], a[104:107], v[152:155]
  ds_read_b128 a[84:87], v15 offset:41984
  v_mfma_f32_16x16x32_bf16 v[140:143], v[160:163], a[108:111], v[140:143]
  s_waitcnt vmcnt(15) lgkmcnt(2)
  ds_read_b128 a[88:91], v15 offset:43008
  v_mfma_f32_16x16x32_bf16 v[156:159], v[164:167], a[108:111], v[156:159]
  s_barrier
  v_mfma_f32_16x16x32_bf16 v[128:131], v[168:171], a[112:115], v[128:131]
  ds_read_b64_tr_b16 v[160:161], v12 offset:0
  s_add_u32 m0, s41, 49152
  v_mfma_f32_16x16x32_bf16 v[144:147], v[172:175], a[112:115], v[144:147]
  ds_read_b64_tr_b16 v[162:163], v12 offset:512
  v_mfma_f32_16x16x32_bf16 v[132:135], v[168:171], a[116:119], v[132:135]
  buffer_load_dwordx4 v3, s[12:15], s79 offen offset:0 lds
  v_mfma_f32_16x16x32_bf16 v[148:151], v[172:175], a[116:119], v[148:151]
  ds_read_b128 a[92:95], v15 offset:44032
  v_mfma_f32_16x16x32_bf16 v[136:139], v[168:171], a[120:123], v[136:139]
  ds_read_b64_tr_b16 v[164:165], v12 offset:3072
  s_waitcnt vmcnt(15)
  v_mfma_f32_16x16x32_bf16 v[192:195], v[184:187], v[88:91], v[192:195]
  ds_read_b128 a[96:99], v15 offset:49152
  v_mfma_f32_16x16x32_bf16 v[152:155], v[172:175], a[120:123], v[152:155]
  ds_read_b64_tr_b16 v[166:167], v12 offset:3584
  v_mfma_f32_16x16x32_bf16 v[140:143], v[168:171], a[124:127], v[140:143]
  buffer_load_dwordx4 v3, s[12:15], s80 offen offset:1024 lds
  v_mfma_f32_16x16x32_bf16 v[156:159], v[172:175], a[124:127], v[156:159]
  ds_read_b128 a[100:103], v15 offset:50176
  s_waitcnt vmcnt(15)
  v_mfma_f32_16x16x32_bf16 v[192:195], v[188:191], v[92:95], v[192:195]
  ds_read_b128 a[104:107], v15 offset:51200
  v_mfma_f32_16x16x32_bf16 v[128:131], v[176:179], a[128:131], v[128:131]
  ds_read_b64_tr_b16 v[168:169], v12 offset:1024
  v_mfma_f32_16x16x32_bf16 v[144:147], v[180:183], a[128:131], v[144:147]
  ds_read_b64_tr_b16 v[170:171], v12 offset:1536
  s_waitcnt vmcnt(14)
  v_mfma_f32_16x16x32_bf16 v[196:199], v[184:187], v[32:35], v[196:199]
  ds_read_b128 a[108:111], v15 offset:52224
  v_cvt_pk_bf16_f32 v192, v192, v193
  v_mfma_f32_16x16x32_bf16 v[132:135], v[176:179], a[132:135], v[132:135]
  buffer_load_dwordx4 v3, s[12:15], s81 offen offset:2048 lds
  v_mfma_f32_16x16x32_bf16 v[148:151], v[180:183], a[132:135], v[148:151]
  s_add_u32 m0, s41, 52224
  v_cvt_pk_bf16_f32 v193, v194, v195
  s_waitcnt vmcnt(14)
  v_mfma_f32_16x16x32_bf16 v[196:199], v[188:191], v[64:67], v[196:199]
  ds_write_b64 v22, v[192:193] offset:0
  v_mfma_f32_16x16x32_bf16 v[136:139], v[176:179], a[136:139], v[136:139]
  ds_read_b64_tr_b16 v[172:173], v12 offset:4096
  v_mfma_f32_16x16x32_bf16 v[152:155], v[180:183], a[136:139], v[152:155]
  ds_read_b64_tr_b16 v[174:175], v12 offset:4608
  v_mfma_f32_16x16x32_bf16 v[140:143], v[176:179], a[140:143], v[140:143]
  buffer_load_dwordx4 v3, s[16:19], s79 offen offset:0 lds
  v_mfma_f32_16x16x32_bf16 v[156:159], v[180:183], a[140:143], v[156:159]
  s_waitcnt lgkmcnt(8)
  v_cvt_pk_bf16_f32 v196, v196, v197
  v_cvt_pk_bf16_f32 v197, v198, v199
  v_mfma_f32_16x16x32_bf16 v[96:99], v[160:163], a[144:147], v[96:99]
  ds_read_b64_tr_b16 v[176:177], v12 offset:2048
  v_mfma_f32_16x16x32_bf16 v[112:115], v[164:167], a[144:147], v[112:115]
  ds_read_b64_tr_b16 v[178:179], v12 offset:2560
  v_mfma_f32_16x16x32_bf16 v[100:103], v[160:163], a[148:151], v[100:103]
  ds_write_b64 v22, v[196:197] offset:512
  v_mfma_f32_16x16x32_bf16 v[116:119], v[164:167], a[148:151], v[116:119]
  buffer_load_dwordx4 v3, s[16:19], s80 offen offset:1024 lds
  v_mfma_f32_16x16x32_bf16 v[104:107], v[160:163], a[152:155], v[104:107]
  ds_read_b64_tr_b16 v[180:181], v12 offset:5120
  s_waitcnt vmcnt(15)
  v_cmp_le_u32 s[62:63], 1, v24
  v_mfma_f32_16x16x32_bf16 v[120:123], v[164:167], a[152:155], v[120:123]
  ds_read_b64_tr_b16 v[182:183], v12 offset:5632
  v_mfma_f32_16x16x32_bf16 v[108:111], v[160:163], a[156:159], v[108:111]
  buffer_load_dwordx4 v3, s[16:19], s81 offen offset:2048 lds
  v_mfma_f32_16x16x32_bf16 v[124:127], v[164:167], a[156:159], v[124:127]
  s_cmp_eq_u64 s[62:63], -1
  s_cbranch_scc0 SLOW20
RES20:
  s_add_u32 m0, s39, 81920
  s_waitcnt lgkmcnt(5)
  v_mfma_f32_16x16x32_bf16 v[96:99], v[168:171], a[160:163], v[96:99]
  ds_read_b64_tr_b16 v[160:161], v13 offset:0
  s_add_u32 s37, s38, 8192
  v_mfma_f32_16x16x32_bf16 v[112:115], v[172:175], a[160:163], v[112:115]
  ds_read_b64_tr_b16 v[162:163], v13 offset:512
  s_xor_b32 s44, s33, 1
  v_mfma_f32_16x16x32_bf16 v[100:103], v[168:171], a[164:167], v[100:103]
  ds_read_b64_tr_b16 v[164:165], v13 offset:3072
  s_mul_i32 s45, s44, 331776
  v_mfma_f32_16x16x32_bf16 v[116:119], v[172:175], a[164:167], v[116:119]
  ds_read_b64_tr_b16 v[166:167], v13 offset:3584
  s_mul_i32 s44, s44, 41472
  v_mfma_f32_16x16x32_bf16 v[104:107], v[168:171], a[168:171], v[104:107]
  buffer_load_dwordx4 v1, s[4:7], s37 offen offset:0 sc1  lds
  v_mfma_f32_16x16x32_bf16 v[120:123], v[172:175], a[168:171], v[120:123]
  s_mul_i32 s51, s43, 294912
  s_add_u32 s51, s51, s45
  s_xor_b32 s42, s43, 1
  v_mfma_f32_16x16x32_bf16 v[108:111], v[168:171], a[172:175], v[108:111]
  s_waitcnt lgkmcnt(0)
  s_mul_i32 s42, s42, 36864
  s_add_u32 s45, s45, s42
  v_mfma_f32_16x16x32_bf16 v[124:127], v[172:175], a[172:175], v[124:127]
  s_barrier
  v_mfma_f32_16x16x32_bf16 v[96:99], v[176:179], a[176:179], v[96:99]
  ds_read_b64_tr_b16 v[168:169], v13 offset:1024
  s_add_u32 s64, s45, 0
  v_mfma_f32_16x16x32_bf16 v[112:115], v[180:183], a[176:179], v[112:115]
  ds_read_b64_tr_b16 v[170:171], v13 offset:1536
  s_sub_u32 s65, s51, 1024
  v_mfma_f32_16x16x32_bf16 v[100:103], v[176:179], a[180:183], v[100:103]
  ds_read_b128 v[184:187], v17 offset:0
  s_add_u32 s66, s45, 34816
  v_mfma_f32_16x16x32_bf16 v[116:119], v[180:183], a[180:183], v[116:119]
  ds_read_b128 v[188:191], v17 offset:16
  s_add_u32 s67, s45, 73728
  v_mfma_f32_16x16x32_bf16 v[104:107], v[176:179], a[184:187], v[104:107]
  ds_read_b64_tr_b16 v[172:173], v13 offset:4096
  s_add_u32 s68, s45, 109568
  v_mfma_f32_16x16x32_bf16 v[120:123], v[180:183], a[184:187], v[120:123]
  ds_read_b64_tr_b16 v[174:175], v13 offset:4608
  s_add_u32 s69, s45, 145408
  v_mfma_f32_16x16x32_bf16 v[108:111], v[176:179], a[188:191], v[108:111]
  ds_read_b128 v[192:195], v17 offset:32
  s_add_u32 s44, s44, 4096
  v_mfma_f32_16x16x32_bf16 v[124:127], v[180:183], a[188:191], v[124:127]
  ds_read_b128 v[196:199], v18 offset:0
  s_mul_i32 s70, s35, 2304
  v_mfma_f32_16x16x32_bf16 v[128:131], v[160:163], a[144:147], v[128:131]
  ds_read_b64_tr_b16 v[176:177], v13 offset:2048
  s_add_u32 s70, s70, s44
  s_waitcnt lgkmcnt(6)
  v_mfma_f32_16x16x32_bf16 v[208:211], v[184:187], v[40:43], 0
  ds_read_b128 v[200:203], v18 offset:16
  s_mul_i32 s42, s33, 41472
  s_waitcnt lgkmcnt(6)
  v_mfma_f32_16x16x32_bf16 v[208:211], v[188:191], v[44:47], v[208:211]
  ds_read_b128 v[204:207], v18 offset:32
  s_add_u32 s42, s42, 22528
  v_mfma_f32_16x16x32_bf16 v[144:147], v[164:167], a[144:147], v[144:147]
  ds_read_b64_tr_b16 v[178:179], v13 offset:2560
  s_add_u32 s72, s45, 182272
  v_mfma_f32_16x16x32_bf16 v[132:135], v[160:163], a[148:151], v[132:135]
  ds_read_b64_tr_b16 v[180:181], v13 offset:5120
  s_add_u32 s73, s45, 221184
  s_waitcnt lgkmcnt(6)
  v_mfma_f32_16x16x32_bf16 v[208:211], v[192:195], v[36:39], v[208:211]
  ds_read_b128 v[48:51], v19 offset:0
  s_add_u32 s74, s45, 257024
  s_waitcnt lgkmcnt(6)
  v_mfma_f32_16x16x32_bf16 v[212:215], v[196:199], v[40:43], 0
  ds_read_b128 v[52:55], v19 offset:16
  v_mfma_f32_16x16x32_bf16 v[148:151], v[164:167], a[148:151], v[148:151]
  ds_read_b64_tr_b16 v[182:183], v13 offset:5632
  s_waitcnt lgkmcnt(6)
  v_mfma_f32_16x16x32_bf16 v[212:215], v[200:203], v[44:47], v[212:215]
  ds_read_b128 v[56:59], v19 offset:32
  s_waitcnt lgkmcnt(6)
  v_mfma_f32_16x16x32_bf16 v[212:215], v[204:207], v[36:39], v[212:215]
  ds_read_b128 v[60:63], v20 offset:0
  v_mfma_f32_16x16x32_bf16 v[136:139], v[160:163], a[152:155], v[136:139]
  ds_read_b128 v[80:83], v20 offset:16
  v_mfma_f32_16x16x32_bf16 v[152:155], v[164:167], a[152:155], v[152:155]
  ds_read_b128 v[84:87], v20 offset:32
  s_waitcnt lgkmcnt(6)
  v_mfma_f32_16x16x32_bf16 v[216:219], v[48:51], v[40:43], 0
  s_cmp_eq_u32 s35, 0
  s_cselect_b32 s71, s42, s44
  v_add_f32 v215, 0x358637bd, v215
  s_waitcnt lgkmcnt(5)
  v_mfma_f32_16x16x32_bf16 v[216:219], v[52:55], v[44:47], v[216:219]
  s_cmp_eq_u32 s36, 0
  s_cselect_b32 s82, s42, s44
  s_mul_i32 s42, s36, 11520
  v_mfma_f32_16x16x32_bf16 v[140:143], v[160:163], a[156:159], v[140:143]
  s_waitcnt vmcnt(11) lgkmcnt(4)
  v_rcp_f32 v215, v215
  s_waitcnt lgkmcnt(3)
  v_mfma_f32_16x16x32_bf16 v[216:219], v[56:59], v[36:39], v[216:219]
  s_add_u32 s71, s71, s42
  v_mul_f32 v208, v208, v215
  v_mul_f32 v209, v209, v215
  s_waitcnt lgkmcnt(2)
  v_mfma_f32_16x16x32_bf16 v[220:223], v[60:63], v[40:43], 0
  s_sub_u32 s71, s71, 1024
  v_mul_f32 v210, v210, v215
  v_mul_f32 v211, v211, v215
  s_waitcnt lgkmcnt(1)
  v_mfma_f32_16x16x32_bf16 v[220:223], v[80:83], v[44:47], v[220:223]
  s_lshl_b32 s42, s35, 30
  v_mul_f32 v212, v212, v215
  v_mul_f32 v213, v213, v215
  s_waitcnt lgkmcnt(0)
  v_mfma_f32_16x16x32_bf16 v[220:223], v[84:87], v[36:39], v[220:223]
  s_sub_u32 s82, s82, 1024
  v_cvt_pk_bf16_f32 v208, v208, v209
  v_cvt_pk_bf16_f32 v209, v210, v211
  v_mfma_f32_16x16x32_bf16 v[156:159], v[164:167], a[156:159], v[156:159]
  s_barrier
  v_mfma_f32_16x16x32_bf16 v[128:131], v[168:171], a[160:163], v[128:131]
  ds_read_b64_tr_b16 v[160:161], v12 offset:24576
  v_cvt_pk_bf16_f32 v210, v212, v213
  v_mfma_f32_16x16x32_bf16 v[212:215], v[196:199], v[72:75], 0
  s_or_b32 s82, s82, s42
  v_mov_b32 v211, 0
  v_add_f32 v223, 0x358637bd, v223
  v_mfma_f32_16x16x32_bf16 v[212:215], v[200:203], v[76:79], v[212:215]
  ds_write_b128 v23, v[208:211] offset:0
  v_mfma_f32_16x16x32_bf16 v[212:215], v[204:207], v[68:71], v[212:215]
  buffer_store_dwordx4 v[208:211], v1, s[4:7], s54 offen offset:0 sc1
  v_mfma_f32_16x16x32_bf16 v[208:211], v[184:187], v[72:75], 0
  s_cmp_eq_u32 s35, 0
  s_cselect_b32 s75, s84, s64
  s_sub_u32 s42, s36, s35
  v_mfma_f32_16x16x32_bf16 v[208:211], v[188:191], v[76:79], v[208:211]
  s_cmp_eq_u32 s35, 0
  s_cselect_b32 s76, s85, s65
  v_add_f32 v215, 0x358637bd, v215
  v_mfma_f32_16x16x32_bf16 v[208:211], v[192:195], v[68:71], v[208:211]
  s_cmp_eq_u32 s35, 0
  s_cselect_b32 s77, s86, s66
  s_mul_i32 s42, s42, 2304
  v_mfma_f32_16x16x32_bf16 v[144:147], v[172:175], a[160:163], v[144:147]
  ds_read_b64_tr_b16 v[162:163], v12 offset:25088
  v_mfma_f32_16x16x32_bf16 v[132:135], v[168:171], a[164:167], v[132:135]
  buffer_load_dwordx4 v1, s[4:7], s37 offen offset:1024 sc1  lds
  v_mfma_f32_16x16x32_bf16 v[148:151], v[172:175], a[164:167], v[148:151]
  s_add_u32 m0, s40, 0
  v_rcp_f32 v223, v223
  v_mfma_f32_16x16x32_bf16 v[136:139], v[168:171], a[168:171], v[136:139]
  ds_read_b64_tr_b16 v[164:165], v12 offset:27648
  v_mul_f32 v216, v216, v223
  v_mfma_f32_16x16x32_bf16 v[152:155], v[172:175], a[168:171], v[152:155]
  ds_read_b64_tr_b16 v[166:167], v12 offset:28160
  v_mul_f32 v217, v217, v223
  v_mfma_f32_16x16x32_bf16 v[140:143], v[168:171], a[172:175], v[140:143]
  buffer_load_dwordx4 v27, s[8:11], s84 offen offset:0 lds
  v_mfma_f32_16x16x32_bf16 v[156:159], v[172:175], a[172:175], v[156:159]
  s_cmp_eq_u32 s35, 0
  s_cselect_b32 s78, s87, s67
  v_mul_f32 v218, v218, v223
  v_mfma_f32_16x16x32_bf16 v[128:131], v[176:179], a[176:179], v[128:131]
  ds_read_b64_tr_b16 v[168:169], v12 offset:25600
  v_mul_f32 v219, v219, v223
  v_mfma_f32_16x16x32_bf16 v[144:147], v[180:183], a[176:179], v[144:147]
  ds_read_b64_tr_b16 v[170:171], v12 offset:26112
  v_mul_f32 v220, v220, v223
  v_mfma_f32_16x16x32_bf16 v[132:135], v[176:179], a[180:183], v[132:135]
  buffer_load_dwordx4 v27, s[8:11], s85 offen offset:1024 lds
  v_mfma_f32_16x16x32_bf16 v[148:151], v[180:183], a[180:183], v[148:151]
  s_waitcnt lgkmcnt(2)
  v_rcp_f32 v215, v215
  v_mfma_f32_16x16x32_bf16 v[136:139], v[176:179], a[184:187], v[136:139]
  ds_read_b64_tr_b16 v[172:173], v12 offset:28672
  v_mul_f32 v221, v221, v223
  v_mfma_f32_16x16x32_bf16 v[152:155], v[180:183], a[184:187], v[152:155]
  ds_read_b64_tr_b16 v[174:175], v12 offset:29184
  v_cvt_pk_bf16_f32 v216, v216, v217
  v_mfma_f32_16x16x32_bf16 v[140:143], v[176:179], a[188:191], v[140:143]
  buffer_load_dwordx4 v27, s[8:11], s86 offen offset:2048 lds
  v_mfma_f32_16x16x32_bf16 v[156:159], v[180:183], a[188:191], v[156:159]
  s_add_u32 m0, s40, 12288
  v_cvt_pk_bf16_f32 v217, v218, v219
  v_cvt_pk_bf16_f32 v218, v220, v221
  v_mfma_f32_16x16x32_bf16 v[220:223], v[60:63], v[72:75], 0
  s_cmp_eq_u32 s35, 0
  s_cselect_b32 s79, s88, s68
  v_mov_b32 v219, 0
  v_mfma_f32_16x16x32_bf16 v[220:223], v[80:83], v[76:79], v[220:223]
  ds_write_b128 v23, v[216:219] offset:1024
  v_mfma_f32_16x16x32_bf16 v[220:223], v[84:87], v[68:71], v[220:223]
  buffer_store_dwordx4 v[216:219], v1, s[4:7], s54 offen offset:1024 sc1
  v_mfma_f32_16x16x32_bf16 v[216:219], v[48:51], v[72:75], 0
  s_cmp_eq_u32 s35, 0
  s_cselect_b32 s80, s89, s69
  v_mul_f32 v208, v208, v215
  v_mfma_f32_16x16x32_bf16 v[216:219], v[52:55], v[76:79], v[216:219]
  s_cmp_eq_u32 s35, 0
  s_cselect_b32 s81, s90, s70
  v_mul_f32 v209, v209, v215
  v_mfma_f32_16x16x32_bf16 v[216:219], v[56:59], v[68:71], v[216:219]
  s_add_u32 s81, s81, s42
  v_mul_f32 v210, v210, v215
  v_mul_f32 v211, v211, v215
  v_mfma_f32_16x16x32_bf16 v[96:99], v[160:163], a[192:195], v[96:99]
  ds_read_b64_tr_b16 v[176:177], v12 offset:26624
  v_mul_f32 v212, v212, v215
  v_mfma_f32_16x16x32_bf16 v[112:115], v[164:167], a[192:195], v[112:115]
  ds_read_b64_tr_b16 v[178:179], v12 offset:27136
  v_mul_f32 v213, v213, v215
  v_mfma_f32_16x16x32_bf16 v[100:103], v[160:163], a[196:199], v[100:103]
  buffer_load_dwordx4 v27, s[8:11], s87 offen offset:0 lds
  v_mfma_f32_16x16x32_bf16 v[116:119], v[164:167], a[196:199], v[116:119]
  s_waitcnt lgkmcnt(3)
  v_cvt_pk_bf16_f32 v208, v208, v209
  v_cvt_pk_bf16_f32 v209, v210, v211
  v_mfma_f32_16x16x32_bf16 v[104:107], v[160:163], a[200:203], v[104:107]
  ds_read_b64_tr_b16 v[180:181], v12 offset:29696
  v_cvt_pk_bf16_f32 v210, v212, v213
  v_mfma_f32_16x16x32_bf16 v[120:123], v[164:167], a[200:203], v[120:123]
  ds_read_b64_tr_b16 v[182:183], v12 offset:30208
  v_mov_b32 v211, 0
  v_mfma_f32_16x16x32_bf16 v[108:111], v[160:163], a[204:207], v[108:111]
  ds_write_b128 v23, v[208:211] offset:2048
  v_mfma_f32_16x16x32_bf16 v[124:127], v[164:167], a[204:207], v[124:127]
  buffer_store_dwordx4 v[208:211], v1, s[4:7], s54 offen offset:2048 sc1
  v_mfma_f32_16x16x32_bf16 v[96:99], v[168:171], a[208:211], v[96:99]
  ds_read_b64_tr_b16 v[160:161], v13 offset:24576
  v_add_f32 v223, 0x358637bd, v223
  v_mfma_f32_16x16x32_bf16 v[112:115], v[172:175], a[208:211], v[112:115]
  ds_read_b64_tr_b16 v[162:163], v13 offset:25088
  v_mfma_f32_16x16x32_bf16 v[100:103], v[168:171], a[212:215], v[100:103]
  buffer_load_dwordx4 v27, s[8:11], s88 offen offset:1024 lds
  v_mfma_f32_16x16x32_bf16 v[116:119], v[172:175], a[212:215], v[116:119]
  s_waitcnt lgkmcnt(3)
STUB8:
  s_cbranch_execz K1_back2
  v_rcp_f32 v223, v223
  v_mfma_f32_16x16x32_bf16 v[104:107], v[168:171], a[216:219], v[104:107]
  ds_read_b64_tr_b16 v[164:165], v13 offset:27648
  v_mul_f32 v216, v216, v223
  v_mfma_f32_16x16x32_bf16 v[120:123], v[172:175], a[216:219], v[120:123]
  ds_read_b64_tr_b16 v[166:167], v13 offset:28160
  v_mul_f32 v217, v217, v223
  v_mfma_f32_16x16x32_bf16 v[108:111], v[168:171], a[220:223], v[108:111]
  buffer_load_dwordx4 v27, s[8:11], s89 offen offset:2048 lds
  v_mfma_f32_16x16x32_bf16 v[124:127], v[172:175], a[220:223], v[124:127]
  s_add_u32 m0, s39, 73728
  s_add_u32 s37, s38, 0
  v_mul_f32 v218, v218, v223
  v_mfma_f32_16x16x32_bf16 v[96:99], v[176:179], a[224:227], v[96:99]
  ds_read_b64_tr_b16 v[168:169], v13 offset:25600
  v_mul_f32 v219, v219, v223
  v_mfma_f32_16x16x32_bf16 v[112:115], v[180:183], a[224:227], v[112:115]
  ds_read_b64_tr_b16 v[170:171], v13 offset:26112
  v_mul_f32 v220, v220, v223
  v_mfma_f32_16x16x32_bf16 v[100:103], v[176:179], a[228:231], v[100:103]
  buffer_load_dwordx4 v1, s[4:7], s37 offen offset:0 sc1  lds
  v_mfma_f32_16x16x32_bf16 v[116:119], v[180:183], a[228:231], v[116:119]
  s_waitcnt lgkmcnt(2)
  v_mul_f32 v221, v221, v223
  v_cvt_pk_bf16_f32 v216, v216, v217
  v_mfma_f32_16x16x32_bf16 v[104:107], v[176:179], a[232:235], v[104:107]
  ds_read_b64_tr_b16 v[172:173], v13 offset:28672
  v_cvt_pk_bf16_f32 v217, v218, v219
  v_mfma_f32_16x16x32_bf16 v[120:123], v[180:183], a[232:235], v[120:123]
  ds_read_b64_tr_b16 v[174:175], v13 offset:29184
  v_cvt_pk_bf16_f32 v218, v220, v221
  v_mfma_f32_16x16x32_bf16 v[108:111], v[176:179], a[236:239], v[108:111]
  buffer_load_dwordx4 v1, s[4:7], s37 offen offset:1024 sc1  lds
  v_mfma_f32_16x16x32_bf16 v[124:127], v[180:183], a[236:239], v[124:127]
  s_add_u32 m0, s39, 90112
  s_add_u32 s37, s38, 16384
  v_mov_b32 v219, 0
  v_mfma_f32_16x16x32_bf16 v[128:131], v[160:163], a[192:195], v[128:131]
  ds_read_b64_tr_b16 v[176:177], v13 offset:26624
  v_mfma_f32_16x16x32_bf16 v[144:147], v[164:167], a[192:195], v[144:147]
  ds_read_b64_tr_b16 v[178:179], v13 offset:27136
  v_mfma_f32_16x16x32_bf16 v[132:135], v[160:163], a[196:199], v[132:135]
  ds_read_b64_tr_b16 v[180:181], v13 offset:29696
  v_mfma_f32_16x16x32_bf16 v[148:151], v[164:167], a[196:199], v[148:151]
  ds_read_b64_tr_b16 v[182:183], v13 offset:30208
  v_mfma_f32_16x16x32_bf16 v[136:139], v[160:163], a[200:203], v[136:139]
  ds_write_b128 v23, v[216:219] offset:3072
  v_mfma_f32_16x16x32_bf16 v[152:155], v[164:167], a[200:203], v[152:155]
  buffer_store_dwordx4 v[216:219], v1, s[4:7], s54 offen offset:3072 sc1
  v_mfma_f32_16x16x32_bf16 v[140:143], v[160:163], a[204:207], v[140:143]
  s_waitcnt vmcnt(14) lgkmcnt(0)
  s_cmp_eq_u32 s35, 0
  s_cselect_b32 s83, s92, s72
  v_mfma_f32_16x16x32_bf16 v[156:159], v[164:167], a[204:207], v[156:159]
  s_barrier
  v_mfma_f32_16x16x32_bf16 v[128:131], v[168:171], a[208:211], v[128:131]
  ds_read_b64_tr_b16 v[160:161], v12 offset:49152
  s_lshl_b32 s42, s36, 11
  v_mfma_f32_16x16x32_bf16 v[144:147], v[172:175], a[208:211], v[144:147]
  ds_read_b64_tr_b16 v[162:163], v12 offset:49664
  s_sub_u32 s52, s38, s42
  v_mfma_f32_16x16x32_bf16 v[132:135], v[168:171], a[212:215], v[132:135]
  buffer_store_dword v15, v30, s[4:7], s101 offen offset:4 sc1
  v_mfma_f32_16x16x32_bf16 v[148:151], v[172:175], a[212:215], v[148:151]
  buffer_load_dwordx4 v1, s[4:7], s37 offen offset:0 sc1  lds
  v_mfma_f32_16x16x32_bf16 v[136:139], v[168:171], a[216:219], v[136:139]
  ds_read_b64_tr_b16 v[164:165], v12 offset:52224
  v_lshrrev_b32 v184, 2, v0
  v_mfma_f32_16x16x32_bf16 v[152:155], v[172:175], a[216:219], v[152:155]
  ds_read_b64_tr_b16 v[166:167], v12 offset:52736
  v_lshl_add_u32 v185, s36, 4, v184
  v_mfma_f32_16x16x32_bf16 v[140:143], v[168:171], a[220:223], v[140:143]
  buffer_load_dwordx4 v1, s[4:7], s37 offen offset:1024 sc1  lds
  v_mfma_f32_16x16x32_bf16 v[156:159], v[172:175], a[220:223], v[156:159]
  v_add_u32 v27, 128, v27
  s_add_u32 m0, s40, 24576
  v_mfma_f32_16x16x32_bf16 v[128:131], v[176:179], a[224:227], v[128:131]
  ds_read_b64_tr_b16 v[168:169], v12 offset:50176
  v_mul_u32_u24 v185, 1152, v185
  v_mfma_f32_16x16x32_bf16 v[144:147], v[180:183], a[224:227], v[144:147]
  ds_read_b64_tr_b16 v[170:171], v12 offset:50688
  v_bfe_u32 v186, v0, 4, 1
  v_mfma_f32_16x16x32_bf16 v[132:135], v[176:179], a[228:231], v[132:135]
  buffer_load_dwordx4 v27, s[8:11], s84 offen offset:0 lds
  v_mfma_f32_16x16x32_bf16 v[148:151], v[180:183], a[228:231], v[148:151]
  ds_read2st64_b64 a[144:147], v25 offset0:0 offset1:16
  v_and_b32 v187, 3, v0
  v_mfma_f32_16x16x32_bf16 v[136:139], v[176:179], a[232:235], v[136:139]
  ds_read_b64_tr_b16 v[172:173], v12 offset:53248
  v_lshlrev_b32 v188, 1, v186
  v_mfma_f32_16x16x32_bf16 v[152:155], v[180:183], a[232:235], v[152:155]
  ds_read_b64_tr_b16 v[174:175], v12 offset:53760
  v_xor_b32 v188, v188, v187
  v_mfma_f32_16x16x32_bf16 v[140:143], v[176:179], a[236:239], v[140:143]
  buffer_load_dwordx4 v27, s[8:11], s85 offen offset:1024 lds
  v_mfma_f32_16x16x32_bf16 v[156:159], v[180:183], a[236:239], v[156:159]
  ds_read2st64_b64 a[148:151], v25 offset0:2 offset1:18
  s_waitcnt lgkmcnt(6)
  v_mfma_f32_16x16x32_bf16 v[96:99], v[160:163], a[240:243], v[96:99]
  ds_read_b64_tr_b16 v[176:177], v12 offset:51200
  v_lshl_add_u32 v185, v188, 4, v185
  v_mfma_f32_16x16x32_bf16 v[112:115], v[164:167], a[240:243], v[112:115]
  ds_read_b64_tr_b16 v[178:179], v12 offset:51712
  s_lshl_b32 s43, s43, 6
  v_mfma_f32_16x16x32_bf16 v[100:103], v[160:163], a[244:247], v[100:103]
  ds_read_b64_tr_b16 v[180:181], v12 offset:54272
  s_add_u32 s43, s43, 512
  v_mfma_f32_16x16x32_bf16 v[116:119], v[164:167], a[244:247], v[116:119]
  ds_read_b64_tr_b16 v[182:183], v12 offset:54784
  v_add_u32 v17, s43, v185
  v_mfma_f32_16x16x32_bf16 v[104:107], v[160:163], a[248:251], v[104:107]
  buffer_load_dwordx4 v27, s[8:11], s86 offen offset:2048 lds
  v_mfma_f32_16x16x32_bf16 v[120:123], v[164:167], a[248:251], v[120:123]
  s_add_u32 m0, s40, 36864
  ds_read2st64_b64 a[152:155], v25 offset0:4 offset1:20
  v_mfma_f32_16x16x32_bf16 v[108:111], v[160:163], a[252:255], v[108:111]
  s_waitcnt lgkmcnt(1)
  ds_read2st64_b64 a[156:159], v25 offset0:6 offset1:22
  v_mfma_f32_16x16x32_bf16 v[124:127], v[164:167], a[252:255], v[124:127]
  s_barrier
  v_mfma_f32_16x16x32_bf16 v[96:99], v[168:171], v[224:227], v[96:99]
  ds_read_b64_tr_b16 v[160:161], v13 offset:49152
  v_xor_b32 v186, s36, v186
  v_mfma_f32_16x16x32_bf16 v[112:115], v[172:175], v[224:227], v[112:115]
  ds_read_b64_tr_b16 v[162:163], v13 offset:49664
  v_lshlrev_b32 v186, 5, v186
  v_mfma_f32_16x16x32_bf16 v[100:103], v[168:171], v[228:231], v[100:103]
  buffer_load_dwordx4 v27, s[8:11], s87 offen offset:0 lds
  v_mfma_f32_16x16x32_bf16 v[116:119], v[172:175], v[228:231], v[116:119]
  ds_read_b64 a[160:161], v26 offset:8
  v_lshl_add_u32 v186, v187, 3, v186
  v_mfma_f32_16x16x32_bf16 v[104:107], v[168:171], v[232:235], v[104:107]
  ds_read_b64_tr_b16 v[164:165], v13 offset:52224
  v_lshl_add_u32 v18, v184, 6, v186
  v_mfma_f32_16x16x32_bf16 v[120:123], v[172:175], v[232:235], v[120:123]
  ds_read_b64_tr_b16 v[166:167], v13 offset:52736
  v_lshrrev_b32 v185, 5, v0
  v_mfma_f32_16x16x32_bf16 v[108:111], v[168:171], v[236:239], v[108:111]
  s_cmp_eq_u32 s35, 0
  s_cselect_b32 s95, s93, s73
  v_mul_u32_u24 v185, 11520, v185
  v_mfma_f32_16x16x32_bf16 v[124:127], v[172:175], v[236:239], v[124:127]
  s_cmp_eq_u32 s35, 0
  s_cselect_b32 s98, s94, s74
  v_add_u32 v21, v17, v185
  v_mfma_f32_16x16x32_bf16 v[96:99], v[176:179], v[240:243], v[96:99]
  ds_read_b64_tr_b16 v[168:169], v13 offset:50176
  v_lshlrev_b32 v19, 3, v0
  v_mfma_f32_16x16x32_bf16 v[112:115], v[180:183], v[240:243], v[112:115]
  ds_read_b64_tr_b16 v[170:171], v13 offset:50688
  v_and_b32 v14, 7, v0
  v_mfma_f32_16x16x32_bf16 v[100:103], v[176:179], v[244:247], v[100:103]
  buffer_load_dwordx4 v27, s[8:11], s88 offen offset:1024 lds
  v_mfma_f32_16x16x32_bf16 v[116:119], v[180:183], v[244:247], v[116:119]
  s_waitcnt lgkmcnt(2)
  v_max_f32 v96, 0, v96
  v_max_f32 v97, 0, v97
  v_mfma_f32_16x16x32_bf16 v[104:107], v[176:179], v[248:251], v[104:107]
  ds_read_b64_tr_b16 v[172:173], v13 offset:53248
  v_max_f32 v98, 0, v98
  v_mfma_f32_16x16x32_bf16 v[120:123], v[180:183], v[248:251], v[120:123]
  ds_read_b64_tr_b16 v[174:175], v13 offset:53760
  v_max_f32 v99, 0, v99
  v_mfma_f32_16x16x32_bf16 v[108:111], v[176:179], v[252:255], v[108:111]
  s_mov_b32 s12, s28
  v_mul_f32 v96, v96, v112
  v_mul_f32 v97, v97, v113
  v_mfma_f32_16x16x32_bf16 v[124:127], v[180:183], v[252:255], v[124:127]
  s_mov_b32 s13, s29
  v_mul_f32 v98, v98, v114
  v_mul_f32 v99, v99, v115
  v_mfma_f32_16x16x32_bf16 v[128:131], v[160:163], a[240:243], v[128:131]
  ds_read_b64_tr_b16 v[176:177], v13 offset:51200
  v_cvt_pk_bf16_f32 v4, v96, v97
  v_mfma_f32_16x16x32_bf16 v[144:147], v[164:167], a[240:243], v[144:147]
  ds_read_b64_tr_b16 v[178:179], v13 offset:51712
  v_cvt_pk_bf16_f32 v5, v98, v99
  v_mfma_f32_16x16x32_bf16 v[132:135], v[160:163], a[244:247], v[132:135]
  ds_read_b64_tr_b16 v[180:181], v13 offset:54272
  v_max_f32 v100, 0, v100
  v_mfma_f32_16x16x32_bf16 v[148:151], v[164:167], a[244:247], v[148:151]
  ds_read_b64_tr_b16 v[182:183], v13 offset:54784
  v_max_f32 v101, 0, v101
  v_mfma_f32_16x16x32_bf16 v[136:139], v[160:163], a[248:251], v[136:139]
  ds_write_b64 v16, v[4:5] offset:57344
  v_mfma_f32_16x16x32_bf16 v[152:155], v[164:167], a[248:251], v[152:155]
  buffer_load_dwordx4 v27, s[8:11], s89 offen offset:2048 lds
  v_mfma_f32_16x16x32_bf16 v[140:143], v[160:163], a[252:255], v[140:143]
  s_waitcnt vmcnt(17) lgkmcnt(1)
  s_add_u32 m0, s39, 106496
  s_add_u32 s37, s38, 32768
  v_mfma_f32_16x16x32_bf16 v[156:159], v[164:167], a[252:255], v[156:159]
  s_barrier
  v_mfma_f32_16x16x32_bf16 v[128:131], v[168:171], v[224:227], v[128:131]
  ds_read_b64_tr_b16 v[160:161], v2 offset:0
  v_max_f32 v102, 0, v102
  v_mfma_f32_16x16x32_bf16 v[144:147], v[172:175], v[224:227], v[144:147]
  ds_read_b64_tr_b16 v[162:163], v2 offset:6144
  v_max_f32 v103, 0, v103
  v_mfma_f32_16x16x32_bf16 v[132:135], v[168:171], v[228:231], v[132:135]
  buffer_load_dwordx4 v1, s[4:7], s37 offen offset:0 sc1  lds
  v_mfma_f32_16x16x32_bf16 v[148:151], v[172:175], v[228:231], v[148:151]
  s_mov_b32 s14, 2359296
  v_mul_f32 v100, v100, v116
  v_mul_f32 v101, v101, v117
  v_mfma_f32_16x16x32_bf16 v[136:139], v[168:171], v[232:235], v[136:139]
  ds_read_b64_tr_b16 v[164:165], v28 offset:0
  v_max_f32 v104, 0, v104
  v_mfma_f32_16x16x32_bf16 v[152:155], v[172:175], v[232:235], v[152:155]
  ds_read_b64_tr_b16 v[166:167], v28 offset:6144
  v_max_f32 v105, 0, v105
  v_mfma_f32_16x16x32_bf16 v[140:143], v[168:171], v[236:239], v[140:143]
  s_mov_b32 s16, s30
  v_max_f32 v108, 0, v108
  v_mul_f32 v102, v102, v118
  v_mfma_f32_16x16x32_bf16 v[156:159], v[172:175], v[236:239], v[156:159]
  s_mov_b32 s17, s31
  v_max_f32 v106, 0, v106
  v_max_f32 v109, 0, v109
  v_mfma_f32_16x16x32_bf16 v[128:131], v[176:179], v[240:243], v[128:131]
  ds_read_b64_tr_b16 v[168:169], v2 offset:1024
  v_max_f32 v107, 0, v107
  v_mfma_f32_16x16x32_bf16 v[144:147], v[180:183], v[240:243], v[144:147]
  ds_read_b64_tr_b16 v[170:171], v2 offset:7168
  v_max_f32 v110, 0, v110
  v_mfma_f32_16x16x32_bf16 v[132:135], v[176:179], v[244:247], v[132:135]
  buffer_load_dwordx4 v1, s[4:7], s37 offen offset:1024 sc1  lds
  v_mfma_f32_16x16x32_bf16 v[148:151], v[180:183], v[244:247], v[148:151]
  v_subrev_u32 v27, 128, v27
  s_add_u32 m0, s40, 49152
  v_mfma_f32_16x16x32_bf16 v[136:139], v[176:179], v[248:251], v[136:139]
  ds_read_b64_tr_b16 v[172:173], v28 offset:1024
  v_mul_f32 v104, v104, v120
  v_mfma_f32_16x16x32_bf16 v[152:155], v[180:183], v[248:251], v[152:155]
  ds_read_b64_tr_b16 v[174:175], v28 offset:7168
  v_mul_f32 v103, v103, v119
  v_mfma_f32_16x16x32_bf16 v[140:143], v[176:179], v[252:255], v[140:143]
  buffer_load_dword v24, off, s[4:7], s53 offset:4 sc1
  v_mfma_f32_16x16x32_bf16 v[156:159], v[180:183], v[252:255], v[156:159]
  s_waitcnt lgkmcnt(4)
  v_cvt_pk_bf16_f32 v6, v100, v101
  v_mul_f32 v105, v105, v121
  v_mfma_f32_16x16x32_bf16 v[96:99], v[160:163], a[16:19], 0
  ds_read_b64_tr_b16 v[176:177], v2 offset:2048
  v_cvt_pk_bf16_f32 v7, v102, v103
  v_mfma_f32_16x16x32_bf16 v[112:115], v[164:167], a[16:19], 0
  ds_read_b64_tr_b16 v[178:179], v2 offset:8192
  v_mul_f32 v106, v106, v122
  v_mfma_f32_16x16x32_bf16 v[100:103], v[160:163], a[20:23], 0
  ds_read_b64_tr_b16 v[180:181], v28 offset:2048
  v_mul_f32 v107, v107, v123
  v_mfma_f32_16x16x32_bf16 v[116:119], v[164:167], a[20:23], 0
  ds_read_b64_tr_b16 v[182:183], v28 offset:8192
  v_cvt_pk_bf16_f32 v8, v104, v105
  v_cvt_pk_bf16_f32 v9, v106, v107
  v_mfma_f32_16x16x32_bf16 v[104:107], v[160:163], a[24:27], 0
  ds_write_b64 v16, v[6:7] offset:58368
  v_mfma_f32_16x16x32_bf16 v[120:123], v[164:167], a[24:27], 0
  buffer_load_dwordx4 v27, s[8:11], s93 offen offset:0 lds
  v_max_f32 v111, 0, v111
  v_mul_f32 v108, v108, v124
  v_mul_f32 v109, v109, v125
  v_mul_f32 v110, v110, v126
  v_mul_f32 v111, v111, v127
  v_cvt_pk_bf16_f32 v10, v108, v109
  v_cvt_pk_bf16_f32 v11, v110, v111
  v_mfma_f32_16x16x32_bf16 v[108:111], v[160:163], a[28:31], 0
  s_waitcnt vmcnt(14) lgkmcnt(1)
  ds_read_b64 a[164:165], v26 offset:1032
  v_mfma_f32_16x16x32_bf16 v[124:127], v[164:167], a[28:31], 0
  s_barrier
  v_mfma_f32_16x16x32_bf16 v[96:99], v[168:171], a[0:3], v[96:99]
  ds_read_b64_tr_b16 v[160:161], v2 offset:12288
  v_max_f32 v128, 0, v128
  v_mfma_f32_16x16x32_bf16 v[112:115], v[172:175], a[0:3], v[112:115]
  ds_read_b64_tr_b16 v[162:163], v2 offset:18432
  v_max_f32 v129, 0, v129
  v_mfma_f32_16x16x32_bf16 v[100:103], v[168:171], a[4:7], v[100:103]
  ds_write_b64 v16, v[8:9] offset:59392
  v_mfma_f32_16x16x32_bf16 v[116:119], v[172:175], a[4:7], v[116:119]
  buffer_load_dwordx4 v27, s[8:11], s94 offen offset:1024 lds
  v_mfma_f32_16x16x32_bf16 v[104:107], v[168:171], a[8:11], v[104:107]
  ds_read_b64_tr_b16 v[164:165], v28 offset:12288
  v_add_u32 v27, 128, v27
  v_mfma_f32_16x16x32_bf16 v[120:123], v[172:175], a[8:11], v[120:123]
  ds_read_b64_tr_b16 v[166:167], v28 offset:18432
  s_add_u32 m0, s40, 61440
  v_mfma_f32_16x16x32_bf16 v[108:111], v[168:171], a[12:15], v[108:111]
  ds_write_b64 v16, v[10:11] offset:60416
  v_mfma_f32_16x16x32_bf16 v[124:127], v[172:175], a[12:15], v[124:127]
  s_mov_b32 s18, 2359296
  v_max_f32 v130, 0, v130
  v_max_f32 v131, 0, v131
  v_mfma_f32_16x16x32_bf16 v[96:99], v[176:179], a[32:35], v[96:99]
  ds_read_b64_tr_b16 v[168:169], v2 offset:13312
  v_mul_f32 v128, v128, v144
  v_mfma_f32_16x16x32_bf16 v[112:115], v[180:183], a[32:35], v[112:115]
  ds_read_b64_tr_b16 v[170:171], v2 offset:19456
  v_mul_f32 v129, v129, v145
  v_mfma_f32_16x16x32_bf16 v[100:103], v[176:179], a[36:39], v[100:103]
  buffer_load_dwordx4 v27, s[8:11], s93 offen offset:0 lds
  v_mfma_f32_16x16x32_bf16 v[116:119], v[180:183], a[36:39], v[116:119]
  s_waitcnt lgkmcnt(3)
  v_mul_f32 v130, v130, v146
  v_mul_f32 v131, v131, v147
  v_mfma_f32_16x16x32_bf16 v[104:107], v[176:179], a[40:43], v[104:107]
  ds_read_b64_tr_b16 v[172:173], v28 offset:13312
  v_cvt_pk_bf16_f32 v4, v128, v129
  v_mfma_f32_16x16x32_bf16 v[120:123], v[180:183], a[40:43], v[120:123]
  ds_read_b64_tr_b16 v[174:175], v28 offset:19456
  v_cvt_pk_bf16_f32 v5, v130, v131
  v_mfma_f32_16x16x32_bf16 v[108:111], v[176:179], a[44:47], v[108:111]
  v_add_u32 v16, 24576, v16
  ds_write_b64 v16, v[4:5] offset:40960
  v_mfma_f32_16x16x32_bf16 v[124:127], v[180:183], a[44:47], v[124:127]
  v_max_f32 v132, 0, v132
  v_max_f32 v133, 0, v133
  v_mfma_f32_16x16x32_bf16 v[96:99], v[160:163], a[48:51], v[96:99]
  ds_read_b64_tr_b16 v[176:177], v2 offset:14336
  v_max_f32 v134, 0, v134
  v_mfma_f32_16x16x32_bf16 v[112:115], v[164:167], a[48:51], v[112:115]
  ds_read_b64_tr_b16 v[178:179], v2 offset:20480
  v_max_f32 v135, 0, v135
  v_mfma_f32_16x16x32_bf16 v[100:103], v[160:163], a[52:55], v[100:103]
  ds_read_b64_tr_b16 v[180:181], v28 offset:14336
  v_mul_f32 v132, v132, v148
  v_mfma_f32_16x16x32_bf16 v[116:119], v[164:167], a[52:55], v[116:119]
  ds_read_b64_tr_b16 v[182:183], v28 offset:20480
  v_mul_f32 v133, v133, v149
  v_mfma_f32_16x16x32_bf16 v[104:107], v[160:163], a[56:59], v[104:107]
  buffer_load_dwordx4 v27, s[8:11], s94 offen offset:1024 lds
  v_mfma_f32_16x16x32_bf16 v[120:123], v[164:167], a[56:59], v[120:123]
  v_subrev_u32 v27, 128, v27
  s_add_u32 m0, s40, 0
  v_mfma_f32_16x16x32_bf16 v[108:111], v[160:163], a[60:63], v[108:111]
  s_waitcnt vmcnt(10) lgkmcnt(0)
  v_mul_f32 v134, v134, v150
  v_mul_f32 v135, v135, v151
  v_mfma_f32_16x16x32_bf16 v[124:127], v[164:167], a[60:63], v[124:127]
  s_barrier
  v_mfma_f32_16x16x32_bf16 v[96:99], v[168:171], a[64:67], v[96:99]
  ds_read_b64_tr_b16 v[160:161], v2 offset:24576
  v_cvt_pk_bf16_f32 v6, v132, v133
  v_mfma_f32_16x16x32_bf16 v[112:115], v[172:175], a[64:67], v[112:115]
  ds_read_b64_tr_b16 v[162:163], v2 offset:30720
  v_cvt_pk_bf16_f32 v7, v134, v135
  v_mfma_f32_16x16x32_bf16 v[100:103], v[168:171], a[68:71], v[100:103]
  ds_write_b64 v16, v[6:7] offset:41984
  v_mfma_f32_16x16x32_bf16 v[116:119], v[172:175], a[68:71], v[116:119]
  buffer_store_dword v15, v30, s[4:7], s101 offen offset:8 sc1
  v_mfma_f32_16x16x32_bf16 v[104:107], v[168:171], a[72:75], v[104:107]
  ds_read_b64_tr_b16 v[164:165], v28 offset:24576
  v_max_f32 v136, 0, v136
  v_mfma_f32_16x16x32_bf16 v[120:123], v[172:175], a[72:75], v[120:123]
  ds_read_b64_tr_b16 v[166:167], v28 offset:30720
  v_max_f32 v137, 0, v137
  v_mfma_f32_16x16x32_bf16 v[108:111], v[168:171], a[76:79], v[108:111]
  buffer_load_dwordx4 v27, s[20:23], s90 offen offset:0 lds
  v_mfma_f32_16x16x32_bf16 v[124:127], v[172:175], a[76:79], v[124:127]
  v_max_f32 v138, 0, v138
  v_max_f32 v140, 0, v140
  v_mfma_f32_16x16x32_bf16 v[96:99], v[176:179], a[80:83], v[96:99]
  ds_read_b64_tr_b16 v[168:169], v2 offset:25600
  v_max_f32 v139, 0, v139
  v_mfma_f32_16x16x32_bf16 v[112:115], v[180:183], a[80:83], v[112:115]
  ds_read_b64_tr_b16 v[170:171], v2 offset:31744
  v_max_f32 v141, 0, v141
  v_mfma_f32_16x16x32_bf16 v[100:103], v[176:179], a[84:87], v[100:103]
  buffer_load_dwordx4 v27, s[8:11], s92 offen offset:2048 lds
  v_mfma_f32_16x16x32_bf16 v[116:119], v[180:183], a[84:87], v[116:119]
  v_add_u32 v27, 128, v27
  s_add_u32 m0, s40, 12288
  v_mfma_f32_16x16x32_bf16 v[104:107], v[176:179], a[88:91], v[104:107]
  ds_read_b64_tr_b16 v[172:173], v28 offset:25600
  v_mul_f32 v136, v136, v152
  v_mfma_f32_16x16x32_bf16 v[120:123], v[180:183], a[88:91], v[120:123]
  ds_read_b64_tr_b16 v[174:175], v28 offset:31744
  v_mul_f32 v137, v137, v153
  v_mfma_f32_16x16x32_bf16 v[108:111], v[176:179], a[92:95], v[108:111]
  s_waitcnt lgkmcnt(4)
  v_mul_f32 v138, v138, v154
  v_max_f32 v142, 0, v142
  v_mfma_f32_16x16x32_bf16 v[124:127], v[180:183], a[92:95], v[124:127]
  v_mul_f32 v139, v139, v155
  v_max_f32 v143, 0, v143
  v_mfma_f32_16x16x32_bf16 v[128:131], v[160:163], a[16:19], 0
  ds_read_b64_tr_b16 v[176:177], v2 offset:26624
  v_cvt_pk_bf16_f32 v8, v136, v137
  v_mfma_f32_16x16x32_bf16 v[144:147], v[164:167], a[16:19], 0
  ds_read_b64_tr_b16 v[178:179], v2 offset:32768
  v_mul_f32 v140, v140, v156
  v_mfma_f32_16x16x32_bf16 v[132:135], v[160:163], a[20:23], 0
  ds_read_b64_tr_b16 v[180:181], v28 offset:26624
  v_cvt_pk_bf16_f32 v9, v138, v139
  v_mfma_f32_16x16x32_bf16 v[148:151], v[164:167], a[20:23], 0
  ds_read_b64_tr_b16 v[182:183], v28 offset:32768
  v_mul_f32 v141, v141, v157
  v_mfma_f32_16x16x32_bf16 v[136:139], v[160:163], a[24:27], 0
  ds_write_b64 v16, v[8:9] offset:43008
  v_mfma_f32_16x16x32_bf16 v[152:155], v[164:167], a[24:27], 0
  buffer_load_dwordx4 v27, s[20:23], s90 offen offset:0 lds
  v_mul_f32 v142, v142, v158
  v_mul_f32 v143, v143, v159
  v_cvt_pk_bf16_f32 v10, v140, v141
  v_cvt_pk_bf16_f32 v11, v142, v143
  v_mfma_f32_16x16x32_bf16 v[140:143], v[160:163], a[28:31], 0
  s_waitcnt vmcnt(11) lgkmcnt(1)
  ds_read_b64 a[168:169], v26 offset:2056
  v_mfma_f32_16x16x32_bf16 v[156:159], v[164:167], a[28:31], 0
  s_barrier
  v_mfma_f32_16x16x32_bf16 v[128:131], v[168:171], a[0:3], v[128:131]
  ds_read_b64_tr_b16 v[160:161], v2 offset:36864
  v_lshlrev_b32 v14, 2, v14
  v_mfma_f32_16x16x32_bf16 v[144:147], v[172:175], a[0:3], v[144:147]
  ds_read_b64_tr_b16 v[162:163], v2 offset:43008
  v_mfma_f32_16x16x32_bf16 v[132:135], v[168:171], a[4:7], v[132:135]
  ds_write_b64 v16, v[10:11] offset:44032
  v_mfma_f32_16x16x32_bf16 v[148:151], v[172:175], a[4:7], v[148:151]
  buffer_load_dwordx4 v27, s[8:11], s92 offen offset:2048 lds
  v_mfma_f32_16x16x32_bf16 v[136:139], v[168:171], a[8:11], v[136:139]
  ds_read_b64_tr_b16 v[164:165], v28 offset:36864
  v_subrev_u32 v27, 128, v27
  v_mfma_f32_16x16x32_bf16 v[152:155], v[172:175], a[8:11], v[152:155]
  ds_read_b64_tr_b16 v[166:167], v28 offset:43008
  s_add_u32 m0, s40, 24576
  v_mfma_f32_16x16x32_bf16 v[140:143], v[168:171], a[12:15], v[140:143]
  buffer_load_dwordx4 v27, s[8:11], s64 offen offset:0 lds
  v_mfma_f32_16x16x32_bf16 v[156:159], v[172:175], a[12:15], v[156:159]
  ds_read_b64 a[172:173], v26 offset:3080
  v_mfma_f32_16x16x32_bf16 v[128:131], v[176:179], a[32:35], v[128:131]
  ds_read_b64_tr_b16 v[168:169], v2 offset:37888
  v_mfma_f32_16x16x32_bf16 v[144:147], v[180:183], a[32:35], v[144:147]
  ds_read_b64_tr_b16 v[170:171], v2 offset:44032
  v_mfma_f32_16x16x32_bf16 v[132:135], v[176:179], a[36:39], v[132:135]
  buffer_load_dwordx4 v27, s[8:11], s65 offen offset:1024 lds
  v_mfma_f32_16x16x32_bf16 v[148:151], v[180:183], a[36:39], v[148:151]
  ds_read_b128 a[112:115], v15 offset:57344
  v_mfma_f32_16x16x32_bf16 v[136:139], v[176:179], a[40:43], v[136:139]
  ds_read_b64_tr_b16 v[172:173], v28 offset:37888
  v_mfma_f32_16x16x32_bf16 v[152:155], v[180:183], a[40:43], v[152:155]
  ds_read_b64_tr_b16 v[174:175], v28 offset:44032
  v_mfma_f32_16x16x32_bf16 v[140:143], v[176:179], a[44:47], v[140:143]
  buffer_load_dwordx4 v27, s[8:11], s66 offen offset:2048 lds
  v_mfma_f32_16x16x32_bf16 v[156:159], v[180:183], a[44:47], v[156:159]
  s_add_u32 m0, s39, 98304
  s_add_u32 s37, s38, 24576
  s_waitcnt lgkmcnt(6)
  v_mfma_f32_16x16x32_bf16 v[128:131], v[160:163], a[48:51], v[128:131]
  ds_read_b64_tr_b16 v[176:177], v2 offset:38912
  v_mfma_f32_16x16x32_bf16 v[144:147], v[164:167], a[48:51], v[144:147]
  ds_read_b64_tr_b16 v[178:179], v2 offset:45056
  v_mfma_f32_16x16x32_bf16 v[132:135], v[160:163], a[52:55], v[132:135]
  ds_read_b64_tr_b16 v[180:181], v28 offset:38912
  v_mfma_f32_16x16x32_bf16 v[148:151], v[164:167], a[52:55], v[148:151]
  ds_read_b64_tr_b16 v[182:183], v28 offset:45056
  v_mfma_f32_16x16x32_bf16 v[136:139], v[160:163], a[56:59], v[136:139]
  buffer_load_dwordx4 v1, s[4:7], s37 offen offset:0 sc1  lds
  v_mfma_f32_16x16x32_bf16 v[152:155], v[164:167], a[56:59], v[152:155]
  ds_read_b128 a[116:119], v15 offset:58368
  v_mfma_f32_16x16x32_bf16 v[140:143], v[160:163], a[60:63], v[140:143]
  s_waitcnt vmcnt(11) lgkmcnt(1)
  v_cmp_le_u32 s[62:63], 1, v24
  v_mfma_f32_16x16x32_bf16 v[156:159], v[164:167], a[60:63], v[156:159]
  s_barrier
  v_mfma_f32_16x16x32_bf16 v[128:131], v[168:171], a[64:67], v[128:131]
  ds_read_b64_tr_b16 v[160:161], v2 offset:49152
  s_cmp_eq_u64 s[62:63], -1
  s_cbranch_scc0 SLOW21
RES21:
  v_mfma_f32_16x16x32_bf16 v[144:147], v[172:175], a[64:67], v[144:147]
  ds_read_b64_tr_b16 v[162:163], v2 offset:55296
  s_add_u32 s49, s39, 131072
  v_mfma_f32_16x16x32_bf16 v[132:135], v[168:171], a[68:71], v[132:135]
  buffer_load_dwordx4 v1, s[4:7], s37 offen offset:1024 sc1  lds
  v_mfma_f32_16x16x32_bf16 v[148:151], v[172:175], a[68:71], v[148:151]
  v_add_u32 v27, 128, v27
  s_add_u32 m0, s40, 36864
  v_mfma_f32_16x16x32_bf16 v[136:139], v[168:171], a[72:75], v[136:139]
  ds_read_b64_tr_b16 v[164:165], v28 offset:49152
  v_add_u32 v4, s49, v1
  v_mfma_f32_16x16x32_bf16 v[152:155], v[172:175], a[72:75], v[152:155]
  ds_read_b64_tr_b16 v[166:167], v28 offset:55296
  s_add_u32 s49, s100, 57344
  v_mfma_f32_16x16x32_bf16 v[140:143], v[168:171], a[76:79], v[140:143]
  ds_read_b128 v[8:11], v4 offset:1024
  v_mfma_f32_16x16x32_bf16 v[156:159], v[172:175], a[76:79], v[156:159]
  ds_read_b128 v[4:7], v4
  v_mfma_f32_16x16x32_bf16 v[128:131], v[176:179], a[80:83], v[128:131]
  ds_read_b64_tr_b16 v[168:169], v2 offset:50176
  v_mfma_f32_16x16x32_bf16 v[144:147], v[180:183], a[80:83], v[144:147]
  ds_read_b64_tr_b16 v[170:171], v2 offset:56320
  v_mfma_f32_16x16x32_bf16 v[132:135], v[176:179], a[84:87], v[132:135]
  ds_read_b64_tr_b16 v[172:173], v28 offset:50176
  v_mfma_f32_16x16x32_bf16 v[148:151], v[180:183], a[84:87], v[148:151]
  ds_read_b64_tr_b16 v[174:175], v28 offset:56320
  ds_read_b128 a[120:123], v15 offset:59392
  ds_read_b128 a[124:127], v15 offset:60416
  v_mfma_f32_16x16x32_bf16 v[136:139], v[176:179], a[88:91], v[136:139]
  s_waitcnt lgkmcnt(7)
  buffer_store_dwordx4 v[8:11], v1, s[4:7], s49 offen offset:1024 sc1
  v_mfma_f32_16x16x32_bf16 v[152:155], v[180:183], a[88:91], v[152:155]
  s_waitcnt lgkmcnt(6)
  buffer_store_dwordx4 v[4:7], v1, s[4:7], s49 offen sc1
  v_mfma_f32_16x16x32_bf16 v[140:143], v[176:179], a[92:95], v[140:143]
  s_waitcnt vmcnt(12) lgkmcnt(0)
  v_add_u32 v15, 24576, v15
  ds_read_b128 a[128:131], v15 offset:40960
  v_mfma_f32_16x16x32_bf16 v[156:159], v[180:183], a[92:95], v[156:159]
  s_barrier
  v_mfma_f32_16x16x32_bf16 v[96:99], v[160:163], a[112:115], v[96:99]
  ds_read_b64_tr_b16 v[176:177], v2 offset:61440
  v_add_u32 v2, 62464, v2
  v_mfma_f32_16x16x32_bf16 v[112:115], v[164:167], a[112:115], v[112:115]
  ds_read_b64_tr_b16 v[178:179], v2 offset:5120
  s_add_u32 s49, s39, 139264
  v_mfma_f32_16x16x32_bf16 v[100:103], v[160:163], a[116:119], v[100:103]
  buffer_load_dword v24, off, s[4:7], s53 offset:8 sc1
  v_mfma_f32_16x16x32_bf16 v[116:119], v[164:167], a[116:119], v[116:119]
  buffer_load_dwordx4 v27, s[8:11], s64 offen offset:0 lds
  ds_read_b128 a[132:135], v15 offset:41984
  ds_read_b128 a[136:139], v15 offset:43008
  ds_read_b128 a[140:143], v15 offset:44032
  v_mfma_f32_16x16x32_bf16 v[104:107], v[160:163], a[120:123], v[104:107]
  ds_read_b64_tr_b16 v[180:181], v28 offset:61440
  v_add_u32 v28, 62464, v28
  v_mfma_f32_16x16x32_bf16 v[120:123], v[164:167], a[120:123], v[120:123]
  ds_read_b64_tr_b16 v[182:183], v28 offset:5120
  v_add_u32 v4, s49, v1
  v_mfma_f32_16x16x32_bf16 v[108:111], v[160:163], a[124:127], v[108:111]
  ds_read_b128 v[8:11], v4 offset:1024
  s_add_u32 s49, s100, 65536
  v_mfma_f32_16x16x32_bf16 v[124:127], v[164:167], a[124:127], v[124:127]
  ds_read_b128 v[4:7], v4
  s_waitcnt lgkmcnt(9)
  v_mfma_f32_16x16x32_bf16 v[96:99], v[168:171], a[128:131], v[96:99]
  ds_read_b64_tr_b16 v[160:161], v2 offset:0
  v_mfma_f32_16x16x32_bf16 v[112:115], v[172:175], a[128:131], v[112:115]
  ds_read_b64_tr_b16 v[162:163], v2 offset:6144
  v_subrev_u32 v2, 62464, v2
  s_waitcnt lgkmcnt(8)
  v_mfma_f32_16x16x32_bf16 v[100:103], v[168:171], a[132:135], v[100:103]
  ds_read_b64_tr_b16 v[164:165], v28 offset:0
  v_mfma_f32_16x16x32_bf16 v[116:119], v[172:175], a[132:135], v[116:119]
  ds_read_b64_tr_b16 v[166:167], v28 offset:6144
  v_subrev_u32 v28, 62464, v28
  s_waitcnt lgkmcnt(9)
  v_mfma_f32_16x16x32_bf16 v[104:107], v[168:171], a[136:139], v[104:107]
  s_waitcnt lgkmcnt(5)
  buffer_store_dwordx4 v[8:11], v1, s[4:7], s49 offen offset:1024 sc1
  v_mfma_f32_16x16x32_bf16 v[120:123], v[172:175], a[136:139], v[120:123]
  s_waitcnt lgkmcnt(4)
  buffer_store_dwordx4 v[4:7], v1, s[4:7], s49 offen sc1
  v_mfma_f32_16x16x32_bf16 v[108:111], v[168:171], a[140:143], v[108:111]
  s_waitcnt vmcnt(13) lgkmcnt(0)
  v_subrev_u32 v15, 16384, v15
  ds_read_b128 a[176:179], v15 offset:0
  v_mfma_f32_16x16x32_bf16 v[124:127], v[172:175], a[140:143], v[124:127]
  s_barrier
  v_mfma_f32_16x16x32_bf16 v[128:131], v[176:179], a[112:115], v[128:131]
  ds_read_b64_tr_b16 v[168:169], v2 offset:0
  v_mfma_f32_16x16x32_bf16 v[144:147], v[180:183], a[112:115], v[144:147]
  ds_read_b64_tr_b16 v[170:171], v2 offset:6144
  v_mfma_f32_16x16x32_bf16 v[132:135], v[176:179], a[116:119], v[132:135]
  buffer_load_dwordx4 v27, s[8:11], s65 offen offset:1024 lds
  v_mfma_f32_16x16x32_bf16 v[148:151], v[180:183], a[116:119], v[148:151]
  ds_read_b128 a[180:183], v15 offset:1024
  v_mfma_f32_16x16x32_bf16 v[136:139], v[176:179], a[120:123], v[136:139]
  ds_read_b64_tr_b16 v[172:173], v28 offset:0
  v_mfma_f32_16x16x32_bf16 v[152:155], v[180:183], a[120:123], v[152:155]
  ds_read_b64_tr_b16 v[174:175], v28 offset:6144
  v_mfma_f32_16x16x32_bf16 v[140:143], v[176:179], a[124:127], v[140:143]
  buffer_load_dwordx4 v27, s[8:11], s66 offen offset:2048 lds
  v_mfma_f32_16x16x32_bf16 v[156:159], v[180:183], a[124:127], v[156:159]
  s_add_u32 m0, s39, 114688
  s_add_u32 s37, s38, 40960
  v_mfma_f32_16x16x32_bf16 v[128:131], v[160:163], a[128:131], v[128:131]
  ds_read_b64_tr_b16 v[176:177], v2 offset:2048
  v_mfma_f32_16x16x32_bf16 v[144:147], v[164:167], a[128:131], v[144:147]
  ds_read_b64_tr_b16 v[178:179], v2 offset:8192
  v_mfma_f32_16x16x32_bf16 v[132:135], v[160:163], a[132:135], v[132:135]
STUB9:
  s_cbranch_execz K1_back2
  ds_read_b64_tr_b16 v[180:181], v28 offset:2048
  v_mfma_f32_16x16x32_bf16 v[148:151], v[164:167], a[132:135], v[148:151]
  ds_read_b64_tr_b16 v[182:183], v28 offset:8192
  v_mfma_f32_16x16x32_bf16 v[136:139], v[160:163], a[136:139], v[136:139]
  buffer_load_dwordx4 v1, s[4:7], s37 offen offset:0 sc1  lds
  v_mfma_f32_16x16x32_bf16 v[152:155], v[164:167], a[136:139], v[152:155]
  ds_read_b128 a[184:187], v15 offset:2048
  v_mfma_f32_16x16x32_bf16 v[140:143], v[160:163], a[140:143], v[140:143]
  s_waitcnt vmcnt(14) lgkmcnt(1)
  ds_read_b128 a[188:191], v15 offset:3072
  v_mfma_f32_16x16x32_bf16 v[156:159], v[164:167], a[140:143], v[156:159]
  s_barrier
  v_mfma_f32_16x16x32_bf16 v[96:99], v[168:171], a[144:147], v[96:99]
  ds_read_b64_tr_b16 v[160:161], v2 offset:12288
  v_mfma_f32_16x16x32_bf16 v[112:115], v[172:175], a[144:147], v[112:115]
  ds_read_b64_tr_b16 v[162:163], v2 offset:18432
  v_mfma_f32_16x16x32_bf16 v[100:103], v[168:171], a[148:151], v[100:103]
  buffer_load_dwordx4 v1, s[4:7], s37 offen offset:1024 sc1  lds
  v_mfma_f32_16x16x32_bf16 v[116:119], v[172:175], a[148:151], v[116:119]
  s_add_u32 m0, s40, 49152
  v_subrev_u32 v15, 8192, v15
  ds_read_b128 a[192:195], v15 offset:0
  v_mfma_f32_16x16x32_bf16 v[104:107], v[168:171], a[152:155], v[104:107]
  ds_read_b64_tr_b16 v[164:165], v28 offset:12288
  v_mfma_f32_16x16x32_bf16 v[120:123], v[172:175], a[152:155], v[120:123]
  ds_read_b64_tr_b16 v[166:167], v28 offset:18432
  v_mfma_f32_16x16x32_bf16 v[108:111], v[168:171], a[156:159], v[108:111]
  buffer_load_dwordx4 v17, s[8:11], s75 offen offset:0 lds
  v_mfma_f32_16x16x32_bf16 v[124:127], v[172:175], a[156:159], v[124:127]
  ds_read_b128 a[196:199], v15 offset:1024
  v_mfma_f32_16x16x32_bf16 v[96:99], v[176:179], a[96:99], v[96:99]
  ds_read_b64_tr_b16 v[168:169], v2 offset:14336
  v_mfma_f32_16x16x32_bf16 v[112:115], v[180:183], a[96:99], v[112:115]
  ds_read_b64_tr_b16 v[170:171], v2 offset:20480
  v_mfma_f32_16x16x32_bf16 v[100:103], v[176:179], a[100:103], v[100:103]
  ds_read_b64_tr_b16 v[172:173], v28 offset:14336
  v_mfma_f32_16x16x32_bf16 v[116:119], v[180:183], a[100:103], v[116:119]
  ds_read_b64_tr_b16 v[174:175], v28 offset:20480
  v_mfma_f32_16x16x32_bf16 v[104:107], v[176:179], a[104:107], v[104:107]
  buffer_load_dwordx4 v17, s[8:11], s76 offen offset:1024 lds
  v_mfma_f32_16x16x32_bf16 v[120:123], v[180:183], a[104:107], v[120:123]
  ds_read_b128 a[200:203], v15 offset:2048
  v_mfma_f32_16x16x32_bf16 v[108:111], v[176:179], a[108:111], v[108:111]
  s_waitcnt vmcnt(14) lgkmcnt(1)
  ds_read_b128 a[204:207], v15 offset:3072
  v_mfma_f32_16x16x32_bf16 v[124:127], v[180:183], a[108:111], v[124:127]
  s_barrier
  v_mfma_f32_16x16x32_bf16 v[128:131], v[160:163], a[144:147], v[128:131]
  ds_read_b64_tr_b16 v[176:177], v2 offset:24576
  v_mfma_f32_16x16x32_bf16 v[144:147], v[164:167], a[144:147], v[144:147]
  ds_read_b64_tr_b16 v[178:179], v2 offset:30720
  v_mfma_f32_16x16x32_bf16 v[132:135], v[160:163], a[148:151], v[132:135]
  buffer_load_dwordx4 v17, s[8:11], s77 offen offset:2048 lds
  v_mfma_f32_16x16x32_bf16 v[148:151], v[164:167], a[148:151], v[148:151]
  v_subrev_u32 v27, 128, v27
  s_add_u32 m0, s40, 61440
  v_mfma_f32_16x16x32_bf16 v[136:139], v[160:163], a[152:155], v[136:139]
  ds_read_b64_tr_b16 v[180:181], v28 offset:24576
  v_mfma_f32_16x16x32_bf16 v[152:155], v[164:167], a[152:155], v[152:155]
  ds_read_b64_tr_b16 v[182:183], v28 offset:30720
  v_mfma_f32_16x16x32_bf16 v[140:143], v[160:163], a[156:159], v[140:143]
  buffer_load_dwordx4 v27, s[8:11], s67 offen offset:0 lds
  v_mfma_f32_16x16x32_bf16 v[156:159], v[164:167], a[156:159], v[156:159]
  ds_read_b128 a[208:211], v15 offset:16384
  v_mfma_f32_16x16x32_bf16 v[128:131], v[168:171], a[96:99], v[128:131]
  ds_read_b64_tr_b16 v[160:161], v2 offset:25600
  v_mfma_f32_16x16x32_bf16 v[144:147], v[172:175], a[96:99], v[144:147]
  ds_read_b64_tr_b16 v[162:163], v2 offset:31744
  v_mfma_f32_16x16x32_bf16 v[132:135], v[168:171], a[100:103], v[132:135]
  buffer_load_dwordx4 v27, s[8:11], s68 offen offset:1024 lds
  v_mfma_f32_16x16x32_bf16 v[148:151], v[172:175], a[100:103], v[148:151]
  ds_read_b128 a[212:215], v15 offset:17408
  v_mfma_f32_16x16x32_bf16 v[136:139], v[168:171], a[104:107], v[136:139]
  ds_read_b64_tr_b16 v[164:165], v28 offset:25600
  v_mfma_f32_16x16x32_bf16 v[152:155], v[172:175], a[104:107], v[152:155]
  ds_read_b64_tr_b16 v[166:167], v28 offset:31744
  v_mfma_f32_16x16x32_bf16 v[140:143], v[168:171], a[108:111], v[140:143]
  buffer_load_dwordx4 v27, s[8:11], s69 offen offset:2048 lds
  v_mfma_f32_16x16x32_bf16 v[156:159], v[172:175], a[108:111], v[156:159]
  v_add_u32 v27, 128, v27
  s_add_u32 m0, s40, 0
  s_waitcnt lgkmcnt(6)
  v_mfma_f32_16x16x32_bf16 v[96:99], v[176:179], a[176:179], v[96:99]
  ds_read_b64_tr_b16 v[168:169], v2 offset:26624
  v_mfma_f32_16x16x32_bf16 v[112:115], v[180:183], a[176:179], v[112:115]
  ds_read_b64_tr_b16 v[170:171], v2 offset:32768
  v_mfma_f32_16x16x32_bf16 v[100:103], v[176:179], a[180:183], v[100:103]
  ds_read_b64_tr_b16 v[172:173], v28 offset:26624
  v_mfma_f32_16x16x32_bf16 v[116:119], v[180:183], a[180:183], v[116:119]
  ds_read_b64_tr_b16 v[174:175], v28 offset:32768
  v_mfma_f32_16x16x32_bf16 v[104:107], v[176:179], a[184:187], v[104:107]
  buffer_load_dwordx4 v27, s[8:11], s67 offen offset:0 lds
  v_mfma_f32_16x16x32_bf16 v[120:123], v[180:183], a[184:187], v[120:123]
  ds_read_b128 a[216:219], v15 offset:18432
  v_mfma_f32_16x16x32_bf16 v[108:111], v[176:179], a[188:191], v[108:111]
  s_waitcnt vmcnt(9) lgkmcnt(1)
  v_cmp_le_u32 s[62:63], 1, v24
  v_mfma_f32_16x16x32_bf16 v[124:127], v[180:183], a[188:191], v[124:127]
  s_barrier
  v_mfma_f32_16x16x32_bf16 v[96:99], v[160:163], a[192:195], v[96:99]
  ds_read_b64_tr_b16 v[176:177], v2 offset:36864
  s_cmp_eq_u64 s[62:63], -1
  s_cbranch_scc0 SLOW22
RES22:
  v_mfma_f32_16x16x32_bf16 v[112:115], v[164:167], a[192:195], v[112:115]
  ds_read_b64_tr_b16 v[178:179], v2 offset:43008
  v_mfma_f32_16x16x32_bf16 v[100:103], v[160:163], a[196:199], v[100:103]
  buffer_store_dword v15, v30, s[4:7], s101 offen offset:12 sc1
  v_mfma_f32_16x16x32_bf16 v[116:119], v[164:167], a[196:199], v[116:119]
  buffer_load_dwordx4 v27, s[8:11], s68 offen offset:1024 lds
  ds_read_b128 a[220:223], v15 offset:19456
  v_mfma_f32_16x16x32_bf16 v[104:107], v[160:163], a[200:203], v[104:107]
  ds_read_b64_tr_b16 v[180:181], v28 offset:36864
  v_mfma_f32_16x16x32_bf16 v[120:123], v[164:167], a[200:203], v[120:123]
  ds_read_b64_tr_b16 v[182:183], v28 offset:43008
  v_mfma_f32_16x16x32_bf16 v[108:111], v[160:163], a[204:207], v[108:111]
  buffer_load_dwordx4 v27, s[8:11], s69 offen offset:2048 lds
  v_mfma_f32_16x16x32_bf16 v[124:127], v[164:167], a[204:207], v[124:127]
  s_add_u32 m0, s39, 122880
  s_add_u32 s37, s38, 49152
  v_mfma_f32_16x16x32_bf16 v[96:99], v[168:171], a[208:211], v[96:99]
  ds_read_b64_tr_b16 v[160:161], v2 offset:37888
  v_mfma_f32_16x16x32_bf16 v[112:115], v[172:175], a[208:211], v[112:115]
  ds_read_b64_tr_b16 v[162:163], v2 offset:44032
  v_mfma_f32_16x16x32_bf16 v[100:103], v[168:171], a[212:215], v[100:103]
  buffer_load_dwordx4 v1, s[4:7], s37 offen offset:0 sc1  lds
  v_mfma_f32_16x16x32_bf16 v[116:119], v[172:175], a[212:215], v[116:119]
  ds_read_b128 a[224:227], v15 offset:24576
  s_waitcnt lgkmcnt(8)
  v_mfma_f32_16x16x32_bf16 v[104:107], v[168:171], a[216:219], v[104:107]
  ds_read_b64_tr_b16 v[164:165], v28 offset:37888
  v_mfma_f32_16x16x32_bf16 v[120:123], v[172:175], a[216:219], v[120:123]
  ds_read_b64_tr_b16 v[166:167], v28 offset:44032
  s_waitcnt lgkmcnt(7)
  v_mfma_f32_16x16x32_bf16 v[108:111], v[168:171], a[220:223], v[108:111]
  buffer_load_dwordx4 v1, s[4:7], s37 offen offset:1024 sc1  lds
  v_mfma_f32_16x16x32_bf16 v[124:127], v[172:175], a[220:223], v[124:127]
  s_add_u32 m0, s39, 147456
  s_add_u32 s37, s38, 73728
  s_waitcnt lgkmcnt(5)
  v_mfma_f32_16x16x32_bf16 v[128:131], v[176:179], a[176:179], v[128:131]
  ds_read_b64_tr_b16 v[168:169], v2 offset:38912
  v_mfma_f32_16x16x32_bf16 v[144:147], v[180:183], a[176:179], v[144:147]
  ds_read_b64_tr_b16 v[170:171], v2 offset:45056
  v_mfma_f32_16x16x32_bf16 v[132:135], v[176:179], a[180:183], v[132:135]
  ds_read_b64_tr_b16 v[172:173], v28 offset:38912
  v_mfma_f32_16x16x32_bf16 v[148:151], v[180:183], a[180:183], v[148:151]
  ds_read_b64_tr_b16 v[174:175], v28 offset:45056
  v_mfma_f32_16x16x32_bf16 v[136:139], v[176:179], a[184:187], v[136:139]
  buffer_load_dwordx4 v1, s[4:7], s37 offen offset:0 sc1  lds
  v_mfma_f32_16x16x32_bf16 v[152:155], v[180:183], a[184:187], v[152:155]
  ds_read_b128 a[228:231], v15 offset:25600
  v_mfma_f32_16x16x32_bf16 v[140:143], v[176:179], a[188:191], v[140:143]
  s_waitcnt vmcnt(10) lgkmcnt(1)
  ds_read_b128 a[232:235], v15 offset:26624
  v_mfma_f32_16x16x32_bf16 v[156:159], v[180:183], a[188:191], v[156:159]
  s_barrier
  v_mfma_f32_16x16x32_bf16 v[128:131], v[160:163], a[192:195], v[128:131]
  ds_read_b64_tr_b16 v[176:177], v18 offset:49152
  v_mfma_f32_16x16x32_bf16 v[144:147], v[164:167], a[192:195], v[144:147]
  ds_read_b64_tr_b16 v[178:179], v18 offset:52224
  v_mfma_f32_16x16x32_bf16 v[132:135], v[160:163], a[196:199], v[132:135]
  buffer_load_dwordx4 v1, s[4:7], s37 offen offset:1024 sc1  lds
  v_mfma_f32_16x16x32_bf16 v[148:151], v[164:167], a[196:199], v[148:151]
  s_add_u32 m0, s39, 155648
  s_add_u32 s37, s38, 81920
  v_mfma_f32_16x16x32_bf16 v[136:139], v[160:163], a[200:203], v[136:139]
  ds_read_b64_tr_b16 v[180:181], v18 offset:55296
  v_mfma_f32_16x16x32_bf16 v[152:155], v[164:167], a[200:203], v[152:155]
  ds_read_b64_tr_b16 v[182:183], v18 offset:58368
  v_mfma_f32_16x16x32_bf16 v[140:143], v[160:163], a[204:207], v[140:143]
  buffer_load_dwordx4 v1, s[4:7], s37 offen offset:0 sc1  lds
  v_mfma_f32_16x16x32_bf16 v[156:159], v[164:167], a[204:207], v[156:159]
  ds_read_b128 a[236:239], v15 offset:27648
  v_mfma_f32_16x16x32_bf16 v[128:131], v[168:171], a[208:211], v[128:131]
  ds_read_b64_tr_b16 v[160:161], v18 offset:50176
  v_mfma_f32_16x16x32_bf16 v[144:147], v[172:175], a[208:211], v[144:147]
  ds_read_b64_tr_b16 v[162:163], v18 offset:53248
  v_mfma_f32_16x16x32_bf16 v[132:135], v[168:171], a[212:215], v[132:135]
  buffer_load_dwordx4 v1, s[4:7], s37 offen offset:1024 sc1  lds
  v_mfma_f32_16x16x32_bf16 v[148:151], v[172:175], a[212:215], v[148:151]
  s_add_u32 m0, s40, 12288
  ds_read_b128 a[240:243], v15 offset:32768
  v_mfma_f32_16x16x32_bf16 v[136:139], v[168:171], a[216:219], v[136:139]
  ds_read_b64_tr_b16 v[164:165], v18 offset:56320
  v_mfma_f32_16x16x32_bf16 v[152:155], v[172:175], a[216:219], v[152:155]
  ds_read_b64_tr_b16 v[166:167], v18 offset:59392
  v_mfma_f32_16x16x32_bf16 v[140:143], v[168:171], a[220:223], v[140:143]
  buffer_load_dwordx4 v17, s[8:11], s78 offen offset:0 lds
  v_mfma_f32_16x16x32_bf16 v[156:159], v[172:175], a[220:223], v[156:159]
  ds_read_b128 a[244:247], v15 offset:33792
  s_waitcnt lgkmcnt(7)
  v_mfma_f32_16x16x32_bf16 v[192:195], v[176:179], a[16:19], 0
  ds_read_b64_tr_b16 v[168:169], v18 offset:51200
  v_mfma_f32_16x16x32_bf16 v[192:195], v[180:183], a[176:179], v[192:195]
  ds_read_b64_tr_b16 v[170:171], v18 offset:54272
  v_mfma_f32_16x16x32_bf16 v[196:199], v[176:179], a[20:23], 0
  ds_read_b64_tr_b16 v[172:173], v18 offset:57344
  v_mfma_f32_16x16x32_bf16 v[196:199], v[180:183], a[180:183], v[196:199]
  ds_read_b64_tr_b16 v[174:175], v18 offset:60416
  v_mfma_f32_16x16x32_bf16 v[200:203], v[176:179], a[24:27], 0
  buffer_load_dwordx4 v17, s[8:11], s79 offen offset:1024 lds
  v_mfma_f32_16x16x32_bf16 v[200:203], v[180:183], a[184:187], v[200:203]
  ds_read_b128 a[248:251], v15 offset:34816
  v_mfma_f32_16x16x32_bf16 v[204:207], v[176:179], a[28:31], 0
  s_waitcnt vmcnt(12) lgkmcnt(1)
  ds_read_b128 a[252:255], v15 offset:35840
  v_mfma_f32_16x16x32_bf16 v[204:207], v[180:183], a[188:191], v[204:207]
  s_barrier
  v_mfma_f32_16x16x32_bf16 v[192:195], v[160:163], a[0:3], v[192:195]
  ds_read_b64_tr_b16 v[176:177], v2 offset:61440
  v_add_u32 v2, 62464, v2
  v_mfma_f32_16x16x32_bf16 v[192:195], v[164:167], a[192:195], v[192:195]
  ds_read_b64_tr_b16 v[178:179], v2 offset:5120
  v_mfma_f32_16x16x32_bf16 v[196:199], v[160:163], a[4:7], v[196:199]
  buffer_load_dwordx4 v17, s[8:11], s80 offen offset:2048 lds
  v_mfma_f32_16x16x32_bf16 v[196:199], v[164:167], a[196:199], v[196:199]
  v_subrev_u32 v27, 128, v27
  s_add_u32 m0, s40, 24576
  v_mfma_f32_16x16x32_bf16 v[200:203], v[160:163], a[8:11], v[200:203]
  ds_read_b64_tr_b16 v[180:181], v28 offset:61440
  v_add_u32 v28, 62464, v28
  v_mfma_f32_16x16x32_bf16 v[200:203], v[164:167], a[200:203], v[200:203]
  ds_read_b64_tr_b16 v[182:183], v28 offset:5120
  v_mfma_f32_16x16x32_bf16 v[204:207], v[160:163], a[12:15], v[204:207]
  buffer_load_dwordx4 v27, s[20:23], s70 offen offset:0 lds
  v_mfma_f32_16x16x32_bf16 v[204:207], v[164:167], a[204:207], v[204:207]
  ds_read_b128 v[32:35], v15 offset:40960
  v_mfma_f32_16x16x32_bf16 v[192:195], v[168:171], a[32:35], v[192:195]
  ds_read_b64_tr_b16 v[160:161], v2 offset:0
  v_mfma_f32_16x16x32_bf16 v[192:195], v[172:175], a[208:211], v[192:195]
  ds_read_b64_tr_b16 v[162:163], v2 offset:6144
  v_mfma_f32_16x16x32_bf16 v[196:199], v[168:171], a[36:39], v[196:199]
  buffer_load_dwordx4 v27, s[20:23], s71 offen offset:1024 lds
  v_mfma_f32_16x16x32_bf16 v[196:199], v[172:175], a[212:215], v[196:199]
  ds_read_b128 v[36:39], v15 offset:41984
  v_mfma_f32_16x16x32_bf16 v[200:203], v[168:171], a[40:43], v[200:203]
  ds_read_b64_tr_b16 v[164:165], v28 offset:0
  v_mfma_f32_16x16x32_bf16 v[200:203], v[172:175], a[216:219], v[200:203]
  ds_read_b64_tr_b16 v[166:167], v28 offset:6144
  v_mfma_f32_16x16x32_bf16 v[204:207], v[168:171], a[44:47], v[204:207]
  buffer_load_dword v24, off, s[4:7], s53 offset:12 sc1
  v_mfma_f32_16x16x32_bf16 v[204:207], v[172:175], a[220:223], v[204:207]
  buffer_load_dwordx4 v27, s[8:11], s72 offen offset:2048 lds
  s_waitcnt lgkmcnt(6)
  v_mfma_f32_16x16x32_bf16 v[96:99], v[176:179], a[224:227], v[96:99]
  ds_read_b64_tr_b16 v[168:169], v2 offset:1024
  v_add_u32 v27, 128, v27
  v_mfma_f32_16x16x32_bf16 v[112:115], v[180:183], a[224:227], v[112:115]
  ds_read_b64_tr_b16 v[170:171], v2 offset:7168
  v_subrev_u32 v2, 62464, v2
  v_mfma_f32_16x16x32_bf16 v[100:103], v[176:179], a[228:231], v[100:103]
  ds_read_b64_tr_b16 v[172:173], v28 offset:1024
  s_add_u32 m0, s40, 36864
  v_mfma_f32_16x16x32_bf16 v[116:119], v[180:183], a[228:231], v[116:119]
  ds_read_b64_tr_b16 v[174:175], v28 offset:7168
  v_subrev_u32 v28, 62464, v28
  v_mfma_f32_16x16x32_bf16 v[104:107], v[176:179], a[232:235], v[104:107]
  buffer_load_dwordx4 v27, s[20:23], s70 offen offset:0 lds
  v_mfma_f32_16x16x32_bf16 v[120:123], v[180:183], a[232:235], v[120:123]
  ds_read_b128 v[40:43], v15 offset:43008
  v_mfma_f32_16x16x32_bf16 v[108:111], v[176:179], a[236:239], v[108:111]
  s_waitcnt vmcnt(14) lgkmcnt(1)
  ds_read_b128 v[44:47], v15 offset:44032
  v_mfma_f32_16x16x32_bf16 v[124:127], v[180:183], a[236:239], v[124:127]
  s_barrier
  v_mfma_f32_16x16x32_bf16 v[96:99], v[160:163], a[240:243], v[96:99]
  ds_read_b64_tr_b16 v[176:177], v2 offset:0
  v_mfma_f32_16x16x32_bf16 v[112:115], v[164:167], a[240:243], v[112:115]
  ds_read_b64_tr_b16 v[178:179], v2 offset:6144
  v_mfma_f32_16x16x32_bf16 v[100:103], v[160:163], a[244:247], v[100:103]
  buffer_load_dwordx4 v27, s[20:23], s71 offen offset:1024 lds
  v_mfma_f32_16x16x32_bf16 v[116:119], v[164:167], a[244:247], v[116:119]
  v_mfma_f32_16x16x32_bf16 v[104:107], v[160:163], a[248:251], v[104:107]
  ds_read_b64_tr_b16 v[180:181], v28 offset:0
  v_mfma_f32_16x16x32_bf16 v[120:123], v[164:167], a[248:251], v[120:123]
  ds_read_b64_tr_b16 v[182:183], v28 offset:6144
  v_mfma_f32_16x16x32_bf16 v[108:111], v[160:163], a[252:255], v[108:111]
  buffer_load_dwordx4 v27, s[8:11], s72 offen offset:2048 lds
  v_mfma_f32_16x16x32_bf16 v[124:127], v[164:167], a[252:255], v[124:127]
  s_add_u32 m0, s40, 49152
  v_mfma_f32_16x16x32_bf16 v[96:99], v[168:171], v[32:35], v[96:99]
  ds_read_b64_tr_b16 v[160:161], v2 offset:1024
  v_mfma_f32_16x16x32_bf16 v[112:115], v[172:175], v[32:35], v[112:115]
  ds_read_b64_tr_b16 v[162:163], v2 offset:7168
  v_mfma_f32_16x16x32_bf16 v[100:103], v[168:171], v[36:39], v[100:103]
  buffer_load_dwordx4 v17, s[20:23], s81 offen offset:0 lds
  v_mfma_f32_16x16x32_bf16 v[116:119], v[172:175], v[36:39], v[116:119]
  s_waitcnt lgkmcnt(2)
  v_mfma_f32_16x16x32_bf16 v[104:107], v[168:171], v[40:43], v[104:107]
  ds_read_b64_tr_b16 v[164:165], v28 offset:1024
  v_mfma_f32_16x16x32_bf16 v[120:123], v[172:175], v[40:43], v[120:123]
  ds_read_b64_tr_b16 v[166:167], v28 offset:7168
  v_mfma_f32_16x16x32_bf16 v[108:111], v[168:171], v[44:47], v[108:111]
  buffer_load_dwordx4 v21, s[20:23], s82 offen offset:1024 lds
  v_mfma_f32_16x16x32_bf16 v[124:127], v[172:175], v[44:47], v[124:127]
  v_mfma_f32_16x16x32_bf16 v[128:131], v[176:179], a[224:227], v[128:131]
  ds_read_b64_tr_b16 v[168:169], v2 offset:2048
  v_mfma_f32_16x16x32_bf16 v[144:147], v[180:183], a[224:227], v[144:147]
  ds_read_b64_tr_b16 v[170:171], v2 offset:8192
  v_mfma_f32_16x16x32_bf16 v[132:135], v[176:179], a[228:231], v[132:135]
  ds_read_b64_tr_b16 v[172:173], v28 offset:2048
  v_mfma_f32_16x16x32_bf16 v[148:151], v[180:183], a[228:231], v[148:151]
  ds_read_b64_tr_b16 v[174:175], v28 offset:8192
  v_mfma_f32_16x16x32_bf16 v[136:139], v[176:179], a[232:235], v[136:139]
  buffer_load_dwordx4 v17, s[8:11], s83 offen offset:2048 lds
  v_mfma_f32_16x16x32_bf16 v[152:155], v[180:183], a[232:235], v[152:155]
  v_subrev_u32 v27, 128, v27
  s_add_u32 m0, s40, 61440
  v_mfma_f32_16x16x32_bf16 v[140:143], v[176:179], a[236:239], v[140:143]
  s_waitcnt vmcnt(10) lgkmcnt(0)
  v_mfma_f32_16x16x32_bf16 v[156:159], v[180:183], a[236:239], v[156:159]
  s_barrier
  v_mfma_f32_16x16x32_bf16 v[128:131], v[160:163], a[240:243], v[128:131]
  ds_read_b64_tr_b16 v[176:177], v18 offset:12288
  v_mfma_f32_16x16x32_bf16 v[144:147], v[164:167], a[240:243], v[144:147]
  ds_read_b64_tr_b16 v[178:179], v18 offset:15360
  v_mfma_f32_16x16x32_bf16 v[132:135], v[160:163], a[244:247], v[132:135]
  buffer_load_dwordx4 v27, s[8:11], s73 offen offset:0 lds
  v_mfma_f32_16x16x32_bf16 v[148:151], v[164:167], a[244:247], v[148:151]
  ds_read2st64_b64 v[48:51], v25 offset0:0 offset1:16
  v_mfma_f32_16x16x32_bf16 v[136:139], v[160:163], a[248:251], v[136:139]
  ds_read_b64_tr_b16 v[180:181], v18 offset:18432
  v_mfma_f32_16x16x32_bf16 v[152:155], v[164:167], a[248:251], v[152:155]
  ds_read_b64_tr_b16 v[182:183], v18 offset:21504
  v_mfma_f32_16x16x32_bf16 v[140:143], v[160:163], a[252:255], v[140:143]
  buffer_load_dwordx4 v27, s[8:11], s74 offen offset:1024 lds
  v_mfma_f32_16x16x32_bf16 v[156:159], v[164:167], a[252:255], v[156:159]
  v_add_u32 v27, 128, v27
  s_add_u32 m0, s40, 0
  v_mfma_f32_16x16x32_bf16 v[128:131], v[168:171], v[32:35], v[128:131]
  ds_read_b64_tr_b16 v[160:161], v18 offset:13312
  v_mfma_f32_16x16x32_bf16 v[144:147], v[172:175], v[32:35], v[144:147]
  ds_read_b64_tr_b16 v[162:163], v18 offset:16384
  v_mfma_f32_16x16x32_bf16 v[132:135], v[168:171], v[36:39], v[132:135]
  buffer_load_dwordx4 v27, s[8:11], s73 offen offset:0 lds
  v_mfma_f32_16x16x32_bf16 v[148:151], v[172:175], v[36:39], v[148:151]
  ds_read2st64_b64 v[52:55], v25 offset0:2 offset1:18
  v_mfma_f32_16x16x32_bf16 v[136:139], v[168:171], v[40:43], v[136:139]
  ds_read_b64_tr_b16 v[164:165], v18 offset:19456
  v_mfma_f32_16x16x32_bf16 v[152:155], v[172:175], v[40:43], v[152:155]
  ds_read_b64_tr_b16 v[166:167], v18 offset:22528
  v_mfma_f32_16x16x32_bf16 v[140:143], v[168:171], v[44:47], v[140:143]
  buffer_load_dwordx4 v27, s[8:11], s74 offen offset:1024 lds
  v_mfma_f32_16x16x32_bf16 v[156:159], v[172:175], v[44:47], v[156:159]
  ds_read2st64_b64 v[56:59], v25 offset0:4 offset1:20
  s_waitcnt lgkmcnt(6)
  v_mfma_f32_16x16x32_bf16 v[192:195], v[176:179], a[48:51], v[192:195]
  ds_read_b64_tr_b16 v[168:169], v18 offset:14336
  v_mfma_f32_16x16x32_bf16 v[192:195], v[180:183], a[224:227], v[192:195]
  ds_read_b64_tr_b16 v[170:171], v18 offset:17408
  v_mfma_f32_16x16x32_bf16 v[196:199], v[176:179], a[52:55], v[196:199]
  ds_read_b64_tr_b16 v[172:173], v18 offset:20480
  v_mfma_f32_16x16x32_bf16 v[196:199], v[180:183], a[228:231], v[196:199]
  ds_read_b64_tr_b16 v[174:175], v18 offset:23552
  v_mfma_f32_16x16x32_bf16 v[200:203], v[176:179], a[56:59], v[200:203]
  ds_read2st64_b64 v[60:63], v25 offset0:6 offset1:22
  v_mfma_f32_16x16x32_bf16 v[200:203], v[180:183], a[232:235], v[200:203]
  ds_read_b64 a[162:163], v26 offset:8
  v_mfma_f32_16x16x32_bf16 v[204:207], v[176:179], a[60:63], v[204:207]
  s_waitcnt vmcnt(10) lgkmcnt(2)
  v_cmp_le_u32 s[62:63], 1, v24
  v_mfma_f32_16x16x32_bf16 v[204:207], v[180:183], a[236:239], v[204:207]
  s_barrier
  v_mfma_f32_16x16x32_bf16 v[192:195], v[160:163], a[64:67], v[192:195]
  ds_read_b64_tr_b16 v[176:177], v2 offset:24576
  s_cmp_eq_u64 s[62:63], -1
  s_cbranch_scc0 SLOW23
RES23:
  v_mfma_f32_16x16x32_bf16 v[192:195], v[164:167], a[240:243], v[192:195]
  ds_read_b64_tr_b16 v[178:179], v2 offset:30720
  s_add_u32 s50, s52, 57344
  v_mfma_f32_16x16x32_bf16 v[196:199], v[160:163], a[68:71], v[196:199]
  buffer_load_dwordx4 v[224:227], v1, s[4:7], s50 offen offset:0 sc1
  v_mfma_f32_16x16x32_bf16 v[196:199], v[164:167], a[244:247], v[196:199]
  s_add_u32 m0, s40, 12288
  ds_read_b64 a[166:167], v26 offset:1032
  v_mfma_f32_16x16x32_bf16 v[200:203], v[160:163], a[72:75], v[200:203]
  ds_read_b64_tr_b16 v[180:181], v28 offset:24576
  v_mfma_f32_16x16x32_bf16 v[200:203], v[164:167], a[248:251], v[200:203]
  ds_read_b64_tr_b16 v[182:183], v28 offset:30720
  v_mfma_f32_16x16x32_bf16 v[204:207], v[160:163], a[76:79], v[204:207]
  buffer_load_dwordx4 v[228:231], v1, s[4:7], s50 offen offset:1024 sc1
  v_mfma_f32_16x16x32_bf16 v[204:207], v[164:167], a[252:255], v[204:207]
  ds_read_b64 a[170:171], v26 offset:2056
  v_mfma_f32_16x16x32_bf16 v[192:195], v[168:171], a[80:83], v[192:195]
  ds_read_b64_tr_b16 v[160:161], v2 offset:25600
  v_mfma_f32_16x16x32_bf16 v[192:195], v[172:175], v[32:35], v[192:195]
  ds_read_b64_tr_b16 v[162:163], v2 offset:31744
  v_mfma_f32_16x16x32_bf16 v[196:199], v[168:171], a[84:87], v[196:199]
  buffer_load_dwordx4 v[232:235], v1, s[4:7], s50 offen offset:2048 sc1
  v_mfma_f32_16x16x32_bf16 v[196:199], v[172:175], v[36:39], v[196:199]
  ds_read_b64 a[174:175], v26 offset:3080
  v_mfma_f32_16x16x32_bf16 v[200:203], v[168:171], a[88:91], v[200:203]
  ds_read_b64_tr_b16 v[164:165], v28 offset:25600
  v_mfma_f32_16x16x32_bf16 v[200:203], v[172:175], v[40:43], v[200:203]
  ds_read_b64_tr_b16 v[166:167], v28 offset:31744
  v_mfma_f32_16x16x32_bf16 v[204:207], v[168:171], a[92:95], v[204:207]
  buffer_load_dwordx4 v[236:239], v1, s[4:7], s50 offen offset:3072 sc1
  s_add_u32 s50, s52, 65536
  v_mfma_f32_16x16x32_bf16 v[204:207], v[172:175], v[44:47], v[204:207]
  ds_read_b128 v[64:67], v15 offset:49152
  s_waitcnt lgkmcnt(7)
  v_mfma_f32_16x16x32_bf16 v[96:99], v[176:179], v[48:51], v[96:99]
  ds_read_b64_tr_b16 v[168:169], v2 offset:26624
  v_mfma_f32_16x16x32_bf16 v[112:115], v[180:183], v[48:51], v[112:115]
  ds_read_b64_tr_b16 v[170:171], v2 offset:32768
  v_mfma_f32_16x16x32_bf16 v[100:103], v[176:179], v[52:55], v[100:103]
  ds_read_b64_tr_b16 v[172:173], v28 offset:26624
  v_mfma_f32_16x16x32_bf16 v[116:119], v[180:183], v[52:55], v[116:119]
  ds_read_b64_tr_b16 v[174:175], v28 offset:32768
  v_mfma_f32_16x16x32_bf16 v[104:107], v[176:179], v[56:59], v[104:107]
  buffer_load_dwordx4 v[240:243], v1, s[4:7], s50 offen offset:0 sc1
  v_mfma_f32_16x16x32_bf16 v[120:123], v[180:183], v[56:59], v[120:123]
  ds_read_b128 v[68:71], v15 offset:50176
  v_mfma_f32_16x16x32_bf16 v[108:111], v[176:179], v[60:63], v[108:111]
  s_waitcnt vmcnt(12) lgkmcnt(1)
  buffer_load_dwordx4 v[244:247], v1, s[4:7], s50 offen offset:1024 sc1
  v_mfma_f32_16x16x32_bf16 v[124:127], v[180:183], v[60:63], v[124:127]
  s_barrier
  v_mfma_f32_16x16x32_bf16 v[96:99], v[160:163], a[160:163], v[96:99]
  ds_read_b64_tr_b16 v[176:177], v2 offset:36864
  v_mfma_f32_16x16x32_bf16 v[112:115], v[164:167], a[160:163], v[112:115]
  ds_read_b64_tr_b16 v[178:179], v2 offset:43008
  v_mfma_f32_16x16x32_bf16 v[100:103], v[160:163], a[164:167], v[100:103]
  buffer_load_dwordx4 v[248:251], v1, s[4:7], s50 offen offset:2048 sc1
  v_mfma_f32_16x16x32_bf16 v[116:119], v[164:167], a[164:167], v[116:119]
  ds_read_b128 v[72:75], v15 offset:51200
  ds_read_b128 v[76:79], v15 offset:52224
  v_mfma_f32_16x16x32_bf16 v[104:107], v[160:163], a[168:171], v[104:107]
  ds_read_b64_tr_b16 v[180:181], v28 offset:36864
  v_mfma_f32_16x16x32_bf16 v[120:123], v[164:167], a[168:171], v[120:123]
  ds_read_b64_tr_b16 v[182:183], v28 offset:43008
  v_mfma_f32_16x16x32_bf16 v[108:111], v[160:163], a[172:175], v[108:111]
  buffer_load_dwordx4 v[252:255], v1, s[4:7], s50 offen offset:3072 sc1
  v_mfma_f32_16x16x32_bf16 v[124:127], v[164:167], a[172:175], v[124:127]
  v_mfma_f32_16x16x32_bf16 v[96:99], v[168:171], v[64:67], v[96:99]
  ds_read_b64_tr_b16 v[160:161], v2 offset:37888
  v_mfma_f32_16x16x32_bf16 v[112:115], v[172:175], v[64:67], v[112:115]
  ds_read_b64_tr_b16 v[162:163], v2 offset:44032
  s_waitcnt lgkmcnt(8)
  v_mfma_f32_16x16x32_bf16 v[100:103], v[168:171], v[68:71], v[100:103]
  buffer_load_dwordx4 v17, s[8:11], s95 offen offset:0 lds
  v_mfma_f32_16x16x32_bf16 v[116:119], v[172:175], v[68:71], v[116:119]
  s_waitcnt lgkmcnt(2)
  v_mfma_f32_16x16x32_bf16 v[104:107], v[168:171], v[72:75], v[104:107]
  ds_read_b64_tr_b16 v[164:165], v28 offset:37888
  v_mfma_f32_16x16x32_bf16 v[120:123], v[172:175], v[72:75], v[120:123]
  ds_read_b64_tr_b16 v[166:167], v28 offset:44032
  v_mfma_f32_16x16x32_bf16 v[108:111], v[168:171], v[76:79], v[108:111]
  buffer_load_dwordx4 v17, s[8:11], s98 offen offset:1024 lds
  v_mfma_f32_16x16x32_bf16 v[124:127], v[172:175], v[76:79], v[124:127]
  v_add_u32 v27, 128, v27
  s_add_u32 m0, s40, 24576
  v_mfma_f32_16x16x32_bf16 v[128:131], v[176:179], v[48:51], v[128:131]
  ds_read_b64_tr_b16 v[168:169], v2 offset:38912
  v_mfma_f32_16x16x32_bf16 v[144:147], v[180:183], v[48:51], v[144:147]
  ds_read_b64_tr_b16 v[170:171], v2 offset:45056
  v_mfma_f32_16x16x32_bf16 v[132:135], v[176:179], v[52:55], v[132:135]
  ds_read_b64_tr_b16 v[172:173], v28 offset:38912
  v_mfma_f32_16x16x32_bf16 v[148:151], v[180:183], v[52:55], v[148:151]
  ds_read_b64_tr_b16 v[174:175], v28 offset:45056
  v_mfma_f32_16x16x32_bf16 v[136:139], v[176:179], v[56:59], v[136:139]
  buffer_load_dwordx4 v27, s[8:11], s84 offen offset:0 lds
  v_mfma_f32_16x16x32_bf16 v[152:155], v[180:183], v[56:59], v[152:155]
  v_mfma_f32_16x16x32_bf16 v[140:143], v[176:179], v[60:63], v[140:143]
  s_waitcnt vmcnt(15) lgkmcnt(0)
  v_mfma_f32_16x16x32_bf16 v[156:159], v[180:183], v[60:63], v[156:159]
  s_barrier
  v_mfma_f32_16x16x32_bf16 v[128:131], v[160:163], a[160:163], v[128:131]
  ds_read_b64_tr_b16 v[176:177], v18 offset:49152
  v_mfma_f32_16x16x32_bf16 v[144:147], v[164:167], a[160:163], v[144:147]
  ds_read_b64_tr_b16 v[178:179], v18 offset:52224
  v_mfma_f32_16x16x32_bf16 v[132:135], v[160:163], a[164:167], v[132:135]
  buffer_load_dwordx4 v27, s[8:11], s85 offen offset:1024 lds
  v_mfma_f32_16x16x32_bf16 v[148:151], v[164:167], a[164:167], v[148:151]
  v_mfma_f32_16x16x32_bf16 v[136:139], v[160:163], a[168:171], v[136:139]
  ds_read_b64_tr_b16 v[180:181], v18 offset:55296
  v_mfma_f32_16x16x32_bf16 v[152:155], v[164:167], a[168:171], v[152:155]
  ds_read_b64_tr_b16 v[182:183], v18 offset:58368
  v_mfma_f32_16x16x32_bf16 v[140:143], v[160:163], a[172:175], v[140:143]
  buffer_load_dwordx4 v27, s[8:11], s86 offen offset:2048 lds
  v_mfma_f32_16x16x32_bf16 v[156:159], v[164:167], a[172:175], v[156:159]
  s_add_u32 m0, s40, 36864
  v_mfma_f32_16x16x32_bf16 v[128:131], v[168:171], v[64:67], v[128:131]
  ds_read_b64_tr_b16 v[160:161], v18 offset:50176
  v_mfma_f32_16x16x32_bf16 v[144:147], v[172:175], v[64:67], v[144:147]
  ds_read_b64_tr_b16 v[162:163], v18 offset:53248
  v_mfma_f32_16x16x32_bf16 v[132:135], v[168:171], v[68:71], v[132:135]
  buffer_load_dwordx4 v27, s[8:11], s87 offen offset:0 lds
  v_mfma_f32_16x16x32_bf16 v[148:151], v[172:175], v[68:71], v[148:151]
  s_waitcnt lgkmcnt(2)
  v_mfma_f32_16x16x32_bf16 v[136:139], v[168:171], v[72:75], v[136:139]
  ds_read_b64_tr_b16 v[164:165], v18 offset:56320
  v_mfma_f32_16x16x32_bf16 v[152:155], v[172:175], v[72:75], v[152:155]
  ds_read_b64_tr_b16 v[166:167], v18 offset:59392
  v_mfma_f32_16x16x32_bf16 v[140:143], v[168:171], v[76:79], v[140:143]
  buffer_load_dwordx4 v27, s[8:11], s88 offen offset:1024 lds
  v_mfma_f32_16x16x32_bf16 v[156:159], v[172:175], v[76:79], v[156:159]
  v_mfma_f32_16x16x32_bf16 v[192:195], v[176:179], a[144:147], v[192:195]
  ds_read_b64_tr_b16 v[168:169], v18 offset:51200
  v_mfma_f32_16x16x32_bf16 v[192:195], v[180:183], v[48:51], v[192:195]
  ds_read_b64_tr_b16 v[170:171], v18 offset:54272
  v_mfma_f32_16x16x32_bf16 v[196:199], v[176:179], a[148:151], v[196:199]
  ds_read_b64_tr_b16 v[172:173], v18 offset:57344
  v_mfma_f32_16x16x32_bf16 v[196:199], v[180:183], v[52:55], v[196:199]
  ds_read_b64_tr_b16 v[174:175], v18 offset:60416
  v_mfma_f32_16x16x32_bf16 v[200:203], v[176:179], a[152:155], v[200:203]
  buffer_load_dwordx4 v27, s[8:11], s89 offen offset:2048 lds
  v_mfma_f32_16x16x32_bf16 v[200:203], v[180:183], v[56:59], v[200:203]
  v_mfma_f32_16x16x32_bf16 v[204:207], v[176:179], a[156:159], v[204:207]
  s_waitcnt vmcnt(18) lgkmcnt(0)
  v_mfma_f32_16x16x32_bf16 v[204:207], v[180:183], v[60:63], v[204:207]
  s_barrier
  v_mfma_f32_16x16x32_bf16 v[192:195], v[160:163], a[160:163], v[192:195]
  ds_read_b64_tr_b16 v[176:177], v2 offset:61440
  v_add_u32 v2, 62464, v2
  v_mfma_f32_16x16x32_bf16 v[192:195], v[164:167], a[160:163], v[192:195]
  ds_read_b64_tr_b16 v[178:179], v2 offset:5120
  s_add_u32 m0, s40, 49152
  v_mfma_f32_16x16x32_bf16 v[196:199], v[160:163], a[164:167], v[196:199]
  buffer_load_dwordx4 v27, s[20:23], s90 offen offset:0 lds
  v_mfma_f32_16x16x32_bf16 v[196:199], v[164:167], a[164:167], v[196:199]
  v_mfma_f32_16x16x32_bf16 v[200:203], v[160:163], a[168:171], v[200:203]
  ds_read_b64_tr_b16 v[180:181], v28 offset:61440
  v_add_u32 v28, 62464, v28
  v_mfma_f32_16x16x32_bf16 v[200:203], v[164:167], a[168:171], v[200:203]
  ds_read_b64_tr_b16 v[182:183], v28 offset:5120
  v_mfma_f32_16x16x32_bf16 v[204:207], v[160:163], a[172:175], v[204:207]
  buffer_load_dwordx4 v27, s[8:11], s92 offen offset:2048 lds
  v_mfma_f32_16x16x32_bf16 v[204:207], v[164:167], a[172:175], v[204:207]
  v_mfma_f32_16x16x32_bf16 v[192:195], v[168:171], a[96:99], v[192:195]
  ds_read_b64_tr_b16 v[160:161], v2 offset:0
  v_mfma_f32_16x16x32_bf16 v[192:195], v[172:175], v[64:67], v[192:195]
STUB10:
  s_cbranch_execz K1_back2
  ds_read_b64_tr_b16 v[162:163], v2 offset:6144
  v_subrev_u32 v2, 62464, v2
  v_mfma_f32_16x16x32_bf16 v[196:199], v[168:171], a[100:103], v[196:199]
  ds_read_b64_tr_b16 v[164:165], v28 offset:0
  v_mfma_f32_16x16x32_bf16 v[196:199], v[172:175], v[68:71], v[196:199]
  ds_read_b64_tr_b16 v[166:167], v28 offset:6144
  v_subrev_u32 v28, 62464, v28
  v_mfma_f32_16x16x32_bf16 v[200:203], v[168:171], a[104:107], v[200:203]
  v_mfma_f32_16x16x32_bf16 v[200:203], v[172:175], v[72:75], v[200:203]
  v_mfma_f32_16x16x32_bf16 v[204:207], v[168:171], a[108:111], v[204:207]
  s_waitcnt vmcnt(18) lgkmcnt(0)
  v_mfma_f32_16x16x32_bf16 v[204:207], v[172:175], v[76:79], v[204:207]
  s_barrier
  s_waitcnt vmcnt(17)
  v_mfma_f32_16x16x32_bf16 v[96:99], v[176:179], v[224:227], v[96:99]
  ds_read_b64_tr_b16 v[168:169], v2 offset:0
  s_add_u32 m0, s40, 61440
  v_mfma_f32_16x16x32_bf16 v[112:115], v[180:183], v[224:227], v[112:115]
  ds_read_b64_tr_b16 v[170:171], v2 offset:6144
  s_waitcnt vmcnt(16)
  v_mfma_f32_16x16x32_bf16 v[100:103], v[176:179], v[228:231], v[100:103]
  buffer_load_dwordx4 v27, s[8:11], s93 offen offset:0 lds
  v_mfma_f32_16x16x32_bf16 v[116:119], v[180:183], v[228:231], v[116:119]
  s_waitcnt vmcnt(16)
  v_mfma_f32_16x16x32_bf16 v[104:107], v[176:179], v[232:235], v[104:107]
  ds_read_b64_tr_b16 v[172:173], v28 offset:0
  v_mfma_f32_16x16x32_bf16 v[120:123], v[180:183], v[232:235], v[120:123]
  ds_read_b64_tr_b16 v[174:175], v28 offset:6144
  s_waitcnt vmcnt(15)
  v_mfma_f32_16x16x32_bf16 v[108:111], v[176:179], v[236:239], v[108:111]
  buffer_load_dwordx4 v27, s[8:11], s94 offen offset:1024 lds
  v_mfma_f32_16x16x32_bf16 v[124:127], v[180:183], v[236:239], v[124:127]
  s_waitcnt vmcnt(15)
  v_mfma_f32_16x16x32_bf16 v[96:99], v[160:163], v[240:243], v[96:99]
  ds_read_b64_tr_b16 v[176:177], v2 offset:1024
  v_mfma_f32_16x16x32_bf16 v[112:115], v[164:167], v[240:243], v[112:115]
  ds_read_b64_tr_b16 v[178:179], v2 offset:7168
  s_waitcnt vmcnt(14)
  v_mfma_f32_16x16x32_bf16 v[100:103], v[160:163], v[244:247], v[100:103]
  ds_read_b64_tr_b16 v[180:181], v28 offset:1024
  v_mfma_f32_16x16x32_bf16 v[116:119], v[164:167], v[244:247], v[116:119]
  ds_read_b64_tr_b16 v[182:183], v28 offset:7168
  s_waitcnt vmcnt(13)
  v_mfma_f32_16x16x32_bf16 v[104:107], v[160:163], v[248:251], v[104:107]
  v_mfma_f32_16x16x32_bf16 v[120:123], v[164:167], v[248:251], v[120:123]
  s_waitcnt vmcnt(12)
  v_mfma_f32_16x16x32_bf16 v[108:111], v[160:163], v[252:255], v[108:111]
  s_waitcnt vmcnt(10) lgkmcnt(0)
  v_mfma_f32_16x16x32_bf16 v[124:127], v[164:167], v[252:255], v[124:127]
  s_barrier
  v_mfma_f32_16x16x32_bf16 v[128:131], v[168:171], v[224:227], v[128:131]
  ds_read_b64_tr_b16 v[160:161], v18 offset:12288
  s_add_u32 m0, s40, 0
  v_mfma_f32_16x16x32_bf16 v[144:147], v[172:175], v[224:227], v[144:147]
  ds_read_b64_tr_b16 v[162:163], v18 offset:15360
  s_lshl_b32 s43, s36, 10
  v_mfma_f32_16x16x32_bf16 v[132:135], v[168:171], v[228:231], v[132:135]
  buffer_load_dwordx4 v27, s[8:11], s64 offen offset:0 lds
  v_mfma_f32_16x16x32_bf16 v[148:151], v[172:175], v[228:231], v[148:151]
  s_add_u32 s43, s43, s46
  v_cvt_pk_bf16_f32 v208, v96, v97
  v_cvt_pk_bf16_f32 v209, v98, v99
  v_mfma_f32_16x16x32_bf16 v[136:139], v[168:171], v[232:235], v[136:139]
  ds_read_b64_tr_b16 v[164:165], v18 offset:18432
  v_cvt_pk_bf16_f32 v210, v112, v113
  v_mfma_f32_16x16x32_bf16 v[152:155], v[172:175], v[232:235], v[152:155]
  ds_read_b64_tr_b16 v[166:167], v18 offset:21504
  v_cvt_pk_bf16_f32 v211, v114, v115
  v_mfma_f32_16x16x32_bf16 v[140:143], v[168:171], v[236:239], v[140:143]
  buffer_load_dwordx4 v27, s[8:11], s65 offen offset:1024 lds
  v_mfma_f32_16x16x32_bf16 v[156:159], v[172:175], v[236:239], v[156:159]
  s_add_u32 s42, s43, 0
  v_cvt_pk_bf16_f32 v212, v100, v101
  v_cvt_pk_bf16_f32 v213, v102, v103
  v_mfma_f32_16x16x32_bf16 v[128:131], v[176:179], v[240:243], v[128:131]
  ds_read_b64_tr_b16 v[168:169], v18 offset:13312
  v_cvt_pk_bf16_f32 v214, v116, v117
  v_mfma_f32_16x16x32_bf16 v[144:147], v[180:183], v[240:243], v[144:147]
  ds_read_b64_tr_b16 v[170:171], v18 offset:16384
  v_cvt_pk_bf16_f32 v215, v118, v119
  v_mfma_f32_16x16x32_bf16 v[132:135], v[176:179], v[244:247], v[132:135]
  ds_read_b64_tr_b16 v[172:173], v18 offset:19456
  v_cvt_pk_bf16_f32 v216, v104, v105
  v_mfma_f32_16x16x32_bf16 v[148:151], v[180:183], v[244:247], v[148:151]
  ds_read_b64_tr_b16 v[174:175], v18 offset:22528
  v_cvt_pk_bf16_f32 v217, v106, v107
  v_mfma_f32_16x16x32_bf16 v[136:139], v[176:179], v[248:251], v[136:139]
  buffer_store_dwordx4 v[208:211], v1, s[4:7], s42 offen sc1
  v_mfma_f32_16x16x32_bf16 v[152:155], v[180:183], v[248:251], v[152:155]
  buffer_load_dwordx4 v27, s[8:11], s66 offen offset:2048 lds
  v_mfma_f32_16x16x32_bf16 v[140:143], v[176:179], v[252:255], v[140:143]
  s_waitcnt vmcnt(11) lgkmcnt(0)
  v_cvt_pk_bf16_f32 v218, v120, v121
  v_cvt_pk_bf16_f32 v219, v122, v123
  v_mfma_f32_16x16x32_bf16 v[156:159], v[180:183], v[252:255], v[156:159]
  s_barrier
  v_mfma_f32_16x16x32_bf16 v[192:195], v[160:163], a[112:115], v[192:195]
  ds_read_b64_tr_b16 v[176:177], v2 offset:24576
  s_add_u32 m0, s40, 12288
  v_mfma_f32_16x16x32_bf16 v[192:195], v[164:167], v[224:227], v[192:195]
  ds_read_b64_tr_b16 v[178:179], v2 offset:30720
  v_cvt_pk_bf16_f32 v220, v108, v109
  v_mfma_f32_16x16x32_bf16 v[196:199], v[160:163], a[116:119], v[196:199]
  buffer_load_dwordx4 v27, s[8:11], s67 offen offset:0 lds
  v_mfma_f32_16x16x32_bf16 v[196:199], v[164:167], v[228:231], v[196:199]
  s_add_u32 s42, s43, 16384
  v_cvt_pk_bf16_f32 v221, v110, v111
  v_cvt_pk_bf16_f32 v222, v124, v125
  v_mfma_f32_16x16x32_bf16 v[200:203], v[160:163], a[120:123], v[200:203]
  ds_read_b64_tr_b16 v[180:181], v28 offset:24576
  v_cvt_pk_bf16_f32 v223, v126, v127
  v_mfma_f32_16x16x32_bf16 v[200:203], v[164:167], v[232:235], v[200:203]
  ds_read_b64_tr_b16 v[182:183], v28 offset:30720
  v_mfma_f32_16x16x32_bf16 v[204:207], v[160:163], a[124:127], v[204:207]
  buffer_store_dwordx4 v[212:215], v1, s[4:7], s42 offen sc1
  v_mfma_f32_16x16x32_bf16 v[204:207], v[164:167], v[236:239], v[204:207]
  buffer_load_dwordx4 v27, s[8:11], s68 offen offset:1024 lds
  v_mfma_f32_16x16x32_bf16 v[192:195], v[168:171], a[128:131], v[192:195]
  ds_read_b64_tr_b16 v[160:161], v2 offset:25600
  s_add_u32 s42, s43, 32768
  v_mfma_f32_16x16x32_bf16 v[192:195], v[172:175], v[240:243], v[192:195]
  ds_read_b64_tr_b16 v[162:163], v2 offset:31744
  v_mfma_f32_16x16x32_bf16 v[196:199], v[168:171], a[132:135], v[196:199]
  buffer_store_dwordx4 v[216:219], v1, s[4:7], s42 offen sc1
  v_mfma_f32_16x16x32_bf16 v[196:199], v[172:175], v[244:247], v[196:199]
  s_waitcnt lgkmcnt(2)
  s_add_u32 s42, s43, 49152
  v_mfma_f32_16x16x32_bf16 v[200:203], v[168:171], a[136:139], v[200:203]
  ds_read_b64_tr_b16 v[164:165], v28 offset:25600
  v_mfma_f32_16x16x32_bf16 v[200:203], v[172:175], v[248:251], v[200:203]
  ds_read_b64_tr_b16 v[166:167], v28 offset:31744
  v_mfma_f32_16x16x32_bf16 v[204:207], v[168:171], a[140:143], v[204:207]
  buffer_store_dwordx4 v[220:223], v1, s[4:7], s42 offen sc1
  v_mfma_f32_16x16x32_bf16 v[204:207], v[172:175], v[252:255], v[204:207]
  buffer_load_dwordx4 v27, s[8:11], s69 offen offset:2048 lds
  v_mfma_f32_16x16x32_bf16 v[96:99], v[176:179], a[16:19], 0
  ds_read_b64_tr_b16 v[168:169], v2 offset:26624
  s_lshl_b32 s43, s36, 10
  v_mfma_f32_16x16x32_bf16 v[112:115], v[180:183], a[16:19], 0
  ds_read_b64_tr_b16 v[170:171], v2 offset:32768
  s_add_u32 s43, s43, s46
  v_mfma_f32_16x16x32_bf16 v[100:103], v[176:179], a[20:23], 0
  ds_read_b64_tr_b16 v[172:173], v28 offset:26624
  v_cvt_pk_bf16_f32 v208, v128, v129
  v_mfma_f32_16x16x32_bf16 v[116:119], v[180:183], a[20:23], 0
  ds_read_b64_tr_b16 v[174:175], v28 offset:32768
  v_cvt_pk_bf16_f32 v209, v130, v131
  v_mfma_f32_16x16x32_bf16 v[104:107], v[176:179], a[24:27], 0
  s_add_u32 s42, s43, 131072
  v_cvt_pk_bf16_f32 v210, v144, v145
  v_cvt_pk_bf16_f32 v211, v146, v147
  v_mfma_f32_16x16x32_bf16 v[120:123], v[180:183], a[24:27], 0
  buffer_store_dwordx4 v[208:211], v1, s[4:7], s42 offen sc1
  v_mfma_f32_16x16x32_bf16 v[108:111], v[176:179], a[28:31], 0
  s_waitcnt vmcnt(15) lgkmcnt(0)
  v_cvt_pk_bf16_f32 v212, v132, v133
  v_cvt_pk_bf16_f32 v213, v134, v135
  v_mfma_f32_16x16x32_bf16 v[124:127], v[180:183], a[28:31], 0
  s_barrier
  v_mfma_f32_16x16x32_bf16 v[96:99], v[160:163], a[0:3], v[96:99]
  ds_read_b64_tr_b16 v[176:177], v2 offset:36864
  s_add_u32 m0, s40, 24576
  v_mfma_f32_16x16x32_bf16 v[112:115], v[164:167], a[0:3], v[112:115]
  ds_read_b64_tr_b16 v[178:179], v2 offset:43008
  v_cvt_pk_bf16_f32 v214, v148, v149
  v_mfma_f32_16x16x32_bf16 v[100:103], v[160:163], a[4:7], v[100:103]
  buffer_load_dwordx4 v27, s[20:23], s70 offen offset:0 lds
  v_mfma_f32_16x16x32_bf16 v[116:119], v[164:167], a[4:7], v[116:119]
  s_add_u32 s42, s43, 147456
  v_cvt_pk_bf16_f32 v215, v150, v151
  v_cvt_pk_bf16_f32 v216, v136, v137
  v_mfma_f32_16x16x32_bf16 v[104:107], v[160:163], a[8:11], v[104:107]
  ds_read_b64_tr_b16 v[180:181], v28 offset:36864
  v_cvt_pk_bf16_f32 v217, v138, v139
  v_mfma_f32_16x16x32_bf16 v[120:123], v[164:167], a[8:11], v[120:123]
  ds_read_b64_tr_b16 v[182:183], v28 offset:43008
  v_cvt_pk_bf16_f32 v218, v152, v153
  v_mfma_f32_16x16x32_bf16 v[108:111], v[160:163], a[12:15], v[108:111]
  buffer_store_dwordx4 v[212:215], v1, s[4:7], s42 offen sc1
  v_mfma_f32_16x16x32_bf16 v[124:127], v[164:167], a[12:15], v[124:127]
  buffer_load_dwordx4 v27, s[20:23], s71 offen offset:1024 lds
  v_mfma_f32_16x16x32_bf16 v[96:99], v[168:171], a[32:35], v[96:99]
  ds_read_b64_tr_b16 v[160:161], v2 offset:37888
  v_cvt_pk_bf16_f32 v219, v154, v155
  v_mfma_f32_16x16x32_bf16 v[112:115], v[172:175], a[32:35], v[112:115]
  ds_read_b64_tr_b16 v[162:163], v2 offset:44032
  v_cvt_pk_bf16_f32 v220, v140, v141
  v_mfma_f32_16x16x32_bf16 v[100:103], v[168:171], a[36:39], v[100:103]
  buffer_load_dwordx4 v27, s[8:11], s72 offen offset:2048 lds
  v_mfma_f32_16x16x32_bf16 v[116:119], v[172:175], a[36:39], v[116:119]
  s_waitcnt lgkmcnt(2)
  v_cvt_pk_bf16_f32 v221, v142, v143
  v_cvt_pk_bf16_f32 v222, v156, v157
  v_mfma_f32_16x16x32_bf16 v[104:107], v[168:171], a[40:43], v[104:107]
  ds_read_b64_tr_b16 v[164:165], v28 offset:37888
  v_cvt_pk_bf16_f32 v223, v158, v159
  v_mfma_f32_16x16x32_bf16 v[120:123], v[172:175], a[40:43], v[120:123]
  ds_read_b64_tr_b16 v[166:167], v28 offset:44032
  s_add_u32 s42, s43, 163840
  v_mfma_f32_16x16x32_bf16 v[108:111], v[168:171], a[44:47], v[108:111]
  buffer_store_dwordx4 v[216:219], v1, s[4:7], s42 offen sc1
  v_mfma_f32_16x16x32_bf16 v[124:127], v[172:175], a[44:47], v[124:127]
  s_add_u32 s42, s43, 180224
  v_mov_b32 v20, 2
  v_mfma_f32_16x16x32_bf16 v[96:99], v[176:179], a[48:51], v[96:99]
  ds_read_b64_tr_b16 v[168:169], v2 offset:38912
  v_mfma_f32_16x16x32_bf16 v[112:115], v[180:183], a[48:51], v[112:115]
  ds_read_b64_tr_b16 v[170:171], v2 offset:45056
  v_mfma_f32_16x16x32_bf16 v[100:103], v[176:179], a[52:55], v[100:103]
  ds_read_b64_tr_b16 v[172:173], v28 offset:38912
  v_mfma_f32_16x16x32_bf16 v[116:119], v[180:183], a[52:55], v[116:119]
  ds_read_b64_tr_b16 v[174:175], v28 offset:45056
  v_mfma_f32_16x16x32_bf16 v[104:107], v[176:179], a[56:59], v[104:107]
  buffer_store_dwordx4 v[220:223], v1, s[4:7], s42 offen sc1
  v_mfma_f32_16x16x32_bf16 v[120:123], v[180:183], a[56:59], v[120:123]
  s_lshl_b32 s43, s36, 9
  s_add_u32 s43, s43, s46
  v_cvt_pk_bf16_f32 v208, v192, v193
  v_mfma_f32_16x16x32_bf16 v[108:111], v[176:179], a[60:63], v[108:111]
  s_waitcnt vmcnt(19) lgkmcnt(0)
  v_cvt_pk_bf16_f32 v209, v194, v195
  v_cvt_pk_bf16_f32 v212, v196, v197
  v_mfma_f32_16x16x32_bf16 v[124:127], v[180:183], a[60:63], v[124:127]
  s_barrier
  v_mfma_f32_16x16x32_bf16 v[96:99], v[160:163], a[64:67], v[96:99]
  ds_read_b64_tr_b16 v[176:177], v2 offset:49152
  s_add_u32 m0, s40, 36864
  v_mfma_f32_16x16x32_bf16 v[112:115], v[164:167], a[64:67], v[112:115]
  ds_read_b64_tr_b16 v[178:179], v2 offset:55296
  v_cvt_pk_bf16_f32 v213, v198, v199
  v_mfma_f32_16x16x32_bf16 v[100:103], v[160:163], a[68:71], v[100:103]
  buffer_load_dwordx4 v27, s[8:11], s73 offen offset:0 lds
  v_mfma_f32_16x16x32_bf16 v[116:119], v[164:167], a[68:71], v[116:119]
  s_add_u32 s42, s43, 524288
  v_cvt_pk_bf16_f32 v216, v200, v201
  v_cvt_pk_bf16_f32 v217, v202, v203
  v_mfma_f32_16x16x32_bf16 v[104:107], v[160:163], a[72:75], v[104:107]
  ds_read_b64_tr_b16 v[180:181], v28 offset:49152
  v_cvt_pk_bf16_f32 v220, v204, v205
  v_mfma_f32_16x16x32_bf16 v[120:123], v[164:167], a[72:75], v[120:123]
  ds_read_b64_tr_b16 v[182:183], v28 offset:55296
  v_cvt_pk_bf16_f32 v221, v206, v207
  v_mfma_f32_16x16x32_bf16 v[108:111], v[160:163], a[76:79], v[108:111]
  buffer_store_dwordx2 v[208:209], v19, s[4:7], s42 offen sc1
  v_mfma_f32_16x16x32_bf16 v[124:127], v[164:167], a[76:79], v[124:127]
  buffer_load_dwordx4 v27, s[8:11], s74 offen offset:1024 lds
  v_mfma_f32_16x16x32_bf16 v[96:99], v[168:171], a[80:83], v[96:99]
  ds_read_b64_tr_b16 v[160:161], v2 offset:51200
  s_add_u32 s42, s43, 540672
  v_mfma_f32_16x16x32_bf16 v[112:115], v[172:175], a[80:83], v[112:115]
  ds_read_b64_tr_b16 v[162:163], v2 offset:57344
  v_mfma_f32_16x16x32_bf16 v[100:103], v[168:171], a[84:87], v[100:103]
  ds_read_b64_tr_b16 v[164:165], v28 offset:51200
  v_mfma_f32_16x16x32_bf16 v[116:119], v[172:175], a[84:87], v[116:119]
  ds_read_b64_tr_b16 v[166:167], v28 offset:57344
  v_mfma_f32_16x16x32_bf16 v[104:107], v[168:171], a[88:91], v[104:107]
  buffer_store_dwordx2 v[212:213], v19, s[4:7], s42 offen sc1
  v_mfma_f32_16x16x32_bf16 v[120:123], v[172:175], a[88:91], v[120:123]
  s_add_u32 s42, s43, 557056
  v_mfma_f32_16x16x32_bf16 v[108:111], v[168:171], a[92:95], v[108:111]
  s_waitcnt vmcnt(21) lgkmcnt(0)
  v_mfma_f32_16x16x32_bf16 v[124:127], v[172:175], a[92:95], v[124:127]
  s_barrier
  v_mfma_f32_16x16x32_bf16 v[96:99], v[176:179], a[144:147], v[96:99]
  ds_read_b64_tr_b16 v[168:169], v2 offset:61440
  v_add_u32 v2, 62464, v2
  v_mfma_f32_16x16x32_bf16 v[112:115], v[180:183], a[144:147], v[112:115]
  ds_read_b64_tr_b16 v[170:171], v2 offset:5120
  v_add_u32 v27, 128, v27
  v_mfma_f32_16x16x32_bf16 v[100:103], v[176:179], a[148:151], v[100:103]
  buffer_store_dwordx2 v[216:217], v19, s[4:7], s42 offen sc1
  v_mfma_f32_16x16x32_bf16 v[116:119], v[180:183], a[148:151], v[116:119]
  s_add_u32 m0, s40, 49152
  s_add_u32 s42, s43, 573440
  v_mfma_f32_16x16x32_bf16 v[104:107], v[176:179], a[152:155], v[104:107]
  ds_read_b64_tr_b16 v[172:173], v28 offset:61440
  v_add_u32 v28, 62464, v28
  v_mfma_f32_16x16x32_bf16 v[120:123], v[180:183], a[152:155], v[120:123]
  ds_read_b64_tr_b16 v[174:175], v28 offset:5120
  v_mfma_f32_16x16x32_bf16 v[108:111], v[176:179], a[156:159], v[108:111]
  buffer_store_dwordx2 v[220:221], v19, s[4:7], s42 offen sc1
  v_mfma_f32_16x16x32_bf16 v[124:127], v[180:183], a[156:159], v[124:127]
  buffer_load_dwordx4 v27, s[8:11], s84 offen offset:0 lds
  v_mfma_f32_16x16x32_bf16 v[96:99], v[160:163], a[96:99], v[96:99]
  ds_read_b64_tr_b16 v[176:177], v2 offset:0
  v_mfma_f32_16x16x32_bf16 v[112:115], v[164:167], a[96:99], v[112:115]
  ds_read_b64_tr_b16 v[178:179], v2 offset:6144
  v_subrev_u32 v2, 62464, v2
  v_mfma_f32_16x16x32_bf16 v[100:103], v[160:163], a[100:103], v[100:103]
  ds_read_b64_tr_b16 v[180:181], v28 offset:0
  v_mfma_f32_16x16x32_bf16 v[116:119], v[164:167], a[100:103], v[116:119]
  ds_read_b64_tr_b16 v[182:183], v28 offset:6144
  v_subrev_u32 v28, 62464, v28
  v_mfma_f32_16x16x32_bf16 v[104:107], v[160:163], a[104:107], v[104:107]
  buffer_load_dwordx4 v27, s[8:11], s85 offen offset:1024 lds
  v_mfma_f32_16x16x32_bf16 v[120:123], v[164:167], a[104:107], v[120:123]
  v_mfma_f32_16x16x32_bf16 v[108:111], v[160:163], a[108:111], v[108:111]
  s_waitcnt vmcnt(21) lgkmcnt(0)
  v_mfma_f32_16x16x32_bf16 v[124:127], v[164:167], a[108:111], v[124:127]
  s_barrier
  v_mfma_f32_16x16x32_bf16 v[96:99], v[168:171], a[112:115], v[96:99]
  ds_read_b64_tr_b16 v[160:161], v2 offset:0
  v_mfma_f32_16x16x32_bf16 v[112:115], v[172:175], a[112:115], v[112:115]
  ds_read_b64_tr_b16 v[162:163], v2 offset:6144
  v_mfma_f32_16x16x32_bf16 v[100:103], v[168:171], a[116:119], v[100:103]
  buffer_load_dwordx4 v27, s[8:11], s86 offen offset:2048 lds
  v_mfma_f32_16x16x32_bf16 v[116:119], v[172:175], a[116:119], v[116:119]
  s_add_u32 m0, s40, 61440
  v_mfma_f32_16x16x32_bf16 v[104:107], v[168:171], a[120:123], v[104:107]
  ds_read_b64_tr_b16 v[164:165], v28 offset:0
  v_mfma_f32_16x16x32_bf16 v[120:123], v[172:175], a[120:123], v[120:123]
  ds_read_b64_tr_b16 v[166:167], v28 offset:6144
  v_mfma_f32_16x16x32_bf16 v[108:111], v[168:171], a[124:127], v[108:111]
  buffer_load_dwordx4 v27, s[8:11], s87 offen offset:0 lds
  v_mfma_f32_16x16x32_bf16 v[124:127], v[172:175], a[124:127], v[124:127]
  s_lshl_b32 s44, s35, 5
  v_and_b32 v4, 15, v0
  v_lshrrev_b32 v5, 4, v0
  v_mfma_f32_16x16x32_bf16 v[96:99], v[176:179], a[128:131], v[96:99]
  ds_read_b64_tr_b16 v[168:169], v2 offset:1024
  v_lshlrev_b32 v3, 4, v4
  v_mfma_f32_16x16x32_bf16 v[112:115], v[180:183], a[128:131], v[112:115]
  ds_read_b64_tr_b16 v[170:171], v2 offset:7168
  v_lshl_add_u32 v3, v5, 12, v3
  v_mfma_f32_16x16x32_bf16 v[100:103], v[176:179], a[132:135], v[100:103]
  buffer_load_dwordx4 v27, s[8:11], s88 offen offset:1024 lds
  v_mfma_f32_16x16x32_bf16 v[116:119], v[180:183], a[132:135], v[116:119]
  s_waitcnt lgkmcnt(2)
  s_lshl_b32 s45, s36, 4
  s_add_u32 s44, s44, s45
  v_mfma_f32_16x16x32_bf16 v[104:107], v[176:179], a[136:139], v[104:107]
  ds_read_b64_tr_b16 v[172:173], v28 offset:1024
  s_add_u32 s48, s48, s44
  v_mfma_f32_16x16x32_bf16 v[120:123], v[180:183], a[136:139], v[120:123]
  ds_read_b64_tr_b16 v[174:175], v28 offset:7168
  s_and_b32 s45, s33, 1
  v_mfma_f32_16x16x32_bf16 v[108:111], v[176:179], a[140:143], v[108:111]
  buffer_load_dwordx4 v27, s[8:11], s89 offen offset:2048 lds
  v_mfma_f32_16x16x32_bf16 v[124:127], v[180:183], a[140:143], v[124:127]
  s_lshl_b32 s44, s45, 6
  s_add_u32 s51, s48, s44
  s_mul_i32 s44, s45, 640
  v_mfma_f32_16x16x32_bf16 v[96:99], v[160:163], a[176:179], v[96:99]
  ds_read_b64_tr_b16 v[176:177], v2 offset:2048
  s_add_u32 s48, s48, s44
  v_mfma_f32_16x16x32_bf16 v[112:115], v[164:167], a[176:179], v[112:115]
  ds_read_b64_tr_b16 v[178:179], v2 offset:8192
  v_mul_u32_u24 v12, 1152, v4
  v_mfma_f32_16x16x32_bf16 v[100:103], v[160:163], a[180:183], v[100:103]
  ds_read_b64_tr_b16 v[180:181], v28 offset:2048
  v_and_b32 v6, 1, v5
  v_mfma_f32_16x16x32_bf16 v[116:119], v[164:167], a[180:183], v[116:119]
  ds_read_b64_tr_b16 v[182:183], v28 offset:8192
  v_lshl_add_u32 v12, v6, 6, v12
  v_mfma_f32_16x16x32_bf16 v[104:107], v[160:163], a[184:187], v[104:107]
  v_lshrrev_b32 v7, 1, v5
  v_lshl_add_u32 v12, v7, 3, v12
  v_mfma_f32_16x16x32_bf16 v[120:123], v[164:167], a[184:187], v[120:123]
  v_and_b32 v13, 7, v4
  v_lshl_add_u32 v13, v13, 1, v6
  v_mfma_f32_16x16x32_bf16 v[108:111], v[160:163], a[188:191], v[108:111]
  s_waitcnt vmcnt(19) lgkmcnt(0)
  v_mul_u32_u24 v13, 1152, v13
  v_and_b32 v4, 8, v4
  v_mfma_f32_16x16x32_bf16 v[124:127], v[164:167], a[188:191], v[124:127]
  s_barrier
  v_mfma_f32_16x16x32_bf16 v[96:99], v[168:171], a[192:195], v[96:99]
  ds_read_b64_tr_b16 v[160:161], v2 offset:12288
  s_add_u32 m0, s40, 0
  v_mfma_f32_16x16x32_bf16 v[112:115], v[172:175], a[192:195], v[112:115]
  ds_read_b64_tr_b16 v[162:163], v2 offset:18432
  v_add_u32 v13, v13, v4
  v_mfma_f32_16x16x32_bf16 v[100:103], v[168:171], a[196:199], v[100:103]
  buffer_load_dwordx4 v27, s[20:23], s90 offen offset:0 lds
  v_mfma_f32_16x16x32_bf16 v[116:119], v[172:175], a[196:199], v[116:119]
  v_lshl_or_b32 v13, v7, 30, v13
  v_and_b32 v4, 1, v0
  v_mfma_f32_16x16x32_bf16 v[104:107], v[168:171], a[200:203], v[104:107]
  ds_read_b64_tr_b16 v[164:165], v28 offset:12288
  v_lshlrev_b32 v4, 4, v4
  v_mfma_f32_16x16x32_bf16 v[120:123], v[172:175], a[200:203], v[120:123]
  ds_read_b64_tr_b16 v[166:167], v28 offset:18432
  v_mov_b32 v5, 0x3f80
  v_mfma_f32_16x16x32_bf16 v[108:111], v[168:171], a[204:207], v[108:111]
  buffer_load_dwordx4 v27, s[8:11], s92 offen offset:2048 lds
  v_mfma_f32_16x16x32_bf16 v[124:127], v[172:175], a[204:207], v[124:127]
  v_lshlrev_b32 v4, v4, v5
  v_bfe_u32 v5, v0, 1, 3
  v_mfma_f32_16x16x32_bf16 v[96:99], v[176:179], a[208:211], v[96:99]
  ds_read_b64_tr_b16 v[168:169], v2 offset:13312
  v_cmp_eq_u32 vcc, 0, v5
  v_mfma_f32_16x16x32_bf16 v[112:115], v[180:183], a[208:211], v[112:115]
  ds_read_b64_tr_b16 v[170:171], v2 offset:19456
  v_cndmask_b32 v184, 0, v4, vcc
  v_mfma_f32_16x16x32_bf16 v[100:103], v[176:179], a[212:215], v[100:103]
  buffer_load_dwordx2 v[6:7], v12, s[12:15], s48 offen offset:128
  v_mfma_f32_16x16x32_bf16 v[116:119], v[180:183], a[212:215], v[116:119]
  buffer_load_dwordx2 v[8:9], v12, s[12:15], s48 offen offset:256
  v_mfma_f32_16x16x32_bf16 v[104:107], v[176:179], a[216:219], v[104:107]
  ds_read_b64_tr_b16 v[172:173], v28 offset:13312
  v_cmp_eq_u32 vcc, 1, v5
  v_mfma_f32_16x16x32_bf16 v[120:123], v[180:183], a[216:219], v[120:123]
  ds_read_b64_tr_b16 v[174:175], v28 offset:19456
  v_cndmask_b32 v185, 0, v4, vcc
  v_mfma_f32_16x16x32_bf16 v[108:111], v[176:179], a[220:223], v[108:111]
  buffer_load_dwordx2 v[10:11], v12, s[12:15], s48 offen offset:384
  v_mfma_f32_16x16x32_bf16 v[124:127], v[180:183], a[220:223], v[124:127]
  buffer_load_dwordx2 v[22:23], v13, s[12:15], s51 offen offset:512
  s_waitcnt lgkmcnt(4)
  v_mfma_f32_16x16x32_bf16 v[96:99], v[160:163], a[224:227], v[96:99]
  ds_read_b64_tr_b16 v[176:177], v2 offset:14336
  v_cmp_eq_u32 vcc, 2, v5
  v_mfma_f32_16x16x32_bf16 v[112:115], v[164:167], a[224:227], v[112:115]
  ds_read_b64_tr_b16 v[178:179], v2 offset:20480
  v_cndmask_b32 v186, 0, v4, vcc
  v_mfma_f32_16x16x32_bf16 v[100:103], v[160:163], a[228:231], v[100:103]
  ds_read_b64_tr_b16 v[180:181], v28 offset:14336
  v_cmp_eq_u32 vcc, 3, v5
  v_mfma_f32_16x16x32_bf16 v[116:119], v[164:167], a[228:231], v[116:119]
  ds_read_b64_tr_b16 v[182:183], v28 offset:20480
  v_cndmask_b32 v187, 0, v4, vcc
  v_mfma_f32_16x16x32_bf16 v[104:107], v[160:163], a[232:235], v[104:107]
  v_cmp_eq_u32 vcc, 4, v5
  v_mfma_f32_16x16x32_bf16 v[120:123], v[164:167], a[232:235], v[120:123]
  v_mfma_f32_16x16x32_bf16 v[108:111], v[160:163], a[236:239], v[108:111]
  s_waitcnt vmcnt(18) lgkmcnt(0)
  v_cndmask_b32 v188, 0, v4, vcc
  v_cmp_eq_u32 vcc, 5, v5
  v_mfma_f32_16x16x32_bf16 v[124:127], v[164:167], a[236:239], v[124:127]
  s_barrier
  v_mfma_f32_16x16x32_bf16 v[96:99], v[168:171], a[240:243], v[96:99]
  ds_read_b64_tr_b16 v[160:161], v2 offset:24576
  s_add_u32 m0, s40, 12288
  v_mfma_f32_16x16x32_bf16 v[112:115], v[172:175], a[240:243], v[112:115]
  ds_read_b64_tr_b16 v[162:163], v2 offset:30720
  v_cndmask_b32 v189, 0, v4, vcc
  v_mfma_f32_16x16x32_bf16 v[100:103], v[168:171], a[244:247], v[100:103]
  buffer_store_dword v20, v30, s[4:7], s56 offen sc1
  v_mfma_f32_16x16x32_bf16 v[116:119], v[172:175], a[244:247], v[116:119]
  buffer_load_dwordx4 v27, s[8:11], s93 offen offset:0 lds
  v_mfma_f32_16x16x32_bf16 v[104:107], v[168:171], a[248:251], v[104:107]
  ds_read_b64_tr_b16 v[164:165], v28 offset:24576
  v_cmp_eq_u32 vcc, 6, v5
  v_mfma_f32_16x16x32_bf16 v[120:123], v[172:175], a[248:251], v[120:123]
  ds_read_b64_tr_b16 v[166:167], v28 offset:30720
  v_cndmask_b32 v190, 0, v4, vcc
  v_mfma_f32_16x16x32_bf16 v[108:111], v[168:171], a[252:255], v[108:111]
  buffer_load_dwordx4 v27, s[8:11], s94 offen offset:1024 lds
  v_mfma_f32_16x16x32_bf16 v[124:127], v[172:175], a[252:255], v[124:127]
  v_cmp_eq_u32 vcc, 7, v5
  v_mfma_f32_16x16x32_bf16 v[96:99], v[176:179], v[32:35], v[96:99]
  ds_read_b64_tr_b16 v[168:169], v2 offset:25600
  v_cndmask_b32 v191, 0, v4, vcc
  v_mfma_f32_16x16x32_bf16 v[112:115], v[180:183], v[32:35], v[112:115]
  ds_read_b64_tr_b16 v[170:171], v2 offset:31744
  v_mfma_f32_16x16x32_bf16 v[100:103], v[176:179], v[36:39], v[100:103]
  buffer_load_dwordx2 v[4:5], v12, s[12:15], s48 offen offset:0
  v_mfma_f32_16x16x32_bf16 v[116:119], v[180:183], v[36:39], v[116:119]
  s_waitcnt lgkmcnt(2)
  v_mfma_f32_16x16x32_bf16 v[104:107], v[176:179], v[40:43], v[104:107]
  ds_read_b64_tr_b16 v[172:173], v28 offset:25600
  v_mfma_f32_16x16x32_bf16 v[120:123], v[180:183], v[40:43], v[120:123]
  ds_read_b64_tr_b16 v[174:175], v28 offset:31744
  v_mfma_f32_16x16x32_bf16 v[108:111], v[176:179], v[44:47], v[108:111]
  v_mfma_f32_16x16x32_bf16 v[124:127], v[180:183], v[44:47], v[124:127]
  v_mfma_f32_16x16x32_bf16 v[96:99], v[160:163], v[48:51], v[96:99]
  ds_read_b64_tr_b16 v[176:177], v2 offset:26624
  v_mfma_f32_16x16x32_bf16 v[112:115], v[164:167], v[48:51], v[112:115]
  ds_read_b64_tr_b16 v[178:179], v2 offset:32768
  v_mfma_f32_16x16x32_bf16 v[100:103], v[160:163], v[52:55], v[100:103]
  ds_read_b64_tr_b16 v[180:181], v28 offset:26624
  v_mfma_f32_16x16x32_bf16 v[116:119], v[164:167], v[52:55], v[116:119]
  ds_read_b64_tr_b16 v[182:183], v28 offset:32768
  v_mfma_f32_16x16x32_bf16 v[104:107], v[160:163], v[56:59], v[104:107]
  v_mfma_f32_16x16x32_bf16 v[120:123], v[164:167], v[56:59], v[120:123]
  v_mfma_f32_16x16x32_bf16 v[108:111], v[160:163], v[60:63], v[108:111]
  s_waitcnt vmcnt(19) lgkmcnt(0)
  v_mfma_f32_16x16x32_bf16 v[124:127], v[164:167], v[60:63], v[124:127]
  s_barrier
  v_mfma_f32_16x16x32_bf16 v[96:99], v[168:171], a[160:163], v[96:99]
  ds_read_b64_tr_b16 v[160:161], v2 offset:36864
  s_add_u32 m0, s40, 24576
  v_mfma_f32_16x16x32_bf16 v[112:115], v[172:175], a[160:163], v[112:115]
  ds_read_b64_tr_b16 v[162:163], v2 offset:43008
  v_mfma_f32_16x16x32_bf16 v[100:103], v[168:171], a[164:167], v[100:103]
  buffer_load_dwordx4 v27, s[8:11], s64 offen offset:0 lds
  v_mfma_f32_16x16x32_bf16 v[116:119], v[172:175], a[164:167], v[116:119]
  v_mfma_f32_16x16x32_bf16 v[104:107], v[168:171], a[168:171], v[104:107]
  ds_read_b64_tr_b16 v[164:165], v28 offset:36864
  v_mfma_f32_16x16x32_bf16 v[120:123], v[172:175], a[168:171], v[120:123]
  ds_read_b64_tr_b16 v[166:167], v28 offset:43008
  v_mfma_f32_16x16x32_bf16 v[108:111], v[168:171], a[172:175], v[108:111]
  buffer_load_dwordx4 v27, s[8:11], s65 offen offset:1024 lds
  v_mfma_f32_16x16x32_bf16 v[124:127], v[172:175], a[172:175], v[124:127]
  v_mfma_f32_16x16x32_bf16 v[96:99], v[176:179], v[64:67], v[96:99]
  ds_read_b64_tr_b16 v[168:169], v2 offset:37888
  v_mfma_f32_16x16x32_bf16 v[112:115], v[180:183], v[64:67], v[112:115]
  ds_read_b64_tr_b16 v[170:171], v2 offset:44032
  v_mfma_f32_16x16x32_bf16 v[100:103], v[176:179], v[68:71], v[100:103]
  ds_read_b64_tr_b16 v[172:173], v28 offset:37888
  v_mfma_f32_16x16x32_bf16 v[116:119], v[180:183], v[68:71], v[116:119]
  ds_read_b64_tr_b16 v[174:175], v28 offset:44032
  v_mfma_f32_16x16x32_bf16 v[104:107], v[176:179], v[72:75], v[104:107]
  buffer_load_dwordx4 v27, s[8:11], s66 offen offset:2048 lds
  v_mfma_f32_16x16x32_bf16 v[120:123], v[180:183], v[72:75], v[120:123]
  v_mfma_f32_16x16x32_bf16 v[108:111], v[176:179], v[76:79], v[108:111]
  s_waitcnt vmcnt(16) lgkmcnt(0)
  v_mfma_f32_16x16x32_bf16 v[124:127], v[180:183], v[76:79], v[124:127]
  s_barrier
  v_mfma_f32_16x16x32_bf16 v[96:99], v[160:163], v[224:227], v[96:99]
  ds_read_b64_tr_b16 v[176:177], v2 offset:49152
  s_add_u32 m0, s40, 36864
  v_mfma_f32_16x16x32_bf16 v[112:115], v[164:167], v[224:227], v[112:115]
  ds_read_b64_tr_b16 v[178:179], v2 offset:55296
  v_mfma_f32_16x16x32_bf16 v[100:103], v[160:163], v[228:231], v[100:103]
  buffer_load_dwordx4 v27, s[8:11], s67 offen offset:0 lds
  v_mfma_f32_16x16x32_bf16 v[116:119], v[164:167], v[228:231], v[116:119]
  v_mfma_f32_16x16x32_bf16 v[104:107], v[160:163], v[232:235], v[104:107]
  ds_read_b64_tr_b16 v[180:181], v28 offset:49152
  v_mfma_f32_16x16x32_bf16 v[120:123], v[164:167], v[232:235], v[120:123]
  ds_read_b64_tr_b16 v[182:183], v28 offset:55296
  v_mfma_f32_16x16x32_bf16 v[108:111], v[160:163], v[236:239], v[108:111]
  buffer_load_dwordx4 v27, s[8:11], s68 offen offset:1024 lds
  v_mfma_f32_16x16x32_bf16 v[124:127], v[164:167], v[236:239], v[124:127]
  buffer_load_dword v25, v14, s[4:7], s55 offen sc1
  v_mfma_f32_16x16x32_bf16 v[96:99], v[168:171], v[240:243], v[96:99]
  ds_read_b64_tr_b16 v[160:161], v2 offset:50176
  v_mfma_f32_16x16x32_bf16 v[112:115], v[172:175], v[240:243], v[112:115]
  ds_read_b64_tr_b16 v[162:163], v2 offset:56320
  v_mfma_f32_16x16x32_bf16 v[100:103], v[168:171], v[244:247], v[100:103]
  buffer_load_dwordx4 v27, s[8:11], s69 offen offset:2048 lds
  v_mfma_f32_16x16x32_bf16 v[116:119], v[172:175], v[244:247], v[116:119]
  s_waitcnt lgkmcnt(2)
  v_mfma_f32_16x16x32_bf16 v[104:107], v[168:171], v[248:251], v[104:107]
  ds_read_b64_tr_b16 v[164:165], v28 offset:50176
  v_mfma_f32_16x16x32_bf16 v[120:123], v[172:175], v[248:251], v[120:123]
  ds_read_b64_tr_b16 v[166:167], v28 offset:56320
  v_mfma_f32_16x16x32_bf16 v[108:111], v[168:171], v[252:255], v[108:111]
  v_mfma_f32_16x16x32_bf16 v[124:127], v[172:175], v[252:255], v[124:127]
  s_lshl_b32 s43, s36, 10
  s_add_u32 s43, s43, s46
  v_cvt_pk_bf16_f32 v208, v96, v97
  v_mfma_f32_16x16x32_bf16 v[128:131], v[176:179], a[16:19], 0
  ds_read_b64_tr_b16 v[168:169], v2 offset:51200
  v_cvt_pk_bf16_f32 v209, v98, v99
  v_mfma_f32_16x16x32_bf16 v[144:147], v[180:183], a[16:19], 0
  ds_read_b64_tr_b16 v[170:171], v2 offset:57344
  v_cvt_pk_bf16_f32 v210, v112, v113
  v_mfma_f32_16x16x32_bf16 v[132:135], v[176:179], a[20:23], 0
  ds_read_b64_tr_b16 v[172:173], v28 offset:51200
  v_cvt_pk_bf16_f32 v211, v114, v115
  v_mfma_f32_16x16x32_bf16 v[148:151], v[180:183], a[20:23], 0
  ds_read_b64_tr_b16 v[174:175], v28 offset:57344
STUB11:
  s_cbranch_execz K1_back2
  v_cvt_pk_bf16_f32 v212, v100, v101
  v_mfma_f32_16x16x32_bf16 v[136:139], v[176:179], a[24:27], 0
  s_add_u32 s42, s43, 262144
  v_cvt_pk_bf16_f32 v213, v102, v103
  v_cvt_pk_bf16_f32 v214, v116, v117
  v_mfma_f32_16x16x32_bf16 v[152:155], v[180:183], a[24:27], 0
  buffer_store_dwordx4 v[208:211], v1, s[4:7], s42 offen sc1
  v_mfma_f32_16x16x32_bf16 v[140:143], v[176:179], a[28:31], 0
  s_waitcnt vmcnt(18) lgkmcnt(0)
  v_cvt_pk_bf16_f32 v215, v118, v119
  v_cvt_pk_bf16_f32 v216, v104, v105
  v_mfma_f32_16x16x32_bf16 v[156:159], v[180:183], a[28:31], 0
  s_barrier
  v_mfma_f32_16x16x32_bf16 v[128:131], v[160:163], a[0:3], v[128:131]
  ds_read_b64_tr_b16 v[176:177], v2 offset:61440
  v_add_u32 v2, 62464, v2
  v_mfma_f32_16x16x32_bf16 v[144:147], v[164:167], a[0:3], v[144:147]
  ds_read_b64_tr_b16 v[178:179], v2 offset:5120
  s_add_u32 m0, s40, 49152
  v_mfma_f32_16x16x32_bf16 v[132:135], v[160:163], a[4:7], v[132:135]
  buffer_load_dwordx4 v27, s[20:23], s70 offen offset:0 lds
  v_mfma_f32_16x16x32_bf16 v[148:151], v[164:167], a[4:7], v[148:151]
  s_add_u32 s42, s43, 278528
  v_cvt_pk_bf16_f32 v217, v106, v107
  v_cvt_pk_bf16_f32 v218, v120, v121
  v_mfma_f32_16x16x32_bf16 v[136:139], v[160:163], a[8:11], v[136:139]
  ds_read_b64_tr_b16 v[180:181], v28 offset:61440
  v_add_u32 v28, 62464, v28
  v_mfma_f32_16x16x32_bf16 v[152:155], v[164:167], a[8:11], v[152:155]
  ds_read_b64_tr_b16 v[182:183], v28 offset:5120
  v_cvt_pk_bf16_f32 v219, v122, v123
  v_mfma_f32_16x16x32_bf16 v[140:143], v[160:163], a[12:15], v[140:143]
  buffer_store_dwordx4 v[212:215], v1, s[4:7], s42 offen sc1
  v_mfma_f32_16x16x32_bf16 v[156:159], v[164:167], a[12:15], v[156:159]
  buffer_load_dwordx4 v27, s[20:23], s71 offen offset:1024 lds
  v_mfma_f32_16x16x32_bf16 v[128:131], v[168:171], a[32:35], v[128:131]
  ds_read_b64_tr_b16 v[160:161], v2 offset:0
  v_cvt_pk_bf16_f32 v220, v108, v109
  v_mfma_f32_16x16x32_bf16 v[144:147], v[172:175], a[32:35], v[144:147]
  ds_read_b64_tr_b16 v[162:163], v2 offset:6144
  v_cvt_pk_bf16_f32 v221, v110, v111
  v_mfma_f32_16x16x32_bf16 v[132:135], v[168:171], a[36:39], v[132:135]
  buffer_load_dwordx4 v27, s[8:11], s72 offen offset:2048 lds
  v_mfma_f32_16x16x32_bf16 v[148:151], v[172:175], a[36:39], v[148:151]
  s_waitcnt lgkmcnt(2)
  v_cvt_pk_bf16_f32 v222, v124, v125
  v_cvt_pk_bf16_f32 v223, v126, v127
  v_mfma_f32_16x16x32_bf16 v[136:139], v[168:171], a[40:43], v[136:139]
  ds_read_b64_tr_b16 v[164:165], v28 offset:0
  s_add_u32 s42, s43, 294912
  v_mfma_f32_16x16x32_bf16 v[152:155], v[172:175], a[40:43], v[152:155]
  ds_read_b64_tr_b16 v[166:167], v28 offset:6144
  v_mov_b32 v20, 4
  v_mfma_f32_16x16x32_bf16 v[140:143], v[168:171], a[44:47], v[140:143]
  buffer_store_dwordx4 v[216:219], v1, s[4:7], s42 offen sc1
  v_mfma_f32_16x16x32_bf16 v[156:159], v[172:175], a[44:47], v[156:159]
  s_add_u32 s42, s43, 311296
  v_mfma_f32_16x16x32_bf16 v[128:131], v[176:179], a[48:51], v[128:131]
  ds_read_b64_tr_b16 v[168:169], v2 offset:1024
  v_mfma_f32_16x16x32_bf16 v[144:147], v[180:183], a[48:51], v[144:147]
  ds_read_b64_tr_b16 v[170:171], v2 offset:7168
  v_subrev_u32 v2, 62464, v2
  v_mfma_f32_16x16x32_bf16 v[132:135], v[176:179], a[52:55], v[132:135]
  ds_read_b64_tr_b16 v[172:173], v28 offset:1024
  v_mfma_f32_16x16x32_bf16 v[148:151], v[180:183], a[52:55], v[148:151]
  ds_read_b64_tr_b16 v[174:175], v28 offset:7168
  v_subrev_u32 v28, 62464, v28
  v_mfma_f32_16x16x32_bf16 v[136:139], v[176:179], a[56:59], v[136:139]
  buffer_store_dwordx4 v[220:223], v1, s[4:7], s42 offen sc1
  v_mfma_f32_16x16x32_bf16 v[152:155], v[180:183], a[56:59], v[152:155]
  v_mfma_f32_16x16x32_bf16 v[140:143], v[176:179], a[60:63], v[140:143]
  s_waitcnt vmcnt(22) lgkmcnt(0)
  v_mfma_f32_16x16x32_bf16 v[156:159], v[180:183], a[60:63], v[156:159]
  s_barrier
  v_mfma_f32_16x16x32_bf16 v[128:131], v[160:163], a[64:67], v[128:131]
  ds_read_b64_tr_b16 v[176:177], v2 offset:0
  s_add_u32 m0, s40, 61440
  v_mfma_f32_16x16x32_bf16 v[144:147], v[164:167], a[64:67], v[144:147]
  ds_read_b64_tr_b16 v[178:179], v2 offset:6144
  v_mfma_f32_16x16x32_bf16 v[132:135], v[160:163], a[68:71], v[132:135]
  buffer_load_dwordx4 v27, s[8:11], s73 offen offset:0 lds
  v_mfma_f32_16x16x32_bf16 v[148:151], v[164:167], a[68:71], v[148:151]
  v_mfma_f32_16x16x32_bf16 v[136:139], v[160:163], a[72:75], v[136:139]
  ds_read_b64_tr_b16 v[180:181], v28 offset:0
  v_mfma_f32_16x16x32_bf16 v[152:155], v[164:167], a[72:75], v[152:155]
  ds_read_b64_tr_b16 v[182:183], v28 offset:6144
  v_mfma_f32_16x16x32_bf16 v[140:143], v[160:163], a[76:79], v[140:143]
  buffer_load_dwordx4 v27, s[8:11], s74 offen offset:1024 lds
  v_mfma_f32_16x16x32_bf16 v[156:159], v[164:167], a[76:79], v[156:159]
  v_mfma_f32_16x16x32_bf16 v[128:131], v[168:171], a[80:83], v[128:131]
  ds_read_b64_tr_b16 v[160:161], v2 offset:2048
  v_mfma_f32_16x16x32_bf16 v[144:147], v[172:175], a[80:83], v[144:147]
  ds_read_b64_tr_b16 v[162:163], v2 offset:8192
  v_mfma_f32_16x16x32_bf16 v[132:135], v[168:171], a[84:87], v[132:135]
  ds_read_b64_tr_b16 v[164:165], v28 offset:2048
  v_mfma_f32_16x16x32_bf16 v[148:151], v[172:175], a[84:87], v[148:151]
  ds_read_b64_tr_b16 v[166:167], v28 offset:8192
  v_mfma_f32_16x16x32_bf16 v[136:139], v[168:171], a[88:91], v[136:139]
  v_mfma_f32_16x16x32_bf16 v[152:155], v[172:175], a[88:91], v[152:155]
  v_mfma_f32_16x16x32_bf16 v[140:143], v[168:171], a[92:95], v[140:143]
  s_waitcnt vmcnt(17) lgkmcnt(0)
  v_mfma_f32_16x16x32_bf16 v[156:159], v[172:175], a[92:95], v[156:159]
  s_barrier
  v_mfma_f32_16x16x32_bf16 v[128:131], v[176:179], a[144:147], v[128:131]
  ds_read_b64_tr_b16 v[168:169], v2 offset:12288
  v_mfma_f32_16x16x32_bf16 v[144:147], v[180:183], a[144:147], v[144:147]
  ds_read_b64_tr_b16 v[170:171], v2 offset:18432
  v_mfma_f32_16x16x32_bf16 v[132:135], v[176:179], a[148:151], v[132:135]
  v_mfma_f32_16x16x32_bf16 v[148:151], v[180:183], a[148:151], v[148:151]
  v_mfma_f32_16x16x32_bf16 v[136:139], v[176:179], a[152:155], v[136:139]
  ds_read_b64_tr_b16 v[172:173], v28 offset:12288
  v_mfma_f32_16x16x32_bf16 v[152:155], v[180:183], a[152:155], v[152:155]
  ds_read_b64_tr_b16 v[174:175], v28 offset:18432
  v_mfma_f32_16x16x32_bf16 v[140:143], v[176:179], a[156:159], v[140:143]
  v_mfma_f32_16x16x32_bf16 v[156:159], v[180:183], a[156:159], v[156:159]
  v_mfma_f32_16x16x32_bf16 v[128:131], v[160:163], a[96:99], v[128:131]
  ds_read_b64_tr_b16 v[176:177], v2 offset:13312
  v_mfma_f32_16x16x32_bf16 v[144:147], v[164:167], a[96:99], v[144:147]
  ds_read_b64_tr_b16 v[178:179], v2 offset:19456
  v_mfma_f32_16x16x32_bf16 v[132:135], v[160:163], a[100:103], v[132:135]
  ds_read_b64_tr_b16 v[180:181], v28 offset:13312
  v_mfma_f32_16x16x32_bf16 v[148:151], v[164:167], a[100:103], v[148:151]
  ds_read_b64_tr_b16 v[182:183], v28 offset:19456
  v_mfma_f32_16x16x32_bf16 v[136:139], v[160:163], a[104:107], v[136:139]
  v_mfma_f32_16x16x32_bf16 v[152:155], v[164:167], a[104:107], v[152:155]
  v_mfma_f32_16x16x32_bf16 v[140:143], v[160:163], a[108:111], v[140:143]
  s_waitcnt vmcnt(13) lgkmcnt(0)
  v_mfma_f32_16x16x32_bf16 v[156:159], v[164:167], a[108:111], v[156:159]
  s_barrier
  v_mfma_f32_16x16x32_bf16 v[128:131], v[168:171], a[112:115], v[128:131]
  ds_read_b64_tr_b16 v[160:161], v2 offset:24576
  v_mfma_f32_16x16x32_bf16 v[144:147], v[172:175], a[112:115], v[144:147]
  ds_read_b64_tr_b16 v[162:163], v2 offset:30720
  v_mfma_f32_16x16x32_bf16 v[132:135], v[168:171], a[116:119], v[132:135]
  v_mfma_f32_16x16x32_bf16 v[148:151], v[172:175], a[116:119], v[148:151]
  v_mfma_f32_16x16x32_bf16 v[136:139], v[168:171], a[120:123], v[136:139]
  ds_read_b64_tr_b16 v[164:165], v28 offset:24576
  v_mfma_f32_16x16x32_bf16 v[152:155], v[172:175], a[120:123], v[152:155]
  ds_read_b64_tr_b16 v[166:167], v28 offset:30720
  v_mfma_f32_16x16x32_bf16 v[140:143], v[168:171], a[124:127], v[140:143]
  v_mfma_f32_16x16x32_bf16 v[156:159], v[172:175], a[124:127], v[156:159]
  s_waitcnt vmcnt(10)
  v_cmp_le_u32 s[62:63], 2, v25
  v_mfma_f32_16x16x32_bf16 v[128:131], v[176:179], a[128:131], v[128:131]
  ds_read_b64_tr_b16 v[168:169], v2 offset:25600
  v_mfma_f32_16x16x32_bf16 v[144:147], v[180:183], a[128:131], v[144:147]
  ds_read_b64_tr_b16 v[170:171], v2 offset:31744
  v_mfma_f32_16x16x32_bf16 v[132:135], v[176:179], a[132:135], v[132:135]
  s_cmp_eq_u64 s[62:63], -1
  s_cbranch_scc0 SLOW1
RES1:
  s_lshl_b32 s44, s34, 9
  v_mfma_f32_16x16x32_bf16 v[148:151], v[180:183], a[132:135], v[148:151]
  s_waitcnt lgkmcnt(2)
  s_add_u32 s44, s44, s47
  s_add_u32 s44, s44, 0
  v_mfma_f32_16x16x32_bf16 v[136:139], v[176:179], a[136:139], v[136:139]
  ds_read_b64_tr_b16 v[172:173], v28 offset:25600
  v_mfma_f32_16x16x32_bf16 v[152:155], v[180:183], a[136:139], v[152:155]
  ds_read_b64_tr_b16 v[174:175], v28 offset:31744
  v_mfma_f32_16x16x32_bf16 v[140:143], v[176:179], a[140:143], v[140:143]
  buffer_load_dwordx4 a[0:3], v3, s[4:7], s44 offen offset:0 sc1
  v_mfma_f32_16x16x32_bf16 v[156:159], v[180:183], a[140:143], v[156:159]
  v_mfma_f32_16x16x32_bf16 v[128:131], v[160:163], a[176:179], v[128:131]
  ds_read_b64_tr_b16 v[176:177], v2 offset:26624
  v_mfma_f32_16x16x32_bf16 v[144:147], v[164:167], a[176:179], v[144:147]
  ds_read_b64_tr_b16 v[178:179], v2 offset:32768
  v_mfma_f32_16x16x32_bf16 v[132:135], v[160:163], a[180:183], v[132:135]
  ds_read_b64_tr_b16 v[180:181], v28 offset:26624
  v_mfma_f32_16x16x32_bf16 v[148:151], v[164:167], a[180:183], v[148:151]
  ds_read_b64_tr_b16 v[182:183], v28 offset:32768
  v_mfma_f32_16x16x32_bf16 v[136:139], v[160:163], a[184:187], v[136:139]
  buffer_load_dwordx4 a[4:7], v3, s[4:7], s44 offen offset:2048 sc1
  v_mfma_f32_16x16x32_bf16 v[152:155], v[164:167], a[184:187], v[152:155]
  v_mfma_f32_16x16x32_bf16 v[140:143], v[160:163], a[188:191], v[140:143]
  s_waitcnt vmcnt(11) lgkmcnt(0)
  v_mfma_f32_16x16x32_bf16 v[156:159], v[164:167], a[188:191], v[156:159]
  s_barrier
  v_mfma_f32_16x16x32_bf16 v[128:131], v[168:171], a[192:195], v[128:131]
  ds_read_b64_tr_b16 v[160:161], v2 offset:36864
  v_mfma_f32_16x16x32_bf16 v[144:147], v[172:175], a[192:195], v[144:147]
  ds_read_b64_tr_b16 v[162:163], v2 offset:43008
  v_mfma_f32_16x16x32_bf16 v[132:135], v[168:171], a[196:199], v[132:135]
  buffer_load_dwordx4 a[8:11], v3, s[4:7], s44 offen offset:256 sc1
  v_mfma_f32_16x16x32_bf16 v[148:151], v[172:175], a[196:199], v[148:151]
  v_mfma_f32_16x16x32_bf16 v[136:139], v[168:171], a[200:203], v[136:139]
  ds_read_b64_tr_b16 v[164:165], v28 offset:36864
  v_mfma_f32_16x16x32_bf16 v[152:155], v[172:175], a[200:203], v[152:155]
  ds_read_b64_tr_b16 v[166:167], v28 offset:43008
  v_mfma_f32_16x16x32_bf16 v[140:143], v[168:171], a[204:207], v[140:143]
  buffer_load_dwordx4 a[12:15], v3, s[4:7], s44 offen offset:2304 sc1
  v_mfma_f32_16x16x32_bf16 v[156:159], v[172:175], a[204:207], v[156:159]
  s_lshl_b32 s44, s34, 9
  s_add_u32 s44, s44, s47
  s_add_u32 s44, s44, 131072
  v_mfma_f32_16x16x32_bf16 v[128:131], v[176:179], a[208:211], v[128:131]
  ds_read_b64_tr_b16 v[168:169], v2 offset:37888
  v_mfma_f32_16x16x32_bf16 v[144:147], v[180:183], a[208:211], v[144:147]
  ds_read_b64_tr_b16 v[170:171], v2 offset:44032
  v_mfma_f32_16x16x32_bf16 v[132:135], v[176:179], a[212:215], v[132:135]
  buffer_load_dwordx4 a[16:19], v3, s[4:7], s44 offen offset:0 sc1
  v_mfma_f32_16x16x32_bf16 v[148:151], v[180:183], a[212:215], v[148:151]
  s_waitcnt lgkmcnt(2)
  v_mfma_f32_16x16x32_bf16 v[136:139], v[176:179], a[216:219], v[136:139]
  ds_read_b64_tr_b16 v[172:173], v28 offset:37888
  v_mfma_f32_16x16x32_bf16 v[152:155], v[180:183], a[216:219], v[152:155]
  ds_read_b64_tr_b16 v[174:175], v28 offset:44032
  v_mfma_f32_16x16x32_bf16 v[140:143], v[176:179], a[220:223], v[140:143]
  buffer_load_dwordx4 a[20:23], v3, s[4:7], s44 offen offset:2048 sc1
  v_mfma_f32_16x16x32_bf16 v[156:159], v[180:183], a[220:223], v[156:159]
  v_mfma_f32_16x16x32_bf16 v[128:131], v[160:163], a[224:227], v[128:131]
  ds_read_b64_tr_b16 v[176:177], v2 offset:38912
  v_mfma_f32_16x16x32_bf16 v[144:147], v[164:167], a[224:227], v[144:147]
  ds_read_b64_tr_b16 v[178:179], v2 offset:45056
  v_mfma_f32_16x16x32_bf16 v[132:135], v[160:163], a[228:231], v[132:135]
  ds_read_b64_tr_b16 v[180:181], v28 offset:38912
  v_mfma_f32_16x16x32_bf16 v[148:151], v[164:167], a[228:231], v[148:151]
  ds_read_b64_tr_b16 v[182:183], v28 offset:45056
  v_mfma_f32_16x16x32_bf16 v[136:139], v[160:163], a[232:235], v[136:139]
  buffer_load_dwordx4 a[24:27], v3, s[4:7], s44 offen offset:256 sc1
  v_mfma_f32_16x16x32_bf16 v[152:155], v[164:167], a[232:235], v[152:155]
  v_mfma_f32_16x16x32_bf16 v[140:143], v[160:163], a[236:239], v[140:143]
  s_waitcnt vmcnt(9) lgkmcnt(0)
  v_mfma_f32_16x16x32_bf16 v[156:159], v[164:167], a[236:239], v[156:159]
  s_barrier
  v_mfma_f32_16x16x32_bf16 v[128:131], v[168:171], a[240:243], v[128:131]
  ds_read_b64_tr_b16 v[160:161], v2 offset:49152
  v_mfma_f32_16x16x32_bf16 v[144:147], v[172:175], a[240:243], v[144:147]
  ds_read_b64_tr_b16 v[162:163], v2 offset:55296
  v_mfma_f32_16x16x32_bf16 v[132:135], v[168:171], a[244:247], v[132:135]
  buffer_store_dword v20, v30, s[4:7], s56 offen sc1
  v_mfma_f32_16x16x32_bf16 v[148:151], v[172:175], a[244:247], v[148:151]
  buffer_load_dwordx4 a[28:31], v3, s[4:7], s44 offen offset:2304 sc1
  v_mfma_f32_16x16x32_bf16 v[136:139], v[168:171], a[248:251], v[136:139]
  ds_read_b64_tr_b16 v[164:165], v28 offset:49152
  v_mfma_f32_16x16x32_bf16 v[152:155], v[172:175], a[248:251], v[152:155]
  ds_read_b64_tr_b16 v[166:167], v28 offset:55296
  v_mfma_f32_16x16x32_bf16 v[140:143], v[168:171], a[252:255], v[140:143]
  v_mfma_f32_16x16x32_bf16 v[156:159], v[172:175], a[252:255], v[156:159]
  v_mfma_f32_16x16x32_bf16 v[128:131], v[176:179], v[32:35], v[128:131]
  ds_read_b64_tr_b16 v[168:169], v2 offset:50176
  v_mfma_f32_16x16x32_bf16 v[144:147], v[180:183], v[32:35], v[144:147]
  ds_read_b64_tr_b16 v[170:171], v2 offset:56320
  v_mfma_f32_16x16x32_bf16 v[132:135], v[176:179], v[36:39], v[132:135]
  v_mfma_f32_16x16x32_bf16 v[148:151], v[180:183], v[36:39], v[148:151]
  s_waitcnt lgkmcnt(2)
  v_mfma_f32_16x16x32_bf16 v[136:139], v[176:179], v[40:43], v[136:139]
  ds_read_b64_tr_b16 v[172:173], v28 offset:50176
  v_mfma_f32_16x16x32_bf16 v[152:155], v[180:183], v[40:43], v[152:155]
  ds_read_b64_tr_b16 v[174:175], v28 offset:56320
  v_mfma_f32_16x16x32_bf16 v[140:143], v[176:179], v[44:47], v[140:143]
  v_mfma_f32_16x16x32_bf16 v[156:159], v[180:183], v[44:47], v[156:159]
  v_mfma_f32_16x16x32_bf16 v[128:131], v[160:163], v[48:51], v[128:131]
  ds_read_b64_tr_b16 v[176:177], v2 offset:51200
  v_mfma_f32_16x16x32_bf16 v[144:147], v[164:167], v[48:51], v[144:147]
  ds_read_b64_tr_b16 v[178:179], v2 offset:57344
  v_mfma_f32_16x16x32_bf16 v[132:135], v[160:163], v[52:55], v[132:135]
  ds_read_b64_tr_b16 v[180:181], v28 offset:51200
  v_mfma_f32_16x16x32_bf16 v[148:151], v[164:167], v[52:55], v[148:151]
  ds_read_b64_tr_b16 v[182:183], v28 offset:57344
  v_mfma_f32_16x16x32_bf16 v[136:139], v[160:163], v[56:59], v[136:139]
  v_mfma_f32_16x16x32_bf16 v[152:155], v[164:167], v[56:59], v[152:155]
  v_mfma_f32_16x16x32_bf16 v[140:143], v[160:163], v[60:63], v[140:143]
  s_waitcnt vmcnt(9) lgkmcnt(0)
  v_mfma_f32_16x16x32_bf16 v[156:159], v[164:167], v[60:63], v[156:159]
  s_barrier
  v_mfma_f32_16x16x32_bf16 v[128:131], v[168:171], a[160:163], v[128:131]
  ds_read_b64_tr_b16 v[160:161], v2 offset:61440
  v_add_u32 v2, 62464, v2
  v_mfma_f32_16x16x32_bf16 v[144:147], v[172:175], a[160:163], v[144:147]
  ds_read_b64_tr_b16 v[162:163], v2 offset:5120
  v_mfma_f32_16x16x32_bf16 v[132:135], v[168:171], a[164:167], v[132:135]
  v_mfma_f32_16x16x32_bf16 v[148:151], v[172:175], a[164:167], v[148:151]
  v_mfma_f32_16x16x32_bf16 v[136:139], v[168:171], a[168:171], v[136:139]
  ds_read_b64_tr_b16 v[164:165], v28 offset:61440
  v_add_u32 v28, 62464, v28
  v_mfma_f32_16x16x32_bf16 v[152:155], v[172:175], a[168:171], v[152:155]
  ds_read_b64_tr_b16 v[166:167], v28 offset:5120
  v_mfma_f32_16x16x32_bf16 v[140:143], v[168:171], a[172:175], v[140:143]
  v_mfma_f32_16x16x32_bf16 v[156:159], v[172:175], a[172:175], v[156:159]
  v_mfma_f32_16x16x32_bf16 v[128:131], v[176:179], v[64:67], v[128:131]
  ds_read_b64_tr_b16 v[168:169], v2 offset:0
  v_mfma_f32_16x16x32_bf16 v[144:147], v[180:183], v[64:67], v[144:147]
  ds_read_b64_tr_b16 v[170:171], v2 offset:6144
  v_mfma_f32_16x16x32_bf16 v[132:135], v[176:179], v[68:71], v[132:135]
  v_mfma_f32_16x16x32_bf16 v[148:151], v[180:183], v[68:71], v[148:151]
  s_waitcnt lgkmcnt(2)
  v_mfma_f32_16x16x32_bf16 v[136:139], v[176:179], v[72:75], v[136:139]
  ds_read_b64_tr_b16 v[172:173], v28 offset:0
  v_mfma_f32_16x16x32_bf16 v[152:155], v[180:183], v[72:75], v[152:155]
  ds_read_b64_tr_b16 v[174:175], v28 offset:6144
  v_mfma_f32_16x16x32_bf16 v[140:143], v[176:179], v[76:79], v[140:143]
  v_mfma_f32_16x16x32_bf16 v[156:159], v[180:183], v[76:79], v[156:159]
  v_mfma_f32_16x16x32_bf16 v[128:131], v[160:163], v[224:227], v[128:131]
  v_mfma_f32_16x16x32_bf16 v[144:147], v[164:167], v[224:227], v[144:147]
  v_mfma_f32_16x16x32_bf16 v[132:135], v[160:163], v[228:231], v[132:135]
  v_mfma_f32_16x16x32_bf16 v[148:151], v[164:167], v[228:231], v[148:151]
  v_mfma_f32_16x16x32_bf16 v[136:139], v[160:163], v[232:235], v[136:139]
  v_mfma_f32_16x16x32_bf16 v[152:155], v[164:167], v[232:235], v[152:155]
  v_mfma_f32_16x16x32_bf16 v[140:143], v[160:163], v[236:239], v[140:143]
  s_waitcnt lgkmcnt(0)
  v_mfma_f32_16x16x32_bf16 v[156:159], v[164:167], v[236:239], v[156:159]
  s_barrier
  v_mfma_f32_16x16x32_bf16 v[128:131], v[168:171], v[240:243], v[128:131]
  v_mfma_f32_16x16x32_bf16 v[144:147], v[172:175], v[240:243], v[144:147]
  v_mfma_f32_16x16x32_bf16 v[132:135], v[168:171], v[244:247], v[132:135]
  v_mfma_f32_16x16x32_bf16 v[148:151], v[172:175], v[244:247], v[148:151]
  v_mfma_f32_16x16x32_bf16 v[136:139], v[168:171], v[248:251], v[136:139]
  v_mfma_f32_16x16x32_bf16 v[152:155], v[172:175], v[248:251], v[152:155]
  v_mfma_f32_16x16x32_bf16 v[140:143], v[168:171], v[252:255], v[140:143]
  v_mfma_f32_16x16x32_bf16 v[156:159], v[172:175], v[252:255], v[156:159]
  s_lshl_b32 s43, s36, 10
  s_add_u32 s43, s43, s46
  v_cvt_pk_bf16_f32 v208, v128, v129
  v_cvt_pk_bf16_f32 v209, v130, v131
  v_cvt_pk_bf16_f32 v210, v144, v145
  v_cvt_pk_bf16_f32 v211, v146, v147
  v_cvt_pk_bf16_f32 v212, v132, v133
  v_cvt_pk_bf16_f32 v213, v134, v135
  v_cvt_pk_bf16_f32 v214, v148, v149
  v_cvt_pk_bf16_f32 v215, v150, v151
  v_cvt_pk_bf16_f32 v216, v136, v137
  v_cvt_pk_bf16_f32 v217, v138, v139
  v_cvt_pk_bf16_f32 v218, v152, v153
  v_cvt_pk_bf16_f32 v219, v154, v155
  v_cvt_pk_bf16_f32 v220, v140, v141
  v_cvt_pk_bf16_f32 v221, v142, v143
  v_cvt_pk_bf16_f32 v222, v156, v157
  v_cvt_pk_bf16_f32 v223, v158, v159
  s_add_u32 s42, s43, 393216
  buffer_store_dwordx4 v[208:211], v1, s[4:7], s42 offen sc1
  s_add_u32 s42, s43, 409600
  buffer_store_dwordx4 v[212:215], v1, s[4:7], s42 offen sc1
  s_add_u32 s42, s43, 425984
  buffer_store_dwordx4 v[216:219], v1, s[4:7], s42 offen sc1
  s_add_u32 s42, s43, 442368
  buffer_store_dwordx4 v[220:223], v1, s[4:7], s42 offen sc1
  v_mov_b32 v20, 5
  buffer_load_dword v26, v14, s[4:7], s55 offen sc1
  v_lshlrev_b32 v32, 16, v4
  v_and_b32 v33, 0xffff0000, v4
  v_lshlrev_b32 v34, 16, v5
  v_and_b32 v35, 0xffff0000, v5
  v_lshlrev_b32 v36, 16, v6
  v_and_b32 v37, 0xffff0000, v6
  v_lshlrev_b32 v38, 16, v7
  v_and_b32 v39, 0xffff0000, v7
  v_lshlrev_b32 v48, 16, v22
  v_and_b32 v49, 0xffff0000, v22
  v_lshlrev_b32 v50, 16, v23
  v_and_b32 v51, 0xffff0000, v23
  v_lshlrev_b32 v40, 16, v8
  v_and_b32 v41, 0xffff0000, v8
  v_lshlrev_b32 v42, 16, v9
  v_and_b32 v43, 0xffff0000, v9
  v_lshlrev_b32 v44, 16, v10
  v_and_b32 v45, 0xffff0000, v10
  v_lshlrev_b32 v46, 16, v11
  v_and_b32 v47, 0xffff0000, v11
  s_waitcnt vmcnt(13)
  v_mfma_f32_16x16x32_bf16 v[32:35], v[184:187], a[0:3], v[32:35]
  s_waitcnt vmcnt(12)
  v_mfma_f32_16x16x32_bf16 v[32:35], v[184:187], a[4:7], v[32:35]
  s_waitcnt vmcnt(11)
  v_mfma_f32_16x16x32_bf16 v[32:35], v[188:191], a[8:11], v[32:35]
  s_waitcnt vmcnt(10)
  v_mfma_f32_16x16x32_bf16 v[32:35], v[188:191], a[12:15], v[32:35]
  s_nop 7
  v_cvt_pk_bf16_f32 v32, v32, v33
  v_cvt_pk_bf16_f32 v33, v34, v35
  buffer_store_dwordx2 v[32:33], v12, s[16:19], s48 offen offset:0
  s_waitcnt vmcnt(10)
  v_mfma_f32_16x16x32_bf16 v[36:39], v[184:187], a[16:19], v[36:39]
  s_waitcnt vmcnt(9)
  v_mfma_f32_16x16x32_bf16 v[36:39], v[184:187], a[20:23], v[36:39]
  s_waitcnt vmcnt(8)
  v_mfma_f32_16x16x32_bf16 v[36:39], v[188:191], a[24:27], v[36:39]
  s_waitcnt vmcnt(6)
  v_mfma_f32_16x16x32_bf16 v[36:39], v[188:191], a[28:31], v[36:39]
  s_nop 7
  v_cvt_pk_bf16_f32 v36, v36, v37
  v_cvt_pk_bf16_f32 v37, v38, v39
  buffer_store_dwordx2 v[36:37], v12, s[16:19], s48 offen offset:128
  s_waitcnt vmcnt(3)
  s_barrier
  buffer_store_dword v20, v30, s[4:7], s56 offen sc1
  s_waitcnt vmcnt(3)
  v_cmp_le_u32 s[60:61], 4, v26
  s_nop 3
  s_cmp_eq_u64 s[60:61], -1
  s_cbranch_scc0 SLOW2
RES2:
  s_lshl_b32 s44, s34, 8
  s_add_u32 s44, s44, s47
  s_add_u32 s44, s44, 524288
  buffer_load_dwordx4 a[64:67], v3, s[4:7], s44 offen offset:0 sc1
  buffer_load_dwordx4 a[68:71], v3, s[4:7], s44 offen offset:2048 sc1
  s_lshl_b32 s44, s34, 9
  s_add_u32 s44, s44, s47
  s_add_u32 s44, s44, 262144
  buffer_load_dwordx4 a[32:35], v3, s[4:7], s44 offen offset:0 sc1
  buffer_load_dwordx4 a[36:39], v3, s[4:7], s44 offen offset:2048 sc1
  buffer_load_dwordx4 a[40:43], v3, s[4:7], s44 offen offset:256 sc1
  buffer_load_dwordx4 a[44:47], v3, s[4:7], s44 offen offset:2304 sc1
  buffer_load_dword v25, v14, s[4:7], s55 offen sc1
  s_waitcnt vmcnt(6)
  v_mfma_f32_16x16x32_bf16 v[48:51], v[184:187], a[64:67], v[48:51]
  s_waitcnt vmcnt(5)
  v_mfma_f32_16x16x32_bf16 v[48:51], v[184:187], a[68:71], v[48:51]
  s_nop 7
  v_cvt_pk_bf16_f32 v48, v48, v49
  v_cvt_pk_bf16_f32 v49, v50, v51
  buffer_store_dwordx2 v[48:49], v13, s[16:19], s51 offen offset:512
  s_waitcnt vmcnt(5)
  v_mfma_f32_16x16x32_bf16 v[40:43], v[184:187], a[32:35], v[40:43]
  s_waitcnt vmcnt(4)
  v_mfma_f32_16x16x32_bf16 v[40:43], v[184:187], a[36:39], v[40:43]
  s_waitcnt vmcnt(3)
  v_mfma_f32_16x16x32_bf16 v[40:43], v[188:191], a[40:43], v[40:43]
  s_waitcnt vmcnt(2)
  v_mfma_f32_16x16x32_bf16 v[40:43], v[188:191], a[44:47], v[40:43]
  s_nop 7
  v_cvt_pk_bf16_f32 v40, v40, v41
  v_cvt_pk_bf16_f32 v41, v42, v43
  buffer_store_dwordx2 v[40:41], v12, s[16:19], s48 offen offset:256
  s_waitcnt vmcnt(2)
  v_cmp_le_u32 s[62:63], 5, v25
  s_nop 3
  s_cmp_eq_u64 s[62:63], -1
  s_cbranch_scc0 SLOW3
RES3:
  s_lshl_b32 s44, s34, 9
  s_add_u32 s44, s44, s47
  s_add_u32 s44, s44, 393216
  buffer_load_dwordx4 a[48:51], v3, s[4:7], s44 offen offset:0 sc1
  buffer_load_dwordx4 a[52:55], v3, s[4:7], s44 offen offset:2048 sc1
  buffer_load_dwordx4 a[56:59], v3, s[4:7], s44 offen offset:256 sc1
  buffer_load_dwordx4 a[60:63], v3, s[4:7], s44 offen offset:2304 sc1
  s_waitcnt vmcnt(3)
  v_mfma_f32_16x16x32_bf16 v[44:47], v[184:187], a[48:51], v[44:47]
  s_waitcnt vmcnt(2)
  v_mfma_f32_16x16x32_bf16 v[44:47], v[184:187], a[52:55], v[44:47]
  s_waitcnt vmcnt(1)
  v_mfma_f32_16x16x32_bf16 v[44:47], v[188:191], a[56:59], v[44:47]
  s_waitcnt vmcnt(0)
  v_mfma_f32_16x16x32_bf16 v[44:47], v[188:191], a[60:63], v[44:47]
  s_nop 7
  v_cvt_pk_bf16_f32 v44, v44, v45
  v_cvt_pk_bf16_f32 v45, v46, v47
  buffer_store_dwordx2 v[44:45], v12, s[16:19], s48 offen offset:384
K1_end:
  s_endpgm
SLOW20:
  s_mov_b32 s3, 200000
SLOW20L:
  buffer_load_dword v24, off, s[4:7], s53 offset:0 sc1
  s_waitcnt vmcnt(0)
  v_cmp_le_u32 s[62:63], 1, v24
  s_nop 3
  s_cmp_eq_u64 s[62:63], -1
  s_cbranch_scc1 RES20
  s_sleep 8
  s_sub_u32 s3, s3, 1
  s_cbranch_scc0 SLOW20L
  s_branch RES20
SLOW21:
  s_mov_b32 s3, 200000
SLOW21L:
  buffer_load_dword v24, off, s[4:7], s53 offset:4 sc1
  s_waitcnt vmcnt(0)
  v_cmp_le_u32 s[62:63], 1, v24
  s_nop 3
  s_cmp_eq_u64 s[62:63], -1
  s_cbranch_scc1 RES21
  s_sleep 8
  s_sub_u32 s3, s3, 1
  s_cbranch_scc0 SLOW21L
  s_branch RES21
SLOW22:
  s_mov_b32 s3, 200000
SLOW22L:
  buffer_load_dword v24, off, s[4:7], s53 offset:8 sc1
  s_waitcnt vmcnt(0)
  v_cmp_le_u32 s[62:63], 1, v24
  s_nop 3
  s_cmp_eq_u64 s[62:63], -1
  s_cbranch_scc1 RES22
  s_sleep 8
  s_sub_u32 s3, s3, 1
  s_cbranch_scc0 SLOW22L
  s_branch RES22
SLOW23:
  s_mov_b32 s3, 200000
SLOW23L:
  buffer_load_dword v24, off, s[4:7], s53 offset:12 sc1
  s_waitcnt vmcnt(0)
  v_cmp_le_u32 s[62:63], 1, v24
  s_nop 3
  s_cmp_eq_u64 s[62:63], -1
  s_cbranch_scc1 RES23
  s_sleep 8
  s_sub_u32 s3, s3, 1
  s_cbranch_scc0 SLOW23L
  s_branch RES23
SLOW1:
  s_mov_b32 s3, 200000
SLOW1L:
  buffer_load_dword v25, v14, s[4:7], s55 offen sc1
  s_waitcnt vmcnt(0)
  v_cmp_le_u32 s[62:63], 2, v25
  s_nop 3
  s_cmp_eq_u64 s[62:63], -1
  s_cbranch_scc1 RES1
  s_sleep 8
  s_sub_u32 s3, s3, 1
  s_cbranch_scc0 SLOW1L
  s_branch RES1
SLOW2:
  s_mov_b32 s3, 200000
SLOW2L:
  buffer_load_dword v26, v14, s[4:7], s55 offen sc1
  s_waitcnt vmcnt(0)
  v_cmp_le_u32 s[60:61], 4, v26
  s_nop 3
  s_cmp_eq_u64 s[60:61], -1
  s_cbranch_scc1 RES2
  s_sleep 8
  s_sub_u32 s3, s3, 1
  s_cbranch_scc0 SLOW2L
  s_branch RES2
SLOW3:
  s_mov_b32 s3, 200000
SLOW3L:
  buffer_load_dword v25, v14, s[4:7], s55 offen sc1
  s_waitcnt vmcnt(0)
  v_cmp_le_u32 s[62:63], 5, v25
  s_nop 3
  s_cmp_eq_u64 s[62:63], -1
  s_cbranch_scc1 RES3
  s_sleep 8
  s_sub_u32 s3, s3, 1
  s_cbranch_scc0 SLOW3L
  s_branch RES3
SLOW0:
  s_mov_b32 s3, 200000
SLOW0L:
  buffer_load_dword v21, v14, s[4:7], s53 offen sc1
  s_waitcnt vmcnt(0)
  v_cmp_le_u32 s[60:61], 1, v21
  s_nop 3
  s_cmp_eq_u64 s[60:61], -1
  s_cbranch_scc1 RES0
  s_sleep 8
  s_sub_u32 s3, s3, 1
  s_cbranch_scc0 SLOW0L
  s_branch RES0
K1_last:
.section .rodata,"a"
.p2align 6
.amdhsa_kernel parallel_sum__linear_kernel_hedgehog__glu_gated_reglu__prompt_kernel
  .amdhsa_next_free_vgpr 512
  .amdhsa_next_free_sgpr 102
  .amdhsa_accum_offset 256
  .amdhsa_group_segment_fixed_size 0
  .amdhsa_kernarg_size 88
  .amdhsa_user_sgpr_count 2
  .amdhsa_user_sgpr_kernarg_segment_ptr 1
  .amdhsa_system_sgpr_workgroup_id_x 1
  .amdhsa_float_denorm_mode_32 3
  .amdhsa_float_denorm_mode_16_64 3
.end_amdhsa_kernel
```
